```python
import torch

def _softmax(x, axis=-1):
    return torch.softmax(x, dim=axis)
def _gelu(x):
    return torch.nn.functional.gelu(x, approximate="tanh")
def _silu(x):
    return torch.nn.functional.silu(x)
def _sigmoid(x):
    return torch.sigmoid(x)
def _layernorm(x, axis=-1, eps=1e-5):
    m = x.mean(dim=axis, keepdim=True)
    v = x.var(dim=axis, keepdim=True, unbiased=False)
    return (x - m) / torch.sqrt(v + eps)
def _scatter_add(tgt, idx, src, axis=0):
    return tgt.clone().index_add_(axis, idx, src)
def _segment_sum(src, seg, n):
    out = torch.zeros((n,) + src.shape[1:], dtype=src.dtype)
    return out.index_add_(0, seg, src)
def _pad(x, pw):
    flat = tuple(v for pair in reversed(pw) for v in pair)
    return torch.nn.functional.pad(x, flat)

kernel_name = 'concat_heads__gqa_block_cached__gqa_block_cached__near_ridge'

def setup_inputs():

    _w = (lambda a: (lambda t: t.to(torch.bfloat16) if t.is_floating_point() else t)(torch.as_tensor(a)))
    def _A_setup():
        B, Sq, D = 32, 32, 512
        Hq, Hkv, Sk, Dh = 32, 8, 512, 128
        assert Hq % Hkv == 0, (Hq, Hkv)
        return {
            "x": _w((lambda *s: torch.randn(*s, dtype=torch.bfloat16) * 0.8)(B, Sq, D)),
            "k_cache": _w((lambda *s: torch.randn(*s, dtype=torch.bfloat16) * 0.8)(B, Hkv, Sk, Dh)),
            "v_cache": _w((lambda *s: torch.randn(*s, dtype=torch.bfloat16) * 0.05)(B, Hkv, Sk, Dh)),
            "wq": _w((lambda *s: torch.randn(*s, dtype=torch.bfloat16) * 0.8)(D, Hq * Dh) * (D ** -0.5)),
            "wo": _w((lambda *s: torch.randn(*s, dtype=torch.bfloat16) * 0.05)(Hq * Dh, D) * ((Hq * Dh) ** -0.5)),
        }
    _A_in = _A_setup()

    def _B_setup():
        B, Sq, D = 32, 32, 512
        Hq, Hkv, Sk, Dh = 32, 8, 512, 128
        assert Hq % Hkv == 0, (Hq, Hkv)
        return {
            "x": _w((lambda *s: torch.randn(*s, dtype=torch.bfloat16) * 0.8)(B, Sq, D)),
            "k_cache": _w((lambda *s: torch.randn(*s, dtype=torch.bfloat16) * 0.8)(B, Hkv, Sk, Dh)),
            "v_cache": _w((lambda *s: torch.randn(*s, dtype=torch.bfloat16) * 0.05)(B, Hkv, Sk, Dh)),
            "wq": _w((lambda *s: torch.randn(*s, dtype=torch.bfloat16) * 0.8)(D, Hq * Dh) * (D ** -0.5)),
            "wo": _w((lambda *s: torch.randn(*s, dtype=torch.bfloat16) * 0.05)(Hq * Dh, D) * ((Hq * Dh) ** -0.5)),
        }
    _B_in = _B_setup()

    return {
        "A_x": _A_in["x"],
        "A_k_cache": _A_in["k_cache"],
        "A_v_cache": _A_in["v_cache"],
        "A_wq": _A_in["wq"],
        "A_wo": _A_in["wo"],
        "B_x": _B_in["x"],
        "B_k_cache": _B_in["k_cache"],
        "B_v_cache": _B_in["v_cache"],
        "B_wq": _B_in["wq"],
        "B_wo": _B_in["wo"],
    }

def reference(A_x, A_k_cache, A_v_cache, A_wq, A_wo, B_x, B_k_cache, B_v_cache, B_wq, B_wo):
    def _A_ref(x, k_cache, v_cache, wq, wo):
        B, Sq, D = x.shape
        Hq, Dh = 32, 128
        Hkv = k_cache.shape[1]
        rep = Hq // Hkv
        q = (lambda x, *d: x.permute(*d))((x @ wq).reshape(B, Sq, Hq, Dh), 0, 2, 1, 3)
        k = (lambda x, n, axis: torch.repeat_interleave(x, n, dim=axis))(k_cache, rep, axis=1)
        v = (lambda x, n, axis: torch.repeat_interleave(x, n, dim=axis))(v_cache, rep, axis=1)
        scores = torch.einsum("bhqd,bhkd->bhqk", q, k) * (Dh ** -0.5)
        p = _softmax(scores, axis=-1)
        o = torch.einsum("bhqk,bhkd->bhqd", p, v)
        return (lambda x, *d: x.permute(*d))(o, 0, 2, 1, 3).reshape(B, Sq, Hq * Dh) @ wo

    def _B_ref(x, k_cache, v_cache, wq, wo):
        B, Sq, D = x.shape
        Hq, Dh = 32, 128
        Hkv = k_cache.shape[1]
        rep = Hq // Hkv
        q = (lambda x, *d: x.permute(*d))((x @ wq).reshape(B, Sq, Hq, Dh), 0, 2, 1, 3)
        k = (lambda x, n, axis: torch.repeat_interleave(x, n, dim=axis))(k_cache, rep, axis=1)
        v = (lambda x, n, axis: torch.repeat_interleave(x, n, dim=axis))(v_cache, rep, axis=1)
        scores = torch.einsum("bhqd,bhkd->bhqk", q, k) * (Dh ** -0.5)
        p = _softmax(scores, axis=-1)
        o = torch.einsum("bhqk,bhkd->bhqd", p, v)
        return (lambda x, *d: x.permute(*d))(o, 0, 2, 1, 3).reshape(B, Sq, Hq * Dh) @ wo

    a = _A_ref(A_x, A_k_cache, A_v_cache, A_wq, A_wo)
    b = _B_ref(B_x, B_k_cache, B_v_cache, B_wq, B_wo)
    return torch.concatenate([a, b], axis=-1)
```

```asm
; @launch grid=(256,1,1) block=(512,1,1) lds=163840
.amdgcn_target "amdgcn-amd-amdhsa--gfx950"
.text
.globl concat_heads__gqa_block_cached__gqa_block_cached__near_ridge_kernel
.p2align 8
.type concat_heads__gqa_block_cached__gqa_block_cached__near_ridge_kernel,@function
concat_heads__gqa_block_cached__gqa_block_cached__near_ridge_kernel:
s_cmp_ge_u32 s2, 256
s_cbranch_scc1 L_end
s_load_dwordx16 s[64:79], s[0:1], 0
s_load_dwordx8 s[80:87], s[0:1], 64
s_load_dwordx2 s[88:89], s[0:1], 96
v_lshrrev_b32 v1, 6, v0
v_and_b32 v255, 63, v0
v_readfirstlane_b32 s40, v1
s_lshr_b32 s43, s2, 4
s_and_b32 s42, s2, 1
s_bfe_u32 s41, s2, 0x10003
s_and_b32 s52, s2, 6
s_or_b32 s41, s41, s52
s_lshl_b32 s51, s43, 1
s_or_b32 s51, s51, s42
s_lshr_b32 s44, s43, 1
s_lshl_b32 s52, s41, 2
s_add_u32 s44, s44, s52
s_and_b32 s44, s44, 7
s_and_b32 s60, s43, 1
s_lshl_b32 s3, s44, 1
s_or_b32 s3, s3, s60
s_and_b32 s63, s43, 1
s_mov_b32 s96, 16384
s_mov_b32 s97, 32768
s_mov_b32 s98, 49152
s_add_u32 s5, s43, s2
s_lshl_b32 s5, s5, 13
s_mov_b32 s45, 0x05040100
s_mov_b32 s46, 0x07060302
s_mov_b32 s6, 0x3e0293ee
s_mov_b32 s7, 0x3e0293ee
s_mov_b32 s48, 0x46800000
s_mov_b32 s58, 0x00003f80
s_mov_b32 s59, 0x3f800000
s_lshl_b32 s50, s40, 10
s_lshr_b32 s47, s40, 2
v_lshrrev_b32 v232, 3, v255
v_lshrrev_b32 v233, 4, v255
v_and_b32 v234, 7, v255
v_xor_b32 v234, v233, v234
v_lshlrev_b32 v234, 4, v234
v_lshl_add_u32 v248, v232, 10, v234
s_lshl_b32 s52, s40, 13
s_and_b32 s53, s40, 1
s_lshl_b32 s53, s53, 6
s_or_b32 s52, s52, s53
v_xor_b32 v248, s52, v248
v_and_b32 v234, 7, v255
v_lshlrev_b32 v234, 4, v234
v_lshl_add_u32 v252, v233, 16, v234
v_and_b32 v232, 1, v232
v_lshl_add_u32 v252, v232, 13, v252
s_and_b32 s52, s40, 3
s_lshl_b32 s52, s52, 8
s_lshl_b32 s53, s47, 7
s_or_b32 s52, s52, s53
s_lshl_b32 s53, s60, 18
s_or_b32 s52, s52, s53
v_add_u32 v252, s52, v252
s_lshl_b32 s61, s44, 19
s_cmp_eq_u32 s42, 0
s_waitcnt lgkmcnt(0)
s_cselect_b32 s8, s64, s74
s_cselect_b32 s9, s65, s75
s_cselect_b32 s20, s70, s80
s_cselect_b32 s21, s71, s81
s_cselect_b32 s12, s66, s76
s_cselect_b32 s13, s67, s77
s_cselect_b32 s16, s68, s78
s_cselect_b32 s17, s69, s79
s_cselect_b32 s24, s72, s82
s_cselect_b32 s25, s73, s83
s_lshl_b32 s52, s43, 16
s_add_u32 s8, s8, s52
s_addc_u32 s9, s9, 0
s_mov_b32 s10, 65536
s_mov_b32 s11, 0x00020000
s_lshl_b32 s52, s41, 10
s_add_u32 s20, s20, s52
s_addc_u32 s21, s21, 0
s_mov_b32 s22, 4187136
s_mov_b32 s23, 0x00020000
s_lshl_b32 s52, s43, 21
s_lshl_b32 s53, s41, 17
s_add_u32 s52, s52, s53
s_add_u32 s12, s12, s52
s_addc_u32 s13, s13, 0
s_mov_b32 s14, 1179648
s_mov_b32 s15, 0x00020000
s_add_u32 s16, s16, s52
s_addc_u32 s17, s17, 0
s_mov_b32 s18, 1179648
s_mov_b32 s19, 0x00020000
s_lshl_b32 s52, s41, 19
s_add_u32 s24, s24, s52
s_addc_u32 s25, s25, 0
s_mov_b32 s26, 524288
s_mov_b32 s27, 0x00020000
s_mov_b32 s32, s84
s_mov_b32 s33, s85
s_mov_b32 s34, 2097152
s_mov_b32 s35, 0x00020000
s_mov_b32 s36, s86
s_mov_b32 s37, s87
s_mov_b32 s38, 256
s_mov_b32 s39, 0x00020000
s_mov_b32 s28, s88
s_mov_b32 s29, s89
s_mov_b32 s30, 268435456
s_mov_b32 s31, 0x00020000
s_mov_b32 vcc_lo, 0x00ff00ff
s_mov_b32 vcc_hi, 0x00ff00ff
s_cmp_eq_u32 s63, 1
s_cbranch_scc1 L_cls1
s_add_u32 s52, s44, 0
s_and_b32 s52, s52, 7
s_lshl_b32 s52, s52, 7
s_add_u32 m0, s50, 24576
s_nop 0
buffer_load_dwordx4 v248, s[8:11], s52 offen  lds
s_add_u32 s52, s44, 1
s_and_b32 s52, s52, 7
s_lshl_b32 s52, s52, 7
s_add_u32 m0, s50, 65536
s_nop 0
buffer_load_dwordx4 v248, s[8:11], s52 offen  lds
s_add_u32 s52, s44, 2
s_and_b32 s52, s52, 7
s_lshl_b32 s52, s52, 7
s_add_u32 m0, s50, 106496
s_nop 0
buffer_load_dwordx4 v248, s[8:11], s52 offen  lds
s_add_u32 s52, s44, 3
s_and_b32 s52, s52, 7
s_lshl_b32 s52, s52, 7
s_add_u32 m0, s50, 147456
s_nop 0
buffer_load_dwordx4 v248, s[8:11], s52 offen  lds
s_barrier
v_add_u32 v251, s61, v252
buffer_load_dwordx4 v[64:67], v251, s[20:23], 0 offen
buffer_load_dwordx4 v[68:71], v251, s[20:23], s96 offen
buffer_load_dwordx4 v[72:75], v251, s[20:23], s97 offen
buffer_load_dwordx4 v[76:79], v251, s[20:23], s98 offen
s_barrier
v_xor_b32 v251, 262144, v251
buffer_load_dwordx4 v[80:83], v251, s[20:23], 0 offen
buffer_load_dwordx4 v[84:87], v251, s[20:23], s96 offen
buffer_load_dwordx4 v[88:91], v251, s[20:23], s97 offen
buffer_load_dwordx4 v[92:95], v251, s[20:23], s98 offen
s_add_u32 s61, s61, 524288
s_and_b32 s61, s61, 4194303
v_add_u32 v251, s61, v252
buffer_load_dwordx4 v[96:99], v251, s[20:23], 0 offen
buffer_load_dwordx4 v[100:103], v251, s[20:23], s96 offen
buffer_load_dwordx4 v[104:107], v251, s[20:23], s97 offen
buffer_load_dwordx4 v[108:111], v251, s[20:23], s98 offen
v_lshrrev_b32 v232, 4, v255
s_lshl_b32 s52, s40, 2
v_add_u32 v233, s52, v232
v_xor_b32 v234, v255, v233
v_and_b32 v234, 15, v234
v_lshlrev_b32 v234, 4, v234
v_lshl_add_u32 v249, v233, 8, v234
v_lshlrev_b32 v234, 2, v232
v_xor_b32 v234, v255, v234
v_and_b32 v234, 15, v234
v_lshlrev_b32 v234, 4, v234
v_lshl_add_u32 v250, v233, 8, v234
v_and_b32 v233, 15, v255
v_lshrrev_b32 v234, 1, v233
v_xor_b32 v234, v234, v232
v_lshlrev_b32 v234, 4, v234
v_lshl_add_u32 v253, v233, 7, v234
s_lshl_b32 s53, s60, 6
s_lshl_b32 s52, s47, 12
s_or_b32 s52, s52, s53
v_xor_b32 v253, s52, v253
v_xor_b32 v254, 0x1000, v253
s_lshl_b32 s62, s51, 19
s_lshl_b32 s53, s41, 16
s_add_u32 s62, s62, s53
s_lshl_b32 s53, s40, 13
s_add_u32 s62, s62, s53
v_and_b32 v232, 31, v255
v_lshrrev_b32 v233, 5, v255
v_and_b32 v234, 15, v255
v_xor_b32 v233, v233, v234
v_lshlrev_b32 v233, 4, v233
v_lshl_add_u32 v233, v232, 8, v233
s_lshl_b32 s52, s47, 7
v_xor_b32 v233, s52, v233
s_mul_i32 s52, s47, 40960
v_add_u32 v236, s52, v233
v_xor_b32 v237, 32, v236
v_xor_b32 v238, 64, v236
v_xor_b32 v239, 96, v236
v_xor_b32 v240, 128, v236
v_xor_b32 v241, 160, v236
v_xor_b32 v242, 192, v236
v_xor_b32 v243, 224, v236
v_bfe_u32 v232, v255, 2, 2
v_lshrrev_b32 v233, 5, v255
v_lshl_add_u32 v233, v233, 2, v232
v_lshlrev_b32 v233, 8, v233
v_lshl_add_u32 v233, v232, 6, v233
v_bfe_u32 v232, v255, 4, 1
v_lshl_add_u32 v233, v232, 5, v233
v_and_b32 v232, 3, v255
v_lshl_add_u32 v233, v232, 3, v233
s_add_u32 s52, s52, 81920
v_add_u32 v244, s52, v233
v_xor_b32 v245, 64, v244
v_xor_b32 v246, 128, v244
v_xor_b32 v247, 192, v244
s_waitcnt vmcnt(12)
s_barrier
ds_read_b128 v[160:163], v253 offset:24576
ds_read_b128 v[164:167], v253 offset:26624
ds_read_b128 v[168:171], v254 offset:24576
ds_read_b128 v[172:175], v254 offset:26624
s_waitcnt vmcnt(11)
v_cndmask_b32_dpp v148, v66, v64, vcc row_ror:8 row_mask:0xf bank_mask:0xf
s_waitcnt vmcnt(10)
v_cndmask_b32_dpp v149, v70, v68, vcc row_ror:8 row_mask:0xf bank_mask:0xf
v_mov_b32_dpp v66, v64 row_ror:8 row_mask:0xf bank_mask:0x3
v_mov_b32_dpp v70, v68 row_ror:8 row_mask:0xf bank_mask:0x3
v_perm_b32 v144, v66, v148, s45
v_perm_b32 v145, v70, v149, s45
v_perm_b32 v148, v66, v148, s46
v_perm_b32 v149, v70, v149, s46
s_waitcnt vmcnt(9)
v_cndmask_b32_dpp v150, v74, v72, vcc row_ror:8 row_mask:0xf bank_mask:0xf
s_waitcnt vmcnt(8)
v_cndmask_b32_dpp v151, v78, v76, vcc row_ror:8 row_mask:0xf bank_mask:0xf
v_mov_b32_dpp v74, v72 row_ror:8 row_mask:0xf bank_mask:0x3
v_mov_b32_dpp v78, v76 row_ror:8 row_mask:0xf bank_mask:0x3
v_perm_b32 v146, v74, v150, s45
v_perm_b32 v147, v78, v151, s45
v_perm_b32 v150, v74, v150, s46
v_perm_b32 v151, v78, v151, s46
s_waitcnt lgkmcnt(3)
v_mfma_f32_16x16x32_bf16 v[0:3], v[144:147], v[160:163], 0
v_cndmask_b32_dpp v156, v67, v65, vcc row_ror:8 row_mask:0xf bank_mask:0xf
v_cndmask_b32_dpp v157, v71, v69, vcc row_ror:8 row_mask:0xf bank_mask:0xf
s_waitcnt lgkmcnt(2)
v_mfma_f32_16x16x32_bf16 v[4:7], v[144:147], v[164:167], 0
v_mov_b32_dpp v67, v65 row_ror:8 row_mask:0xf bank_mask:0x3
v_mov_b32_dpp v71, v69 row_ror:8 row_mask:0xf bank_mask:0x3
s_waitcnt lgkmcnt(1)
v_mfma_f32_16x16x32_bf16 v[8:11], v[144:147], v[168:171], 0
v_perm_b32 v152, v67, v156, s45
v_perm_b32 v153, v71, v157, s45
s_waitcnt lgkmcnt(0)
v_mfma_f32_16x16x32_bf16 v[12:15], v[144:147], v[172:175], 0
v_perm_b32 v156, v67, v156, s46
v_perm_b32 v157, v71, v157, s46
v_mfma_f32_16x16x32_bf16 v[16:19], v[148:151], v[160:163], 0
v_cndmask_b32_dpp v158, v75, v73, vcc row_ror:8 row_mask:0xf bank_mask:0xf
v_cndmask_b32_dpp v159, v79, v77, vcc row_ror:8 row_mask:0xf bank_mask:0xf
v_mfma_f32_16x16x32_bf16 v[20:23], v[148:151], v[164:167], 0
v_mov_b32_dpp v75, v73 row_ror:8 row_mask:0xf bank_mask:0x3
v_mov_b32_dpp v79, v77 row_ror:8 row_mask:0xf bank_mask:0x3
v_mfma_f32_16x16x32_bf16 v[24:27], v[148:151], v[168:171], 0
v_perm_b32 v154, v75, v158, s45
v_perm_b32 v155, v79, v159, s45
v_mfma_f32_16x16x32_bf16 v[28:31], v[148:151], v[172:175], 0
v_perm_b32 v158, v75, v158, s46
v_perm_b32 v159, v79, v159, s46
v_mfma_f32_16x16x32_bf16 v[32:35], v[152:155], v[160:163], 0
v_xor_b32 v251, 262144, v251
buffer_load_dwordx4 v[64:67], v251, s[20:23], 0 offen
buffer_load_dwordx4 v[68:71], v251, s[20:23], s96 offen
buffer_load_dwordx4 v[72:75], v251, s[20:23], s97 offen
buffer_load_dwordx4 v[76:79], v251, s[20:23], s98 offen
s_waitcnt vmcnt(11)
v_cndmask_b32_dpp v148, v82, v80, vcc row_ror:8 row_mask:0xf bank_mask:0xf
s_waitcnt vmcnt(10)
v_cndmask_b32_dpp v149, v86, v84, vcc row_ror:8 row_mask:0xf bank_mask:0xf
v_mfma_f32_16x16x32_bf16 v[48:51], v[156:159], v[160:163], 0
v_xor_b32 v253, 64, v253
v_xor_b32 v254, 64, v254
ds_read_b128 v[160:163], v253 offset:24576
v_mov_b32_dpp v82, v80 row_ror:8 row_mask:0xf bank_mask:0x3
v_mov_b32_dpp v86, v84 row_ror:8 row_mask:0xf bank_mask:0x3
v_mfma_f32_16x16x32_bf16 v[36:39], v[152:155], v[164:167], 0
v_perm_b32 v144, v82, v148, s45
v_perm_b32 v145, v86, v149, s45
v_mfma_f32_16x16x32_bf16 v[52:55], v[156:159], v[164:167], 0
ds_read_b128 v[164:167], v253 offset:26624
v_perm_b32 v148, v82, v148, s46
v_perm_b32 v149, v86, v149, s46
v_mfma_f32_16x16x32_bf16 v[40:43], v[152:155], v[168:171], 0
s_waitcnt vmcnt(9)
v_cndmask_b32_dpp v150, v90, v88, vcc row_ror:8 row_mask:0xf bank_mask:0xf
s_waitcnt vmcnt(8)
v_cndmask_b32_dpp v151, v94, v92, vcc row_ror:8 row_mask:0xf bank_mask:0xf
v_mfma_f32_16x16x32_bf16 v[56:59], v[156:159], v[168:171], 0
ds_read_b128 v[168:171], v254 offset:24576
v_mov_b32_dpp v90, v88 row_ror:8 row_mask:0xf bank_mask:0x3
v_mov_b32_dpp v94, v92 row_ror:8 row_mask:0xf bank_mask:0x3
v_mfma_f32_16x16x32_bf16 v[44:47], v[152:155], v[172:175], 0
v_perm_b32 v146, v90, v150, s45
v_perm_b32 v147, v94, v151, s45
v_mfma_f32_16x16x32_bf16 v[60:63], v[156:159], v[172:175], 0
ds_read_b128 v[172:175], v254 offset:26624
v_perm_b32 v150, v90, v150, s46
v_perm_b32 v151, v94, v151, s46
s_add_u32 s52, s44, 4
s_and_b32 s52, s52, 7
s_lshl_b32 s52, s52, 7
s_add_u32 m0, s50, 32768
s_nop 0
buffer_load_dwordx4 v248, s[8:11], s52 offen  lds
s_add_u32 s52, s44, 5
s_and_b32 s52, s52, 7
s_lshl_b32 s52, s52, 7
s_add_u32 m0, s50, 73728
s_nop 0
buffer_load_dwordx4 v248, s[8:11], s52 offen  lds
s_add_u32 s52, s44, 6
s_and_b32 s52, s52, 7
s_lshl_b32 s52, s52, 7
s_add_u32 m0, s50, 114688
s_nop 0
buffer_load_dwordx4 v248, s[8:11], s52 offen  lds
s_add_u32 s52, s44, 7
s_and_b32 s52, s52, 7
s_lshl_b32 s52, s52, 7
s_add_u32 m0, s50, 155648
s_nop 0
buffer_load_dwordx4 v248, s[8:11], s52 offen  lds
s_waitcnt lgkmcnt(3)
v_mfma_f32_16x16x32_bf16 v[0:3], v[144:147], v[160:163], v[0:3]
v_cndmask_b32_dpp v156, v83, v81, vcc row_ror:8 row_mask:0xf bank_mask:0xf
v_cndmask_b32_dpp v157, v87, v85, vcc row_ror:8 row_mask:0xf bank_mask:0xf
s_waitcnt lgkmcnt(2)
v_mfma_f32_16x16x32_bf16 v[4:7], v[144:147], v[164:167], v[4:7]
v_mov_b32_dpp v83, v81 row_ror:8 row_mask:0xf bank_mask:0x3
v_mov_b32_dpp v87, v85 row_ror:8 row_mask:0xf bank_mask:0x3
s_waitcnt lgkmcnt(1)
v_mfma_f32_16x16x32_bf16 v[8:11], v[144:147], v[168:171], v[8:11]
v_perm_b32 v152, v83, v156, s45
v_perm_b32 v153, v87, v157, s45
s_waitcnt lgkmcnt(0)
v_mfma_f32_16x16x32_bf16 v[12:15], v[144:147], v[172:175], v[12:15]
v_perm_b32 v156, v83, v156, s46
v_perm_b32 v157, v87, v157, s46
v_mfma_f32_16x16x32_bf16 v[16:19], v[148:151], v[160:163], v[16:19]
v_cndmask_b32_dpp v158, v91, v89, vcc row_ror:8 row_mask:0xf bank_mask:0xf
v_cndmask_b32_dpp v159, v95, v93, vcc row_ror:8 row_mask:0xf bank_mask:0xf
v_mfma_f32_16x16x32_bf16 v[20:23], v[148:151], v[164:167], v[20:23]
v_mov_b32_dpp v91, v89 row_ror:8 row_mask:0xf bank_mask:0x3
v_mov_b32_dpp v95, v93 row_ror:8 row_mask:0xf bank_mask:0x3
v_mfma_f32_16x16x32_bf16 v[24:27], v[148:151], v[168:171], v[24:27]
v_perm_b32 v154, v91, v158, s45
v_perm_b32 v155, v95, v159, s45
v_mfma_f32_16x16x32_bf16 v[28:31], v[148:151], v[172:175], v[28:31]
v_perm_b32 v158, v91, v158, s46
v_perm_b32 v159, v95, v159, s46
v_mfma_f32_16x16x32_bf16 v[32:35], v[152:155], v[160:163], v[32:35]
s_add_u32 s61, s61, 524288
s_and_b32 s61, s61, 4194303
v_add_u32 v251, s61, v252
buffer_load_dwordx4 v[80:83], v251, s[20:23], 0 offen
buffer_load_dwordx4 v[84:87], v251, s[20:23], s96 offen
buffer_load_dwordx4 v[88:91], v251, s[20:23], s97 offen
buffer_load_dwordx4 v[92:95], v251, s[20:23], s98 offen
s_waitcnt vmcnt(15)
v_cndmask_b32_dpp v148, v98, v96, vcc row_ror:8 row_mask:0xf bank_mask:0xf
s_waitcnt vmcnt(14)
v_cndmask_b32_dpp v149, v102, v100, vcc row_ror:8 row_mask:0xf bank_mask:0xf
v_mfma_f32_16x16x32_bf16 v[48:51], v[156:159], v[160:163], v[48:51]
v_xor_b32 v253, 64, v253
v_add_u32 v253, 65536, v253
v_xor_b32 v254, 64, v254
v_add_u32 v254, 65536, v254
ds_read_b128 v[160:163], v253 offset:0
v_mov_b32_dpp v98, v96 row_ror:8 row_mask:0xf bank_mask:0x3
v_mov_b32_dpp v102, v100 row_ror:8 row_mask:0xf bank_mask:0x3
v_mfma_f32_16x16x32_bf16 v[36:39], v[152:155], v[164:167], v[36:39]
v_perm_b32 v144, v98, v148, s45
v_perm_b32 v145, v102, v149, s45
v_mfma_f32_16x16x32_bf16 v[52:55], v[156:159], v[164:167], v[52:55]
ds_read_b128 v[164:167], v253 offset:2048
v_perm_b32 v148, v98, v148, s46
v_perm_b32 v149, v102, v149, s46
v_mfma_f32_16x16x32_bf16 v[40:43], v[152:155], v[168:171], v[40:43]
s_waitcnt vmcnt(13)
v_cndmask_b32_dpp v150, v106, v104, vcc row_ror:8 row_mask:0xf bank_mask:0xf
s_waitcnt vmcnt(12)
v_cndmask_b32_dpp v151, v110, v108, vcc row_ror:8 row_mask:0xf bank_mask:0xf
v_mfma_f32_16x16x32_bf16 v[56:59], v[156:159], v[168:171], v[56:59]
ds_read_b128 v[168:171], v254 offset:0
v_mov_b32_dpp v106, v104 row_ror:8 row_mask:0xf bank_mask:0x3
v_mov_b32_dpp v110, v108 row_ror:8 row_mask:0xf bank_mask:0x3
v_mfma_f32_16x16x32_bf16 v[44:47], v[152:155], v[172:175], v[44:47]
v_perm_b32 v146, v106, v150, s45
v_perm_b32 v147, v110, v151, s45
v_mfma_f32_16x16x32_bf16 v[60:63], v[156:159], v[172:175], v[60:63]
ds_read_b128 v[172:175], v254 offset:2048
v_perm_b32 v150, v106, v150, s46
v_perm_b32 v151, v110, v151, s46
s_waitcnt lgkmcnt(3)
v_mfma_f32_16x16x32_bf16 v[0:3], v[144:147], v[160:163], v[0:3]
v_cndmask_b32_dpp v156, v99, v97, vcc row_ror:8 row_mask:0xf bank_mask:0xf
v_cndmask_b32_dpp v157, v103, v101, vcc row_ror:8 row_mask:0xf bank_mask:0xf
s_waitcnt lgkmcnt(2)
v_mfma_f32_16x16x32_bf16 v[4:7], v[144:147], v[164:167], v[4:7]
v_mov_b32_dpp v99, v97 row_ror:8 row_mask:0xf bank_mask:0x3
v_mov_b32_dpp v103, v101 row_ror:8 row_mask:0xf bank_mask:0x3
s_waitcnt lgkmcnt(1)
v_mfma_f32_16x16x32_bf16 v[8:11], v[144:147], v[168:171], v[8:11]
v_perm_b32 v152, v99, v156, s45
v_perm_b32 v153, v103, v157, s45
s_waitcnt lgkmcnt(0)
v_mfma_f32_16x16x32_bf16 v[12:15], v[144:147], v[172:175], v[12:15]
v_perm_b32 v156, v99, v156, s46
v_perm_b32 v157, v103, v157, s46
v_mfma_f32_16x16x32_bf16 v[16:19], v[148:151], v[160:163], v[16:19]
v_cndmask_b32_dpp v158, v107, v105, vcc row_ror:8 row_mask:0xf bank_mask:0xf
v_cndmask_b32_dpp v159, v111, v109, vcc row_ror:8 row_mask:0xf bank_mask:0xf
v_mfma_f32_16x16x32_bf16 v[20:23], v[148:151], v[164:167], v[20:23]
v_mov_b32_dpp v107, v105 row_ror:8 row_mask:0xf bank_mask:0x3
v_mov_b32_dpp v111, v109 row_ror:8 row_mask:0xf bank_mask:0x3
v_mfma_f32_16x16x32_bf16 v[24:27], v[148:151], v[168:171], v[24:27]
v_perm_b32 v154, v107, v158, s45
v_perm_b32 v155, v111, v159, s45
v_mfma_f32_16x16x32_bf16 v[28:31], v[148:151], v[172:175], v[28:31]
v_perm_b32 v158, v107, v158, s46
v_perm_b32 v159, v111, v159, s46
v_mfma_f32_16x16x32_bf16 v[32:35], v[152:155], v[160:163], v[32:35]
v_xor_b32 v251, 262144, v251
buffer_load_dwordx4 v[96:99], v251, s[20:23], 0 offen
buffer_load_dwordx4 v[100:103], v251, s[20:23], s96 offen
buffer_load_dwordx4 v[104:107], v251, s[20:23], s97 offen
buffer_load_dwordx4 v[108:111], v251, s[20:23], s98 offen
s_waitcnt vmcnt(15)
v_cndmask_b32_dpp v148, v66, v64, vcc row_ror:8 row_mask:0xf bank_mask:0xf
s_waitcnt vmcnt(14)
v_cndmask_b32_dpp v149, v70, v68, vcc row_ror:8 row_mask:0xf bank_mask:0xf
v_mfma_f32_16x16x32_bf16 v[48:51], v[156:159], v[160:163], v[48:51]
v_xor_b32 v253, 64, v253
v_xor_b32 v254, 64, v254
ds_read_b128 v[160:163], v253 offset:0
v_mov_b32_dpp v66, v64 row_ror:8 row_mask:0xf bank_mask:0x3
v_mov_b32_dpp v70, v68 row_ror:8 row_mask:0xf bank_mask:0x3
v_mfma_f32_16x16x32_bf16 v[36:39], v[152:155], v[164:167], v[36:39]
v_perm_b32 v144, v66, v148, s45
v_perm_b32 v145, v70, v149, s45
v_mfma_f32_16x16x32_bf16 v[52:55], v[156:159], v[164:167], v[52:55]
ds_read_b128 v[164:167], v253 offset:2048
v_perm_b32 v148, v66, v148, s46
v_perm_b32 v149, v70, v149, s46
v_mfma_f32_16x16x32_bf16 v[40:43], v[152:155], v[168:171], v[40:43]
s_waitcnt vmcnt(13)
v_cndmask_b32_dpp v150, v74, v72, vcc row_ror:8 row_mask:0xf bank_mask:0xf
s_waitcnt vmcnt(12)
v_cndmask_b32_dpp v151, v78, v76, vcc row_ror:8 row_mask:0xf bank_mask:0xf
v_mfma_f32_16x16x32_bf16 v[56:59], v[156:159], v[168:171], v[56:59]
ds_read_b128 v[168:171], v254 offset:0
v_mov_b32_dpp v74, v72 row_ror:8 row_mask:0xf bank_mask:0x3
v_mov_b32_dpp v78, v76 row_ror:8 row_mask:0xf bank_mask:0x3
v_mfma_f32_16x16x32_bf16 v[44:47], v[152:155], v[172:175], v[44:47]
v_perm_b32 v146, v74, v150, s45
v_perm_b32 v147, v78, v151, s45
v_mfma_f32_16x16x32_bf16 v[60:63], v[156:159], v[172:175], v[60:63]
ds_read_b128 v[172:175], v254 offset:2048
v_perm_b32 v150, v74, v150, s46
v_perm_b32 v151, v78, v151, s46
s_lshl_b32 s52, s51, 11
s_lshr_b32 s53, s50, 2
s_add_u32 s52, s52, s53
s_add_u32 s52, s52, 16777216
s_lshl_b32 s53, s41, 2
s_add_u32 s52, s52, s53
v_min_u32 v228, 1, v255
v_lshlrev_b32 v228, 30, v228
v_mov_b32 v224, 0
buffer_store_dword v224, v228, s[28:31], s52 offen sc1
s_waitcnt lgkmcnt(3)
v_mfma_f32_16x16x32_bf16 v[0:3], v[144:147], v[160:163], v[0:3]
v_cndmask_b32_dpp v156, v67, v65, vcc row_ror:8 row_mask:0xf bank_mask:0xf
v_cndmask_b32_dpp v157, v71, v69, vcc row_ror:8 row_mask:0xf bank_mask:0xf
s_waitcnt lgkmcnt(2)
v_mfma_f32_16x16x32_bf16 v[4:7], v[144:147], v[164:167], v[4:7]
v_mov_b32_dpp v67, v65 row_ror:8 row_mask:0xf bank_mask:0x3
v_mov_b32_dpp v71, v69 row_ror:8 row_mask:0xf bank_mask:0x3
s_waitcnt lgkmcnt(1)
v_mfma_f32_16x16x32_bf16 v[8:11], v[144:147], v[168:171], v[8:11]
v_perm_b32 v152, v67, v156, s45
v_perm_b32 v153, v71, v157, s45
s_waitcnt lgkmcnt(0)
v_mfma_f32_16x16x32_bf16 v[12:15], v[144:147], v[172:175], v[12:15]
v_perm_b32 v156, v67, v156, s46
v_perm_b32 v157, v71, v157, s46
v_mfma_f32_16x16x32_bf16 v[16:19], v[148:151], v[160:163], v[16:19]
v_cndmask_b32_dpp v158, v75, v73, vcc row_ror:8 row_mask:0xf bank_mask:0xf
v_cndmask_b32_dpp v159, v79, v77, vcc row_ror:8 row_mask:0xf bank_mask:0xf
v_mfma_f32_16x16x32_bf16 v[20:23], v[148:151], v[164:167], v[20:23]
v_mov_b32_dpp v75, v73 row_ror:8 row_mask:0xf bank_mask:0x3
v_mov_b32_dpp v79, v77 row_ror:8 row_mask:0xf bank_mask:0x3
v_mfma_f32_16x16x32_bf16 v[24:27], v[148:151], v[168:171], v[24:27]
v_perm_b32 v154, v75, v158, s45
v_perm_b32 v155, v79, v159, s45
v_mfma_f32_16x16x32_bf16 v[28:31], v[148:151], v[172:175], v[28:31]
v_perm_b32 v158, v75, v158, s46
v_perm_b32 v159, v79, v159, s46
v_mfma_f32_16x16x32_bf16 v[32:35], v[152:155], v[160:163], v[32:35]
s_add_u32 s61, s61, 524288
s_and_b32 s61, s61, 4194303
v_add_u32 v251, s61, v252
buffer_load_dwordx4 v[64:67], v251, s[20:23], 0 offen
buffer_load_dwordx4 v[68:71], v251, s[20:23], s96 offen
buffer_load_dwordx4 v[72:75], v251, s[20:23], s97 offen
buffer_load_dwordx4 v[76:79], v251, s[20:23], s98 offen
s_waitcnt vmcnt(12)
v_cndmask_b32_dpp v148, v82, v80, vcc row_ror:8 row_mask:0xf bank_mask:0xf
s_waitcnt vmcnt(11)
v_cndmask_b32_dpp v149, v86, v84, vcc row_ror:8 row_mask:0xf bank_mask:0xf
v_mfma_f32_16x16x32_bf16 v[48:51], v[156:159], v[160:163], v[48:51]
v_xor_b32 v253, 64, v253
v_xor_b32 v254, 64, v254
ds_read_b128 v[160:163], v253 offset:40960
v_mov_b32_dpp v82, v80 row_ror:8 row_mask:0xf bank_mask:0x3
v_mov_b32_dpp v86, v84 row_ror:8 row_mask:0xf bank_mask:0x3
v_mfma_f32_16x16x32_bf16 v[36:39], v[152:155], v[164:167], v[36:39]
v_perm_b32 v144, v82, v148, s45
v_perm_b32 v145, v86, v149, s45
v_mfma_f32_16x16x32_bf16 v[52:55], v[156:159], v[164:167], v[52:55]
ds_read_b128 v[164:167], v253 offset:43008
v_perm_b32 v148, v82, v148, s46
v_perm_b32 v149, v86, v149, s46
v_mfma_f32_16x16x32_bf16 v[40:43], v[152:155], v[168:171], v[40:43]
s_waitcnt vmcnt(10)
v_cndmask_b32_dpp v150, v90, v88, vcc row_ror:8 row_mask:0xf bank_mask:0xf
s_waitcnt vmcnt(9)
v_cndmask_b32_dpp v151, v94, v92, vcc row_ror:8 row_mask:0xf bank_mask:0xf
v_mfma_f32_16x16x32_bf16 v[56:59], v[156:159], v[168:171], v[56:59]
ds_read_b128 v[168:171], v254 offset:40960
v_mov_b32_dpp v90, v88 row_ror:8 row_mask:0xf bank_mask:0x3
v_mov_b32_dpp v94, v92 row_ror:8 row_mask:0xf bank_mask:0x3
v_mfma_f32_16x16x32_bf16 v[44:47], v[152:155], v[172:175], v[44:47]
v_perm_b32 v146, v90, v150, s45
v_perm_b32 v147, v94, v151, s45
v_mfma_f32_16x16x32_bf16 v[60:63], v[156:159], v[172:175], v[60:63]
ds_read_b128 v[172:175], v254 offset:43008
v_perm_b32 v150, v90, v150, s46
v_perm_b32 v151, v94, v151, s46
s_waitcnt lgkmcnt(3)
v_mfma_f32_16x16x32_bf16 v[0:3], v[144:147], v[160:163], v[0:3]
v_cndmask_b32_dpp v156, v83, v81, vcc row_ror:8 row_mask:0xf bank_mask:0xf
v_cndmask_b32_dpp v157, v87, v85, vcc row_ror:8 row_mask:0xf bank_mask:0xf
s_waitcnt lgkmcnt(2)
v_mfma_f32_16x16x32_bf16 v[4:7], v[144:147], v[164:167], v[4:7]
v_mov_b32_dpp v83, v81 row_ror:8 row_mask:0xf bank_mask:0x3
v_mov_b32_dpp v87, v85 row_ror:8 row_mask:0xf bank_mask:0x3
s_waitcnt lgkmcnt(1)
v_mfma_f32_16x16x32_bf16 v[8:11], v[144:147], v[168:171], v[8:11]
v_perm_b32 v152, v83, v156, s45
v_perm_b32 v153, v87, v157, s45
s_waitcnt lgkmcnt(0)
v_mfma_f32_16x16x32_bf16 v[12:15], v[144:147], v[172:175], v[12:15]
v_perm_b32 v156, v83, v156, s46
v_perm_b32 v157, v87, v157, s46
v_mfma_f32_16x16x32_bf16 v[16:19], v[148:151], v[160:163], v[16:19]
v_cndmask_b32_dpp v158, v91, v89, vcc row_ror:8 row_mask:0xf bank_mask:0xf
v_cndmask_b32_dpp v159, v95, v93, vcc row_ror:8 row_mask:0xf bank_mask:0xf
v_mfma_f32_16x16x32_bf16 v[20:23], v[148:151], v[164:167], v[20:23]
v_mov_b32_dpp v91, v89 row_ror:8 row_mask:0xf bank_mask:0x3
v_mov_b32_dpp v95, v93 row_ror:8 row_mask:0xf bank_mask:0x3
v_mfma_f32_16x16x32_bf16 v[24:27], v[148:151], v[168:171], v[24:27]
v_perm_b32 v154, v91, v158, s45
v_perm_b32 v155, v95, v159, s45
v_mfma_f32_16x16x32_bf16 v[28:31], v[148:151], v[172:175], v[28:31]
v_perm_b32 v158, v91, v158, s46
v_perm_b32 v159, v95, v159, s46
v_mfma_f32_16x16x32_bf16 v[32:35], v[152:155], v[160:163], v[32:35]
v_xor_b32 v251, 262144, v251
buffer_load_dwordx4 v[80:83], v251, s[20:23], 0 offen
buffer_load_dwordx4 v[84:87], v251, s[20:23], s96 offen
buffer_load_dwordx4 v[88:91], v251, s[20:23], s97 offen
buffer_load_dwordx4 v[92:95], v251, s[20:23], s98 offen
s_waitcnt vmcnt(12)
v_cndmask_b32_dpp v148, v98, v96, vcc row_ror:8 row_mask:0xf bank_mask:0xf
s_waitcnt vmcnt(11)
v_cndmask_b32_dpp v149, v102, v100, vcc row_ror:8 row_mask:0xf bank_mask:0xf
v_mfma_f32_16x16x32_bf16 v[48:51], v[156:159], v[160:163], v[48:51]
v_xor_b32 v253, 64, v253
v_xor_b32 v254, 64, v254
ds_read_b128 v[160:163], v253 offset:40960
v_mov_b32_dpp v98, v96 row_ror:8 row_mask:0xf bank_mask:0x3
v_mov_b32_dpp v102, v100 row_ror:8 row_mask:0xf bank_mask:0x3
v_mfma_f32_16x16x32_bf16 v[36:39], v[152:155], v[164:167], v[36:39]
v_perm_b32 v144, v98, v148, s45
v_perm_b32 v145, v102, v149, s45
v_mfma_f32_16x16x32_bf16 v[52:55], v[156:159], v[164:167], v[52:55]
ds_read_b128 v[164:167], v253 offset:43008
v_perm_b32 v148, v98, v148, s46
v_perm_b32 v149, v102, v149, s46
v_mfma_f32_16x16x32_bf16 v[40:43], v[152:155], v[168:171], v[40:43]
s_waitcnt vmcnt(10)
v_cndmask_b32_dpp v150, v106, v104, vcc row_ror:8 row_mask:0xf bank_mask:0xf
s_waitcnt vmcnt(9)
v_cndmask_b32_dpp v151, v110, v108, vcc row_ror:8 row_mask:0xf bank_mask:0xf
v_mfma_f32_16x16x32_bf16 v[56:59], v[156:159], v[168:171], v[56:59]
ds_read_b128 v[168:171], v254 offset:40960
v_mov_b32_dpp v106, v104 row_ror:8 row_mask:0xf bank_mask:0x3
v_mov_b32_dpp v110, v108 row_ror:8 row_mask:0xf bank_mask:0x3
v_mfma_f32_16x16x32_bf16 v[44:47], v[152:155], v[172:175], v[44:47]
v_perm_b32 v146, v106, v150, s45
v_perm_b32 v147, v110, v151, s45
v_mfma_f32_16x16x32_bf16 v[60:63], v[156:159], v[172:175], v[60:63]
ds_read_b128 v[172:175], v254 offset:43008
v_perm_b32 v150, v106, v150, s46
v_perm_b32 v151, v110, v151, s46
s_waitcnt lgkmcnt(3)
v_mfma_f32_16x16x32_bf16 v[0:3], v[144:147], v[160:163], v[0:3]
v_cndmask_b32_dpp v156, v99, v97, vcc row_ror:8 row_mask:0xf bank_mask:0xf
v_cndmask_b32_dpp v157, v103, v101, vcc row_ror:8 row_mask:0xf bank_mask:0xf
s_waitcnt lgkmcnt(2)
v_mfma_f32_16x16x32_bf16 v[4:7], v[144:147], v[164:167], v[4:7]
v_mov_b32_dpp v99, v97 row_ror:8 row_mask:0xf bank_mask:0x3
v_mov_b32_dpp v103, v101 row_ror:8 row_mask:0xf bank_mask:0x3
s_waitcnt lgkmcnt(1)
v_mfma_f32_16x16x32_bf16 v[8:11], v[144:147], v[168:171], v[8:11]
v_perm_b32 v152, v99, v156, s45
v_perm_b32 v153, v103, v157, s45
s_waitcnt lgkmcnt(0)
v_mfma_f32_16x16x32_bf16 v[12:15], v[144:147], v[172:175], v[12:15]
v_perm_b32 v156, v99, v156, s46
v_perm_b32 v157, v103, v157, s46
v_mfma_f32_16x16x32_bf16 v[16:19], v[148:151], v[160:163], v[16:19]
v_cndmask_b32_dpp v158, v107, v105, vcc row_ror:8 row_mask:0xf bank_mask:0xf
v_cndmask_b32_dpp v159, v111, v109, vcc row_ror:8 row_mask:0xf bank_mask:0xf
v_mfma_f32_16x16x32_bf16 v[20:23], v[148:151], v[164:167], v[20:23]
v_mov_b32_dpp v107, v105 row_ror:8 row_mask:0xf bank_mask:0x3
v_mov_b32_dpp v111, v109 row_ror:8 row_mask:0xf bank_mask:0x3
v_mfma_f32_16x16x32_bf16 v[24:27], v[148:151], v[168:171], v[24:27]
v_perm_b32 v154, v107, v158, s45
v_perm_b32 v155, v111, v159, s45
v_mfma_f32_16x16x32_bf16 v[28:31], v[148:151], v[172:175], v[28:31]
v_perm_b32 v158, v107, v158, s46
v_perm_b32 v159, v111, v159, s46
v_mfma_f32_16x16x32_bf16 v[32:35], v[152:155], v[160:163], v[32:35]
s_add_u32 s61, s61, 524288
s_and_b32 s61, s61, 4194303
v_add_u32 v251, s61, v252
buffer_load_dwordx4 v[96:99], v251, s[20:23], 0 offen
buffer_load_dwordx4 v[100:103], v251, s[20:23], s96 offen
buffer_load_dwordx4 v[104:107], v251, s[20:23], s97 offen
buffer_load_dwordx4 v[108:111], v251, s[20:23], s98 offen
s_waitcnt vmcnt(11)
v_cndmask_b32_dpp v148, v66, v64, vcc row_ror:8 row_mask:0xf bank_mask:0xf
s_waitcnt vmcnt(10)
v_cndmask_b32_dpp v149, v70, v68, vcc row_ror:8 row_mask:0xf bank_mask:0xf
v_mfma_f32_16x16x32_bf16 v[48:51], v[156:159], v[160:163], v[48:51]
v_xor_b32 v253, 64, v253
v_add_u32 v253, 81920, v253
v_xor_b32 v254, 64, v254
v_add_u32 v254, 81920, v254
ds_read_b128 v[160:163], v253 offset:0
v_mov_b32_dpp v66, v64 row_ror:8 row_mask:0xf bank_mask:0x3
v_mov_b32_dpp v70, v68 row_ror:8 row_mask:0xf bank_mask:0x3
v_mfma_f32_16x16x32_bf16 v[36:39], v[152:155], v[164:167], v[36:39]
v_perm_b32 v144, v66, v148, s45
v_perm_b32 v145, v70, v149, s45
v_mfma_f32_16x16x32_bf16 v[52:55], v[156:159], v[164:167], v[52:55]
ds_read_b128 v[164:167], v253 offset:2048
v_perm_b32 v148, v66, v148, s46
v_perm_b32 v149, v70, v149, s46
v_mfma_f32_16x16x32_bf16 v[40:43], v[152:155], v[168:171], v[40:43]
s_waitcnt vmcnt(9)
v_cndmask_b32_dpp v150, v74, v72, vcc row_ror:8 row_mask:0xf bank_mask:0xf
s_waitcnt vmcnt(8)
v_cndmask_b32_dpp v151, v78, v76, vcc row_ror:8 row_mask:0xf bank_mask:0xf
v_mfma_f32_16x16x32_bf16 v[56:59], v[156:159], v[168:171], v[56:59]
ds_read_b128 v[168:171], v254 offset:0
v_mov_b32_dpp v74, v72 row_ror:8 row_mask:0xf bank_mask:0x3
v_mov_b32_dpp v78, v76 row_ror:8 row_mask:0xf bank_mask:0x3
v_mfma_f32_16x16x32_bf16 v[44:47], v[152:155], v[172:175], v[44:47]
v_perm_b32 v146, v74, v150, s45
v_perm_b32 v147, v78, v151, s45
v_mfma_f32_16x16x32_bf16 v[60:63], v[156:159], v[172:175], v[60:63]
ds_read_b128 v[172:175], v254 offset:2048
v_perm_b32 v150, v74, v150, s46
v_perm_b32 v151, v78, v151, s46
s_waitcnt lgkmcnt(3)
v_mfma_f32_16x16x32_bf16 v[0:3], v[144:147], v[160:163], v[0:3]
v_cndmask_b32_dpp v156, v67, v65, vcc row_ror:8 row_mask:0xf bank_mask:0xf
v_cndmask_b32_dpp v157, v71, v69, vcc row_ror:8 row_mask:0xf bank_mask:0xf
s_waitcnt lgkmcnt(2)
v_mfma_f32_16x16x32_bf16 v[4:7], v[144:147], v[164:167], v[4:7]
v_mov_b32_dpp v67, v65 row_ror:8 row_mask:0xf bank_mask:0x3
v_mov_b32_dpp v71, v69 row_ror:8 row_mask:0xf bank_mask:0x3
s_waitcnt lgkmcnt(1)
v_mfma_f32_16x16x32_bf16 v[8:11], v[144:147], v[168:171], v[8:11]
v_perm_b32 v152, v67, v156, s45
v_perm_b32 v153, v71, v157, s45
s_waitcnt lgkmcnt(0)
v_mfma_f32_16x16x32_bf16 v[12:15], v[144:147], v[172:175], v[12:15]
v_perm_b32 v156, v67, v156, s46
v_perm_b32 v157, v71, v157, s46
v_mfma_f32_16x16x32_bf16 v[16:19], v[148:151], v[160:163], v[16:19]
v_cndmask_b32_dpp v158, v75, v73, vcc row_ror:8 row_mask:0xf bank_mask:0xf
v_cndmask_b32_dpp v159, v79, v77, vcc row_ror:8 row_mask:0xf bank_mask:0xf
v_mfma_f32_16x16x32_bf16 v[20:23], v[148:151], v[164:167], v[20:23]
v_mov_b32_dpp v75, v73 row_ror:8 row_mask:0xf bank_mask:0x3
v_mov_b32_dpp v79, v77 row_ror:8 row_mask:0xf bank_mask:0x3
v_mfma_f32_16x16x32_bf16 v[24:27], v[148:151], v[168:171], v[24:27]
v_perm_b32 v154, v75, v158, s45
v_perm_b32 v155, v79, v159, s45
v_mfma_f32_16x16x32_bf16 v[28:31], v[148:151], v[172:175], v[28:31]
v_perm_b32 v158, v75, v158, s46
v_perm_b32 v159, v79, v159, s46
v_mfma_f32_16x16x32_bf16 v[32:35], v[152:155], v[160:163], v[32:35]
v_xor_b32 v251, 262144, v251
buffer_load_dwordx4 v[64:67], v251, s[20:23], 0 offen
buffer_load_dwordx4 v[68:71], v251, s[20:23], s96 offen
buffer_load_dwordx4 v[72:75], v251, s[20:23], s97 offen
buffer_load_dwordx4 v[76:79], v251, s[20:23], s98 offen
s_waitcnt vmcnt(11)
v_cndmask_b32_dpp v148, v82, v80, vcc row_ror:8 row_mask:0xf bank_mask:0xf
s_waitcnt vmcnt(10)
v_cndmask_b32_dpp v149, v86, v84, vcc row_ror:8 row_mask:0xf bank_mask:0xf
v_mfma_f32_16x16x32_bf16 v[48:51], v[156:159], v[160:163], v[48:51]
v_xor_b32 v253, 64, v253
v_xor_b32 v254, 64, v254
ds_read_b128 v[160:163], v253 offset:0
v_mov_b32_dpp v82, v80 row_ror:8 row_mask:0xf bank_mask:0x3
v_mov_b32_dpp v86, v84 row_ror:8 row_mask:0xf bank_mask:0x3
v_mfma_f32_16x16x32_bf16 v[36:39], v[152:155], v[164:167], v[36:39]
v_perm_b32 v144, v82, v148, s45
v_perm_b32 v145, v86, v149, s45
v_mfma_f32_16x16x32_bf16 v[52:55], v[156:159], v[164:167], v[52:55]
ds_read_b128 v[164:167], v253 offset:2048
v_perm_b32 v148, v82, v148, s46
v_perm_b32 v149, v86, v149, s46
v_mfma_f32_16x16x32_bf16 v[40:43], v[152:155], v[168:171], v[40:43]
s_waitcnt vmcnt(9)
v_cndmask_b32_dpp v150, v90, v88, vcc row_ror:8 row_mask:0xf bank_mask:0xf
s_waitcnt vmcnt(8)
v_cndmask_b32_dpp v151, v94, v92, vcc row_ror:8 row_mask:0xf bank_mask:0xf
v_mfma_f32_16x16x32_bf16 v[56:59], v[156:159], v[168:171], v[56:59]
ds_read_b128 v[168:171], v254 offset:0
v_mov_b32_dpp v90, v88 row_ror:8 row_mask:0xf bank_mask:0x3
v_mov_b32_dpp v94, v92 row_ror:8 row_mask:0xf bank_mask:0x3
v_mfma_f32_16x16x32_bf16 v[44:47], v[152:155], v[172:175], v[44:47]
v_perm_b32 v146, v90, v150, s45
v_perm_b32 v147, v94, v151, s45
v_mfma_f32_16x16x32_bf16 v[60:63], v[156:159], v[172:175], v[60:63]
ds_read_b128 v[172:175], v254 offset:2048
v_perm_b32 v150, v90, v150, s46
v_perm_b32 v151, v94, v151, s46
s_waitcnt lgkmcnt(3)
v_mfma_f32_16x16x32_bf16 v[0:3], v[144:147], v[160:163], v[0:3]
v_cndmask_b32_dpp v156, v83, v81, vcc row_ror:8 row_mask:0xf bank_mask:0xf
v_cndmask_b32_dpp v157, v87, v85, vcc row_ror:8 row_mask:0xf bank_mask:0xf
s_waitcnt lgkmcnt(2)
v_mfma_f32_16x16x32_bf16 v[4:7], v[144:147], v[164:167], v[4:7]
v_mov_b32_dpp v83, v81 row_ror:8 row_mask:0xf bank_mask:0x3
v_mov_b32_dpp v87, v85 row_ror:8 row_mask:0xf bank_mask:0x3
s_waitcnt lgkmcnt(1)
v_mfma_f32_16x16x32_bf16 v[8:11], v[144:147], v[168:171], v[8:11]
v_perm_b32 v152, v83, v156, s45
v_perm_b32 v153, v87, v157, s45
s_waitcnt lgkmcnt(0)
v_mfma_f32_16x16x32_bf16 v[12:15], v[144:147], v[172:175], v[12:15]
v_perm_b32 v156, v83, v156, s46
v_perm_b32 v157, v87, v157, s46
v_mfma_f32_16x16x32_bf16 v[16:19], v[148:151], v[160:163], v[16:19]
v_cndmask_b32_dpp v158, v91, v89, vcc row_ror:8 row_mask:0xf bank_mask:0xf
v_cndmask_b32_dpp v159, v95, v93, vcc row_ror:8 row_mask:0xf bank_mask:0xf
v_mfma_f32_16x16x32_bf16 v[20:23], v[148:151], v[164:167], v[20:23]
v_mov_b32_dpp v91, v89 row_ror:8 row_mask:0xf bank_mask:0x3
v_mov_b32_dpp v95, v93 row_ror:8 row_mask:0xf bank_mask:0x3
v_mfma_f32_16x16x32_bf16 v[24:27], v[148:151], v[168:171], v[24:27]
v_perm_b32 v154, v91, v158, s45
v_perm_b32 v155, v95, v159, s45
v_mfma_f32_16x16x32_bf16 v[28:31], v[148:151], v[172:175], v[28:31]
v_perm_b32 v158, v91, v158, s46
v_perm_b32 v159, v95, v159, s46
v_mfma_f32_16x16x32_bf16 v[32:35], v[152:155], v[160:163], v[32:35]
s_barrier
s_add_u32 s61, s61, 524288
s_and_b32 s61, s61, 4194303
v_add_u32 v251, s61, v252
buffer_load_dwordx4 v[80:83], v251, s[20:23], 0 offen
buffer_load_dwordx4 v[84:87], v251, s[20:23], s96 offen
buffer_load_dwordx4 v[88:91], v251, s[20:23], s97 offen
buffer_load_dwordx4 v[92:95], v251, s[20:23], s98 offen
s_waitcnt vmcnt(11)
v_cndmask_b32_dpp v148, v98, v96, vcc row_ror:8 row_mask:0xf bank_mask:0xf
s_waitcnt vmcnt(10)
v_cndmask_b32_dpp v149, v102, v100, vcc row_ror:8 row_mask:0xf bank_mask:0xf
v_mfma_f32_16x16x32_bf16 v[48:51], v[156:159], v[160:163], v[48:51]
v_xor_b32 v253, 64, v253
v_add_u32 v253, 4294852608, v253
v_xor_b32 v254, 64, v254
v_add_u32 v254, 4294852608, v254
ds_read_b128 v[160:163], v253 offset:0
v_mov_b32_dpp v98, v96 row_ror:8 row_mask:0xf bank_mask:0x3
v_mov_b32_dpp v102, v100 row_ror:8 row_mask:0xf bank_mask:0x3
v_mfma_f32_16x16x32_bf16 v[36:39], v[152:155], v[164:167], v[36:39]
v_perm_b32 v144, v98, v148, s45
v_perm_b32 v145, v102, v149, s45
v_mfma_f32_16x16x32_bf16 v[52:55], v[156:159], v[164:167], v[52:55]
ds_read_b128 v[164:167], v253 offset:2048
v_perm_b32 v148, v98, v148, s46
v_perm_b32 v149, v102, v149, s46
v_mfma_f32_16x16x32_bf16 v[40:43], v[152:155], v[168:171], v[40:43]
s_waitcnt vmcnt(9)
v_cndmask_b32_dpp v150, v106, v104, vcc row_ror:8 row_mask:0xf bank_mask:0xf
s_waitcnt vmcnt(8)
v_cndmask_b32_dpp v151, v110, v108, vcc row_ror:8 row_mask:0xf bank_mask:0xf
v_mfma_f32_16x16x32_bf16 v[56:59], v[156:159], v[168:171], v[56:59]
ds_read_b128 v[168:171], v254 offset:0
v_mov_b32_dpp v106, v104 row_ror:8 row_mask:0xf bank_mask:0x3
v_mov_b32_dpp v110, v108 row_ror:8 row_mask:0xf bank_mask:0x3
v_mfma_f32_16x16x32_bf16 v[44:47], v[152:155], v[172:175], v[44:47]
v_perm_b32 v146, v106, v150, s45
v_perm_b32 v147, v110, v151, s45
v_mfma_f32_16x16x32_bf16 v[60:63], v[156:159], v[172:175], v[60:63]
ds_read_b128 v[172:175], v254 offset:2048
v_perm_b32 v150, v106, v150, s46
v_perm_b32 v151, v110, v151, s46
s_waitcnt lgkmcnt(3)
v_mfma_f32_16x16x32_bf16 v[0:3], v[144:147], v[160:163], v[0:3]
v_cndmask_b32_dpp v156, v99, v97, vcc row_ror:8 row_mask:0xf bank_mask:0xf
v_cndmask_b32_dpp v157, v103, v101, vcc row_ror:8 row_mask:0xf bank_mask:0xf
s_waitcnt lgkmcnt(2)
v_mfma_f32_16x16x32_bf16 v[4:7], v[144:147], v[164:167], v[4:7]
v_mov_b32_dpp v99, v97 row_ror:8 row_mask:0xf bank_mask:0x3
v_mov_b32_dpp v103, v101 row_ror:8 row_mask:0xf bank_mask:0x3
s_waitcnt lgkmcnt(1)
v_mfma_f32_16x16x32_bf16 v[8:11], v[144:147], v[168:171], v[8:11]
v_perm_b32 v152, v99, v156, s45
v_perm_b32 v153, v103, v157, s45
s_waitcnt lgkmcnt(0)
v_mfma_f32_16x16x32_bf16 v[12:15], v[144:147], v[172:175], v[12:15]
v_perm_b32 v156, v99, v156, s46
v_perm_b32 v157, v103, v157, s46
v_mfma_f32_16x16x32_bf16 v[16:19], v[148:151], v[160:163], v[16:19]
v_cndmask_b32_dpp v158, v107, v105, vcc row_ror:8 row_mask:0xf bank_mask:0xf
v_cndmask_b32_dpp v159, v111, v109, vcc row_ror:8 row_mask:0xf bank_mask:0xf
v_mfma_f32_16x16x32_bf16 v[20:23], v[148:151], v[164:167], v[20:23]
v_mov_b32_dpp v107, v105 row_ror:8 row_mask:0xf bank_mask:0x3
v_mov_b32_dpp v111, v109 row_ror:8 row_mask:0xf bank_mask:0x3
v_mfma_f32_16x16x32_bf16 v[24:27], v[148:151], v[168:171], v[24:27]
v_perm_b32 v154, v107, v158, s45
v_perm_b32 v155, v111, v159, s45
v_mfma_f32_16x16x32_bf16 v[28:31], v[148:151], v[172:175], v[28:31]
v_perm_b32 v158, v107, v158, s46
v_perm_b32 v159, v111, v159, s46
v_mfma_f32_16x16x32_bf16 v[32:35], v[152:155], v[160:163], v[32:35]
v_xor_b32 v251, 262144, v251
buffer_load_dwordx4 v[96:99], v251, s[20:23], 0 offen
buffer_load_dwordx4 v[100:103], v251, s[20:23], s96 offen
buffer_load_dwordx4 v[104:107], v251, s[20:23], s97 offen
buffer_load_dwordx4 v[108:111], v251, s[20:23], s98 offen
s_waitcnt vmcnt(11)
v_cndmask_b32_dpp v148, v66, v64, vcc row_ror:8 row_mask:0xf bank_mask:0xf
s_waitcnt vmcnt(10)
v_cndmask_b32_dpp v149, v70, v68, vcc row_ror:8 row_mask:0xf bank_mask:0xf
v_mfma_f32_16x16x32_bf16 v[48:51], v[156:159], v[160:163], v[48:51]
v_xor_b32 v253, 64, v253
v_xor_b32 v254, 64, v254
ds_read_b128 v[160:163], v253 offset:0
v_mov_b32_dpp v66, v64 row_ror:8 row_mask:0xf bank_mask:0x3
v_mov_b32_dpp v70, v68 row_ror:8 row_mask:0xf bank_mask:0x3
v_mfma_f32_16x16x32_bf16 v[36:39], v[152:155], v[164:167], v[36:39]
v_perm_b32 v144, v66, v148, s45
v_perm_b32 v145, v70, v149, s45
v_mfma_f32_16x16x32_bf16 v[52:55], v[156:159], v[164:167], v[52:55]
ds_read_b128 v[164:167], v253 offset:2048
v_perm_b32 v148, v66, v148, s46
v_perm_b32 v149, v70, v149, s46
v_mfma_f32_16x16x32_bf16 v[40:43], v[152:155], v[168:171], v[40:43]
s_waitcnt vmcnt(9)
v_cndmask_b32_dpp v150, v74, v72, vcc row_ror:8 row_mask:0xf bank_mask:0xf
s_waitcnt vmcnt(8)
v_cndmask_b32_dpp v151, v78, v76, vcc row_ror:8 row_mask:0xf bank_mask:0xf
v_mfma_f32_16x16x32_bf16 v[56:59], v[156:159], v[168:171], v[56:59]
ds_read_b128 v[168:171], v254 offset:0
v_mov_b32_dpp v74, v72 row_ror:8 row_mask:0xf bank_mask:0x3
v_mov_b32_dpp v78, v76 row_ror:8 row_mask:0xf bank_mask:0x3
v_mfma_f32_16x16x32_bf16 v[44:47], v[152:155], v[172:175], v[44:47]
v_perm_b32 v146, v74, v150, s45
v_perm_b32 v147, v78, v151, s45
v_mfma_f32_16x16x32_bf16 v[60:63], v[156:159], v[172:175], v[60:63]
ds_read_b128 v[172:175], v254 offset:2048
v_perm_b32 v150, v74, v150, s46
v_perm_b32 v151, v78, v151, s46
s_waitcnt lgkmcnt(3)
v_mfma_f32_16x16x32_bf16 v[0:3], v[144:147], v[160:163], v[0:3]
v_cndmask_b32_dpp v156, v67, v65, vcc row_ror:8 row_mask:0xf bank_mask:0xf
v_cndmask_b32_dpp v157, v71, v69, vcc row_ror:8 row_mask:0xf bank_mask:0xf
s_waitcnt lgkmcnt(2)
v_mfma_f32_16x16x32_bf16 v[4:7], v[144:147], v[164:167], v[4:7]
v_mov_b32_dpp v67, v65 row_ror:8 row_mask:0xf bank_mask:0x3
v_mov_b32_dpp v71, v69 row_ror:8 row_mask:0xf bank_mask:0x3
s_waitcnt lgkmcnt(1)
v_mfma_f32_16x16x32_bf16 v[8:11], v[144:147], v[168:171], v[8:11]
v_perm_b32 v152, v67, v156, s45
v_perm_b32 v153, v71, v157, s45
s_waitcnt lgkmcnt(0)
v_mfma_f32_16x16x32_bf16 v[12:15], v[144:147], v[172:175], v[12:15]
v_perm_b32 v156, v67, v156, s46
v_perm_b32 v157, v71, v157, s46
v_mfma_f32_16x16x32_bf16 v[16:19], v[148:151], v[160:163], v[16:19]
v_cndmask_b32_dpp v158, v75, v73, vcc row_ror:8 row_mask:0xf bank_mask:0xf
v_cndmask_b32_dpp v159, v79, v77, vcc row_ror:8 row_mask:0xf bank_mask:0xf
v_mfma_f32_16x16x32_bf16 v[20:23], v[148:151], v[164:167], v[20:23]
v_mov_b32_dpp v75, v73 row_ror:8 row_mask:0xf bank_mask:0x3
v_mov_b32_dpp v79, v77 row_ror:8 row_mask:0xf bank_mask:0x3
v_mfma_f32_16x16x32_bf16 v[24:27], v[148:151], v[168:171], v[24:27]
v_perm_b32 v154, v75, v158, s45
v_perm_b32 v155, v79, v159, s45
v_mfma_f32_16x16x32_bf16 v[28:31], v[148:151], v[172:175], v[28:31]
v_perm_b32 v158, v75, v158, s46
v_perm_b32 v159, v79, v159, s46
v_mfma_f32_16x16x32_bf16 v[32:35], v[152:155], v[160:163], v[32:35]
s_add_u32 s61, s61, 524288
s_and_b32 s61, s61, 4194303
v_add_u32 v251, s61, v252
buffer_load_dwordx4 v[64:67], v251, s[20:23], 0 offen
buffer_load_dwordx4 v[68:71], v251, s[20:23], s96 offen
buffer_load_dwordx4 v[72:75], v251, s[20:23], s97 offen
buffer_load_dwordx4 v[76:79], v251, s[20:23], s98 offen
s_waitcnt vmcnt(11)
v_cndmask_b32_dpp v148, v82, v80, vcc row_ror:8 row_mask:0xf bank_mask:0xf
s_waitcnt vmcnt(10)
v_cndmask_b32_dpp v149, v86, v84, vcc row_ror:8 row_mask:0xf bank_mask:0xf
v_mfma_f32_16x16x32_bf16 v[48:51], v[156:159], v[160:163], v[48:51]
v_xor_b32 v253, 64, v253
v_xor_b32 v254, 64, v254
ds_read_b128 v[160:163], v253 offset:40960
v_mov_b32_dpp v82, v80 row_ror:8 row_mask:0xf bank_mask:0x3
v_mov_b32_dpp v86, v84 row_ror:8 row_mask:0xf bank_mask:0x3
v_mfma_f32_16x16x32_bf16 v[36:39], v[152:155], v[164:167], v[36:39]
v_perm_b32 v144, v82, v148, s45
v_perm_b32 v145, v86, v149, s45
v_mfma_f32_16x16x32_bf16 v[52:55], v[156:159], v[164:167], v[52:55]
ds_read_b128 v[164:167], v253 offset:43008
v_perm_b32 v148, v82, v148, s46
v_perm_b32 v149, v86, v149, s46
v_mfma_f32_16x16x32_bf16 v[40:43], v[152:155], v[168:171], v[40:43]
s_waitcnt vmcnt(9)
v_cndmask_b32_dpp v150, v90, v88, vcc row_ror:8 row_mask:0xf bank_mask:0xf
s_waitcnt vmcnt(8)
v_cndmask_b32_dpp v151, v94, v92, vcc row_ror:8 row_mask:0xf bank_mask:0xf
v_mfma_f32_16x16x32_bf16 v[56:59], v[156:159], v[168:171], v[56:59]
ds_read_b128 v[168:171], v254 offset:40960
v_mov_b32_dpp v90, v88 row_ror:8 row_mask:0xf bank_mask:0x3
v_mov_b32_dpp v94, v92 row_ror:8 row_mask:0xf bank_mask:0x3
v_mfma_f32_16x16x32_bf16 v[44:47], v[152:155], v[172:175], v[44:47]
v_perm_b32 v146, v90, v150, s45
v_perm_b32 v147, v94, v151, s45
v_mfma_f32_16x16x32_bf16 v[60:63], v[156:159], v[172:175], v[60:63]
ds_read_b128 v[172:175], v254 offset:43008
v_perm_b32 v150, v90, v150, s46
v_perm_b32 v151, v94, v151, s46
s_waitcnt lgkmcnt(3)
v_mfma_f32_16x16x32_bf16 v[0:3], v[144:147], v[160:163], v[0:3]
v_cndmask_b32_dpp v156, v83, v81, vcc row_ror:8 row_mask:0xf bank_mask:0xf
v_cndmask_b32_dpp v157, v87, v85, vcc row_ror:8 row_mask:0xf bank_mask:0xf
s_waitcnt lgkmcnt(2)
v_mfma_f32_16x16x32_bf16 v[4:7], v[144:147], v[164:167], v[4:7]
v_mov_b32_dpp v83, v81 row_ror:8 row_mask:0xf bank_mask:0x3
v_mov_b32_dpp v87, v85 row_ror:8 row_mask:0xf bank_mask:0x3
s_waitcnt lgkmcnt(1)
v_mfma_f32_16x16x32_bf16 v[8:11], v[144:147], v[168:171], v[8:11]
v_perm_b32 v152, v83, v156, s45
v_perm_b32 v153, v87, v157, s45
s_waitcnt lgkmcnt(0)
v_mfma_f32_16x16x32_bf16 v[12:15], v[144:147], v[172:175], v[12:15]
v_perm_b32 v156, v83, v156, s46
v_perm_b32 v157, v87, v157, s46
v_mfma_f32_16x16x32_bf16 v[16:19], v[148:151], v[160:163], v[16:19]
v_cndmask_b32_dpp v158, v91, v89, vcc row_ror:8 row_mask:0xf bank_mask:0xf
v_cndmask_b32_dpp v159, v95, v93, vcc row_ror:8 row_mask:0xf bank_mask:0xf
v_mfma_f32_16x16x32_bf16 v[20:23], v[148:151], v[164:167], v[20:23]
v_mov_b32_dpp v91, v89 row_ror:8 row_mask:0xf bank_mask:0x3
v_mov_b32_dpp v95, v93 row_ror:8 row_mask:0xf bank_mask:0x3
v_mfma_f32_16x16x32_bf16 v[24:27], v[148:151], v[168:171], v[24:27]
v_perm_b32 v154, v91, v158, s45
v_perm_b32 v155, v95, v159, s45
v_mfma_f32_16x16x32_bf16 v[28:31], v[148:151], v[172:175], v[28:31]
v_perm_b32 v158, v91, v158, s46
v_perm_b32 v159, v95, v159, s46
v_mfma_f32_16x16x32_bf16 v[32:35], v[152:155], v[160:163], v[32:35]
v_xor_b32 v251, 262144, v251
buffer_load_dwordx4 v[80:83], v251, s[20:23], 0 offen
buffer_load_dwordx4 v[84:87], v251, s[20:23], s96 offen
buffer_load_dwordx4 v[88:91], v251, s[20:23], s97 offen
buffer_load_dwordx4 v[92:95], v251, s[20:23], s98 offen
s_waitcnt vmcnt(11)
v_cndmask_b32_dpp v148, v98, v96, vcc row_ror:8 row_mask:0xf bank_mask:0xf
s_waitcnt vmcnt(10)
v_cndmask_b32_dpp v149, v102, v100, vcc row_ror:8 row_mask:0xf bank_mask:0xf
v_mfma_f32_16x16x32_bf16 v[48:51], v[156:159], v[160:163], v[48:51]
v_xor_b32 v253, 64, v253
v_xor_b32 v254, 64, v254
ds_read_b128 v[160:163], v253 offset:40960
v_mov_b32_dpp v98, v96 row_ror:8 row_mask:0xf bank_mask:0x3
v_mov_b32_dpp v102, v100 row_ror:8 row_mask:0xf bank_mask:0x3
v_mfma_f32_16x16x32_bf16 v[36:39], v[152:155], v[164:167], v[36:39]
v_perm_b32 v144, v98, v148, s45
v_perm_b32 v145, v102, v149, s45
v_mfma_f32_16x16x32_bf16 v[52:55], v[156:159], v[164:167], v[52:55]
ds_read_b128 v[164:167], v253 offset:43008
v_perm_b32 v148, v98, v148, s46
v_perm_b32 v149, v102, v149, s46
v_mfma_f32_16x16x32_bf16 v[40:43], v[152:155], v[168:171], v[40:43]
s_waitcnt vmcnt(9)
v_cndmask_b32_dpp v150, v106, v104, vcc row_ror:8 row_mask:0xf bank_mask:0xf
s_waitcnt vmcnt(8)
v_cndmask_b32_dpp v151, v110, v108, vcc row_ror:8 row_mask:0xf bank_mask:0xf
v_mfma_f32_16x16x32_bf16 v[56:59], v[156:159], v[168:171], v[56:59]
ds_read_b128 v[168:171], v254 offset:40960
v_mov_b32_dpp v106, v104 row_ror:8 row_mask:0xf bank_mask:0x3
v_mov_b32_dpp v110, v108 row_ror:8 row_mask:0xf bank_mask:0x3
v_mfma_f32_16x16x32_bf16 v[44:47], v[152:155], v[172:175], v[44:47]
v_perm_b32 v146, v106, v150, s45
v_perm_b32 v147, v110, v151, s45
v_mfma_f32_16x16x32_bf16 v[60:63], v[156:159], v[172:175], v[60:63]
ds_read_b128 v[172:175], v254 offset:43008
v_perm_b32 v150, v106, v150, s46
v_perm_b32 v151, v110, v151, s46
s_waitcnt lgkmcnt(3)
v_mfma_f32_16x16x32_bf16 v[0:3], v[144:147], v[160:163], v[0:3]
v_cndmask_b32_dpp v156, v99, v97, vcc row_ror:8 row_mask:0xf bank_mask:0xf
v_cndmask_b32_dpp v157, v103, v101, vcc row_ror:8 row_mask:0xf bank_mask:0xf
s_waitcnt lgkmcnt(2)
v_mfma_f32_16x16x32_bf16 v[4:7], v[144:147], v[164:167], v[4:7]
v_mov_b32_dpp v99, v97 row_ror:8 row_mask:0xf bank_mask:0x3
v_mov_b32_dpp v103, v101 row_ror:8 row_mask:0xf bank_mask:0x3
s_waitcnt lgkmcnt(1)
v_mfma_f32_16x16x32_bf16 v[8:11], v[144:147], v[168:171], v[8:11]
v_perm_b32 v152, v99, v156, s45
v_perm_b32 v153, v103, v157, s45
s_waitcnt lgkmcnt(0)
v_mfma_f32_16x16x32_bf16 v[12:15], v[144:147], v[172:175], v[12:15]
v_perm_b32 v156, v99, v156, s46
v_perm_b32 v157, v103, v157, s46
v_mfma_f32_16x16x32_bf16 v[16:19], v[148:151], v[160:163], v[16:19]
v_cndmask_b32_dpp v158, v107, v105, vcc row_ror:8 row_mask:0xf bank_mask:0xf
v_cndmask_b32_dpp v159, v111, v109, vcc row_ror:8 row_mask:0xf bank_mask:0xf
v_mfma_f32_16x16x32_bf16 v[20:23], v[148:151], v[164:167], v[20:23]
v_mov_b32_dpp v107, v105 row_ror:8 row_mask:0xf bank_mask:0x3
v_mov_b32_dpp v111, v109 row_ror:8 row_mask:0xf bank_mask:0x3
v_mfma_f32_16x16x32_bf16 v[24:27], v[148:151], v[168:171], v[24:27]
v_perm_b32 v154, v107, v158, s45
v_perm_b32 v155, v111, v159, s45
v_mfma_f32_16x16x32_bf16 v[28:31], v[148:151], v[172:175], v[28:31]
v_perm_b32 v158, v107, v158, s46
v_perm_b32 v159, v111, v159, s46
v_mfma_f32_16x16x32_bf16 v[32:35], v[152:155], v[160:163], v[32:35]
s_add_u32 s61, s61, 524288
s_and_b32 s61, s61, 4194303
v_add_u32 v251, s61, v252
buffer_load_dwordx4 v[96:99], v251, s[20:23], 0 offen
buffer_load_dwordx4 v[100:103], v251, s[20:23], s96 offen
buffer_load_dwordx4 v[104:107], v251, s[20:23], s97 offen
buffer_load_dwordx4 v[108:111], v251, s[20:23], s98 offen
s_waitcnt vmcnt(11)
v_cndmask_b32_dpp v148, v66, v64, vcc row_ror:8 row_mask:0xf bank_mask:0xf
s_waitcnt vmcnt(10)
v_cndmask_b32_dpp v149, v70, v68, vcc row_ror:8 row_mask:0xf bank_mask:0xf
v_mfma_f32_16x16x32_bf16 v[48:51], v[156:159], v[160:163], v[48:51]
v_xor_b32 v253, 64, v253
v_add_u32 v253, 81920, v253
v_xor_b32 v254, 64, v254
v_add_u32 v254, 81920, v254
ds_read_b128 v[160:163], v253 offset:0
v_mov_b32_dpp v66, v64 row_ror:8 row_mask:0xf bank_mask:0x3
v_mov_b32_dpp v70, v68 row_ror:8 row_mask:0xf bank_mask:0x3
v_mfma_f32_16x16x32_bf16 v[36:39], v[152:155], v[164:167], v[36:39]
v_perm_b32 v144, v66, v148, s45
v_perm_b32 v145, v70, v149, s45
v_mfma_f32_16x16x32_bf16 v[52:55], v[156:159], v[164:167], v[52:55]
ds_read_b128 v[164:167], v253 offset:2048
v_perm_b32 v148, v66, v148, s46
v_perm_b32 v149, v70, v149, s46
v_mfma_f32_16x16x32_bf16 v[40:43], v[152:155], v[168:171], v[40:43]
s_waitcnt vmcnt(9)
v_cndmask_b32_dpp v150, v74, v72, vcc row_ror:8 row_mask:0xf bank_mask:0xf
s_waitcnt vmcnt(8)
v_cndmask_b32_dpp v151, v78, v76, vcc row_ror:8 row_mask:0xf bank_mask:0xf
v_mfma_f32_16x16x32_bf16 v[56:59], v[156:159], v[168:171], v[56:59]
ds_read_b128 v[168:171], v254 offset:0
v_mov_b32_dpp v74, v72 row_ror:8 row_mask:0xf bank_mask:0x3
v_mov_b32_dpp v78, v76 row_ror:8 row_mask:0xf bank_mask:0x3
v_mfma_f32_16x16x32_bf16 v[44:47], v[152:155], v[172:175], v[44:47]
v_perm_b32 v146, v74, v150, s45
v_perm_b32 v147, v78, v151, s45
v_mfma_f32_16x16x32_bf16 v[60:63], v[156:159], v[172:175], v[60:63]
ds_read_b128 v[172:175], v254 offset:2048
v_perm_b32 v150, v74, v150, s46
v_perm_b32 v151, v78, v151, s46
s_waitcnt lgkmcnt(3)
v_mfma_f32_16x16x32_bf16 v[0:3], v[144:147], v[160:163], v[0:3]
v_cndmask_b32_dpp v156, v67, v65, vcc row_ror:8 row_mask:0xf bank_mask:0xf
v_cndmask_b32_dpp v157, v71, v69, vcc row_ror:8 row_mask:0xf bank_mask:0xf
s_waitcnt lgkmcnt(2)
v_mfma_f32_16x16x32_bf16 v[4:7], v[144:147], v[164:167], v[4:7]
v_mov_b32_dpp v67, v65 row_ror:8 row_mask:0xf bank_mask:0x3
v_mov_b32_dpp v71, v69 row_ror:8 row_mask:0xf bank_mask:0x3
s_waitcnt lgkmcnt(1)
v_mfma_f32_16x16x32_bf16 v[8:11], v[144:147], v[168:171], v[8:11]
v_perm_b32 v152, v67, v156, s45
v_perm_b32 v153, v71, v157, s45
s_waitcnt lgkmcnt(0)
v_mfma_f32_16x16x32_bf16 v[12:15], v[144:147], v[172:175], v[12:15]
v_perm_b32 v156, v67, v156, s46
v_perm_b32 v157, v71, v157, s46
v_mfma_f32_16x16x32_bf16 v[16:19], v[148:151], v[160:163], v[16:19]
v_cndmask_b32_dpp v158, v75, v73, vcc row_ror:8 row_mask:0xf bank_mask:0xf
v_cndmask_b32_dpp v159, v79, v77, vcc row_ror:8 row_mask:0xf bank_mask:0xf
v_mfma_f32_16x16x32_bf16 v[20:23], v[148:151], v[164:167], v[20:23]
v_mov_b32_dpp v75, v73 row_ror:8 row_mask:0xf bank_mask:0x3
v_mov_b32_dpp v79, v77 row_ror:8 row_mask:0xf bank_mask:0x3
v_mfma_f32_16x16x32_bf16 v[24:27], v[148:151], v[168:171], v[24:27]
v_perm_b32 v154, v75, v158, s45
v_perm_b32 v155, v79, v159, s45
v_mfma_f32_16x16x32_bf16 v[28:31], v[148:151], v[172:175], v[28:31]
v_perm_b32 v158, v75, v158, s46
v_perm_b32 v159, v79, v159, s46
v_mfma_f32_16x16x32_bf16 v[32:35], v[152:155], v[160:163], v[32:35]
v_xor_b32 v251, 262144, v251
buffer_load_dwordx4 v[64:67], v251, s[20:23], 0 offen
buffer_load_dwordx4 v[68:71], v251, s[20:23], s96 offen
buffer_load_dwordx4 v[72:75], v251, s[20:23], s97 offen
buffer_load_dwordx4 v[76:79], v251, s[20:23], s98 offen
s_waitcnt vmcnt(11)
v_cndmask_b32_dpp v148, v82, v80, vcc row_ror:8 row_mask:0xf bank_mask:0xf
s_waitcnt vmcnt(10)
v_cndmask_b32_dpp v149, v86, v84, vcc row_ror:8 row_mask:0xf bank_mask:0xf
v_mfma_f32_16x16x32_bf16 v[48:51], v[156:159], v[160:163], v[48:51]
v_xor_b32 v253, 64, v253
v_xor_b32 v254, 64, v254
ds_read_b128 v[160:163], v253 offset:0
v_mov_b32_dpp v82, v80 row_ror:8 row_mask:0xf bank_mask:0x3
v_mov_b32_dpp v86, v84 row_ror:8 row_mask:0xf bank_mask:0x3
v_mfma_f32_16x16x32_bf16 v[36:39], v[152:155], v[164:167], v[36:39]
v_perm_b32 v144, v82, v148, s45
v_perm_b32 v145, v86, v149, s45
v_mfma_f32_16x16x32_bf16 v[52:55], v[156:159], v[164:167], v[52:55]
ds_read_b128 v[164:167], v253 offset:2048
v_perm_b32 v148, v82, v148, s46
v_perm_b32 v149, v86, v149, s46
v_mfma_f32_16x16x32_bf16 v[40:43], v[152:155], v[168:171], v[40:43]
s_waitcnt vmcnt(9)
v_cndmask_b32_dpp v150, v90, v88, vcc row_ror:8 row_mask:0xf bank_mask:0xf
s_waitcnt vmcnt(8)
v_cndmask_b32_dpp v151, v94, v92, vcc row_ror:8 row_mask:0xf bank_mask:0xf
v_mfma_f32_16x16x32_bf16 v[56:59], v[156:159], v[168:171], v[56:59]
ds_read_b128 v[168:171], v254 offset:0
v_mov_b32_dpp v90, v88 row_ror:8 row_mask:0xf bank_mask:0x3
v_mov_b32_dpp v94, v92 row_ror:8 row_mask:0xf bank_mask:0x3
v_mfma_f32_16x16x32_bf16 v[44:47], v[152:155], v[172:175], v[44:47]
v_perm_b32 v146, v90, v150, s45
v_perm_b32 v147, v94, v151, s45
v_mfma_f32_16x16x32_bf16 v[60:63], v[156:159], v[172:175], v[60:63]
ds_read_b128 v[172:175], v254 offset:2048
v_perm_b32 v150, v90, v150, s46
v_perm_b32 v151, v94, v151, s46
s_add_u32 s54, s5, 0
s_and_b32 s54, s54, 0x1ffff
s_add_u32 m0, s50, 0
s_nop 0
buffer_load_dwordx4 v249, s[12:15], s54 offen nt lds
s_or_b32 s54, s54, 0x100000
s_add_u32 m0, s50, 40960
s_nop 0
buffer_load_dwordx4 v249, s[12:15], s54 offen nt lds
s_add_u32 s54, s5, 8192
s_and_b32 s54, s54, 0x1ffff
s_add_u32 m0, s50, 8192
s_nop 0
buffer_load_dwordx4 v249, s[12:15], s54 offen nt lds
s_or_b32 s54, s54, 0x100000
s_add_u32 m0, s50, 49152
s_nop 0
buffer_load_dwordx4 v249, s[12:15], s54 offen nt lds
s_add_u32 s54, s5, 0
s_and_b32 s54, s54, 0x1ffff
s_add_u32 m0, s50, 81920
s_nop 0
buffer_load_dwordx4 v250, s[16:19], s54 offen nt lds
s_or_b32 s54, s54, 0x100000
s_add_u32 m0, s50, 122880
s_nop 0
buffer_load_dwordx4 v250, s[16:19], s54 offen nt lds
s_add_u32 s54, s5, 16384
s_and_b32 s54, s54, 0x1ffff
s_add_u32 m0, s50, 16384
s_nop 0
buffer_load_dwordx4 v249, s[12:15], s54 offen nt lds
s_or_b32 s54, s54, 0x100000
s_add_u32 m0, s50, 57344
s_nop 0
buffer_load_dwordx4 v249, s[12:15], s54 offen nt lds
s_waitcnt lgkmcnt(3)
v_mfma_f32_16x16x32_bf16 v[0:3], v[144:147], v[160:163], v[0:3]
v_cndmask_b32_dpp v156, v83, v81, vcc row_ror:8 row_mask:0xf bank_mask:0xf
v_cndmask_b32_dpp v157, v87, v85, vcc row_ror:8 row_mask:0xf bank_mask:0xf
s_waitcnt lgkmcnt(2)
v_mfma_f32_16x16x32_bf16 v[4:7], v[144:147], v[164:167], v[4:7]
v_mov_b32_dpp v83, v81 row_ror:8 row_mask:0xf bank_mask:0x3
v_mov_b32_dpp v87, v85 row_ror:8 row_mask:0xf bank_mask:0x3
s_waitcnt lgkmcnt(1)
v_mfma_f32_16x16x32_bf16 v[8:11], v[144:147], v[168:171], v[8:11]
v_perm_b32 v152, v83, v156, s45
v_perm_b32 v153, v87, v157, s45
s_waitcnt lgkmcnt(0)
v_mfma_f32_16x16x32_bf16 v[12:15], v[144:147], v[172:175], v[12:15]
v_perm_b32 v156, v83, v156, s46
v_perm_b32 v157, v87, v157, s46
v_mfma_f32_16x16x32_bf16 v[16:19], v[148:151], v[160:163], v[16:19]
v_cndmask_b32_dpp v158, v91, v89, vcc row_ror:8 row_mask:0xf bank_mask:0xf
v_cndmask_b32_dpp v159, v95, v93, vcc row_ror:8 row_mask:0xf bank_mask:0xf
v_mfma_f32_16x16x32_bf16 v[20:23], v[148:151], v[164:167], v[20:23]
v_mov_b32_dpp v91, v89 row_ror:8 row_mask:0xf bank_mask:0x3
v_mov_b32_dpp v95, v93 row_ror:8 row_mask:0xf bank_mask:0x3
v_mfma_f32_16x16x32_bf16 v[24:27], v[148:151], v[168:171], v[24:27]
v_perm_b32 v154, v91, v158, s45
v_perm_b32 v155, v95, v159, s45
v_mfma_f32_16x16x32_bf16 v[28:31], v[148:151], v[172:175], v[28:31]
v_perm_b32 v158, v91, v158, s46
v_perm_b32 v159, v95, v159, s46
v_mfma_f32_16x16x32_bf16 v[32:35], v[152:155], v[160:163], v[32:35]
s_waitcnt vmcnt(15)
v_cndmask_b32_dpp v148, v98, v96, vcc row_ror:8 row_mask:0xf bank_mask:0xf
s_waitcnt vmcnt(14)
v_cndmask_b32_dpp v149, v102, v100, vcc row_ror:8 row_mask:0xf bank_mask:0xf
v_mfma_f32_16x16x32_bf16 v[48:51], v[156:159], v[160:163], v[48:51]
v_xor_b32 v253, 64, v253
v_xor_b32 v254, 64, v254
ds_read_b128 v[160:163], v253 offset:40960
v_mov_b32_dpp v98, v96 row_ror:8 row_mask:0xf bank_mask:0x3
v_mov_b32_dpp v102, v100 row_ror:8 row_mask:0xf bank_mask:0x3
v_mfma_f32_16x16x32_bf16 v[36:39], v[152:155], v[164:167], v[36:39]
v_perm_b32 v144, v98, v148, s45
v_perm_b32 v145, v102, v149, s45
v_mfma_f32_16x16x32_bf16 v[52:55], v[156:159], v[164:167], v[52:55]
ds_read_b128 v[164:167], v253 offset:43008
v_perm_b32 v148, v98, v148, s46
v_perm_b32 v149, v102, v149, s46
v_mfma_f32_16x16x32_bf16 v[40:43], v[152:155], v[168:171], v[40:43]
s_waitcnt vmcnt(13)
v_cndmask_b32_dpp v150, v106, v104, vcc row_ror:8 row_mask:0xf bank_mask:0xf
s_waitcnt vmcnt(12)
v_cndmask_b32_dpp v151, v110, v108, vcc row_ror:8 row_mask:0xf bank_mask:0xf
v_mfma_f32_16x16x32_bf16 v[56:59], v[156:159], v[168:171], v[56:59]
ds_read_b128 v[168:171], v254 offset:40960
v_mov_b32_dpp v106, v104 row_ror:8 row_mask:0xf bank_mask:0x3
v_mov_b32_dpp v110, v108 row_ror:8 row_mask:0xf bank_mask:0x3
v_mfma_f32_16x16x32_bf16 v[44:47], v[152:155], v[172:175], v[44:47]
v_perm_b32 v146, v106, v150, s45
v_perm_b32 v147, v110, v151, s45
v_mfma_f32_16x16x32_bf16 v[60:63], v[156:159], v[172:175], v[60:63]
ds_read_b128 v[172:175], v254 offset:43008
v_perm_b32 v150, v106, v150, s46
v_perm_b32 v151, v110, v151, s46
s_add_u32 s54, s5, 8192
s_and_b32 s54, s54, 0x1ffff
s_add_u32 m0, s50, 90112
s_nop 0
buffer_load_dwordx4 v250, s[16:19], s54 offen nt lds
s_or_b32 s54, s54, 0x100000
s_add_u32 m0, s50, 131072
s_nop 0
buffer_load_dwordx4 v250, s[16:19], s54 offen nt lds
s_add_u32 s54, s5, 24576
s_and_b32 s54, s54, 0x1ffff
s_add_u32 m0, s50, 24576
s_nop 0
buffer_load_dwordx4 v249, s[12:15], s54 offen nt lds
s_or_b32 s54, s54, 0x100000
s_add_u32 m0, s50, 65536
s_nop 0
buffer_load_dwordx4 v249, s[12:15], s54 offen nt lds
s_waitcnt lgkmcnt(3)
v_mfma_f32_16x16x32_bf16 v[0:3], v[144:147], v[160:163], v[0:3]
v_cndmask_b32_dpp v156, v99, v97, vcc row_ror:8 row_mask:0xf bank_mask:0xf
v_cndmask_b32_dpp v157, v103, v101, vcc row_ror:8 row_mask:0xf bank_mask:0xf
s_waitcnt lgkmcnt(2)
v_mfma_f32_16x16x32_bf16 v[4:7], v[144:147], v[164:167], v[4:7]
v_mov_b32_dpp v99, v97 row_ror:8 row_mask:0xf bank_mask:0x3
v_mov_b32_dpp v103, v101 row_ror:8 row_mask:0xf bank_mask:0x3
s_waitcnt lgkmcnt(1)
v_mfma_f32_16x16x32_bf16 v[8:11], v[144:147], v[168:171], v[8:11]
v_perm_b32 v152, v99, v156, s45
v_perm_b32 v153, v103, v157, s45
s_waitcnt lgkmcnt(0)
v_mfma_f32_16x16x32_bf16 v[12:15], v[144:147], v[172:175], v[12:15]
v_perm_b32 v156, v99, v156, s46
v_perm_b32 v157, v103, v157, s46
v_mfma_f32_16x16x32_bf16 v[16:19], v[148:151], v[160:163], v[16:19]
v_cndmask_b32_dpp v158, v107, v105, vcc row_ror:8 row_mask:0xf bank_mask:0xf
v_cndmask_b32_dpp v159, v111, v109, vcc row_ror:8 row_mask:0xf bank_mask:0xf
v_mfma_f32_16x16x32_bf16 v[20:23], v[148:151], v[164:167], v[20:23]
v_mov_b32_dpp v107, v105 row_ror:8 row_mask:0xf bank_mask:0x3
v_mov_b32_dpp v111, v109 row_ror:8 row_mask:0xf bank_mask:0x3
v_mfma_f32_16x16x32_bf16 v[24:27], v[148:151], v[168:171], v[24:27]
v_perm_b32 v154, v107, v158, s45
v_perm_b32 v155, v111, v159, s45
v_mfma_f32_16x16x32_bf16 v[28:31], v[148:151], v[172:175], v[28:31]
v_perm_b32 v158, v107, v158, s46
v_perm_b32 v159, v111, v159, s46
v_mfma_f32_16x16x32_bf16 v[32:35], v[152:155], v[160:163], v[32:35]
s_waitcnt vmcnt(15)
v_cndmask_b32_dpp v148, v66, v64, vcc row_ror:8 row_mask:0xf bank_mask:0xf
s_waitcnt vmcnt(14)
v_cndmask_b32_dpp v149, v70, v68, vcc row_ror:8 row_mask:0xf bank_mask:0xf
v_mfma_f32_16x16x32_bf16 v[48:51], v[156:159], v[160:163], v[48:51]
v_xor_b32 v253, 64, v253
v_xor_b32 v254, 64, v254
ds_read_b128 v[160:163], v253 offset:40960
v_mov_b32_dpp v66, v64 row_ror:8 row_mask:0xf bank_mask:0x3
v_mov_b32_dpp v70, v68 row_ror:8 row_mask:0xf bank_mask:0x3
v_mfma_f32_16x16x32_bf16 v[36:39], v[152:155], v[164:167], v[36:39]
v_perm_b32 v144, v66, v148, s45
v_perm_b32 v145, v70, v149, s45
v_mfma_f32_16x16x32_bf16 v[52:55], v[156:159], v[164:167], v[52:55]
ds_read_b128 v[164:167], v253 offset:43008
v_perm_b32 v148, v66, v148, s46
v_perm_b32 v149, v70, v149, s46
v_mfma_f32_16x16x32_bf16 v[40:43], v[152:155], v[168:171], v[40:43]
s_waitcnt vmcnt(13)
v_cndmask_b32_dpp v150, v74, v72, vcc row_ror:8 row_mask:0xf bank_mask:0xf
s_waitcnt vmcnt(12)
v_cndmask_b32_dpp v151, v78, v76, vcc row_ror:8 row_mask:0xf bank_mask:0xf
v_mfma_f32_16x16x32_bf16 v[56:59], v[156:159], v[168:171], v[56:59]
ds_read_b128 v[168:171], v254 offset:40960
v_mov_b32_dpp v74, v72 row_ror:8 row_mask:0xf bank_mask:0x3
v_mov_b32_dpp v78, v76 row_ror:8 row_mask:0xf bank_mask:0x3
v_mfma_f32_16x16x32_bf16 v[44:47], v[152:155], v[172:175], v[44:47]
v_perm_b32 v146, v74, v150, s45
v_perm_b32 v147, v78, v151, s45
v_mfma_f32_16x16x32_bf16 v[60:63], v[156:159], v[172:175], v[60:63]
ds_read_b128 v[172:175], v254 offset:43008
v_perm_b32 v150, v74, v150, s46
v_perm_b32 v151, v78, v151, s46
s_add_u32 s54, s5, 16384
s_and_b32 s54, s54, 0x1ffff
s_add_u32 m0, s50, 98304
s_nop 0
buffer_load_dwordx4 v250, s[16:19], s54 offen nt lds
s_or_b32 s54, s54, 0x100000
s_add_u32 m0, s50, 139264
s_nop 0
buffer_load_dwordx4 v250, s[16:19], s54 offen nt lds
s_add_u32 s54, s5, 24576
s_and_b32 s54, s54, 0x1ffff
s_add_u32 m0, s50, 106496
s_nop 0
buffer_load_dwordx4 v250, s[16:19], s54 offen nt lds
s_or_b32 s54, s54, 0x100000
s_add_u32 m0, s50, 147456
s_nop 0
buffer_load_dwordx4 v250, s[16:19], s54 offen nt lds
s_waitcnt lgkmcnt(3)
v_mfma_f32_16x16x32_bf16 v[0:3], v[144:147], v[160:163], v[0:3]
v_cndmask_b32_dpp v156, v67, v65, vcc row_ror:8 row_mask:0xf bank_mask:0xf
v_cndmask_b32_dpp v157, v71, v69, vcc row_ror:8 row_mask:0xf bank_mask:0xf
s_waitcnt lgkmcnt(2)
v_mfma_f32_16x16x32_bf16 v[4:7], v[144:147], v[164:167], v[4:7]
v_mov_b32_dpp v67, v65 row_ror:8 row_mask:0xf bank_mask:0x3
v_mov_b32_dpp v71, v69 row_ror:8 row_mask:0xf bank_mask:0x3
s_waitcnt lgkmcnt(1)
v_mfma_f32_16x16x32_bf16 v[8:11], v[144:147], v[168:171], v[8:11]
v_perm_b32 v152, v67, v156, s45
v_perm_b32 v153, v71, v157, s45
s_waitcnt lgkmcnt(0)
v_mfma_f32_16x16x32_bf16 v[12:15], v[144:147], v[172:175], v[12:15]
v_perm_b32 v156, v67, v156, s46
v_perm_b32 v157, v71, v157, s46
v_mfma_f32_16x16x32_bf16 v[16:19], v[148:151], v[160:163], v[16:19]
v_cndmask_b32_dpp v158, v75, v73, vcc row_ror:8 row_mask:0xf bank_mask:0xf
v_cndmask_b32_dpp v159, v79, v77, vcc row_ror:8 row_mask:0xf bank_mask:0xf
v_mfma_f32_16x16x32_bf16 v[20:23], v[148:151], v[164:167], v[20:23]
v_mov_b32_dpp v75, v73 row_ror:8 row_mask:0xf bank_mask:0x3
v_mov_b32_dpp v79, v77 row_ror:8 row_mask:0xf bank_mask:0x3
v_mfma_f32_16x16x32_bf16 v[24:27], v[148:151], v[168:171], v[24:27]
v_perm_b32 v154, v75, v158, s45
v_perm_b32 v155, v79, v159, s45
v_mfma_f32_16x16x32_bf16 v[28:31], v[148:151], v[172:175], v[28:31]
v_perm_b32 v158, v75, v158, s46
v_perm_b32 v159, v79, v159, s46
v_mfma_f32_16x16x32_bf16 v[32:35], v[152:155], v[160:163], v[32:35]
s_nop 0
v_mfma_f32_16x16x32_bf16 v[48:51], v[156:159], v[160:163], v[48:51]
v_mfma_f32_16x16x32_bf16 v[36:39], v[152:155], v[164:167], v[36:39]
v_mfma_f32_16x16x32_bf16 v[52:55], v[156:159], v[164:167], v[52:55]
v_mfma_f32_16x16x32_bf16 v[40:43], v[152:155], v[168:171], v[40:43]
v_mfma_f32_16x16x32_bf16 v[56:59], v[156:159], v[168:171], v[56:59]
v_mfma_f32_16x16x32_bf16 v[44:47], v[152:155], v[172:175], v[44:47]
v_mfma_f32_16x16x32_bf16 v[60:63], v[156:159], v[172:175], v[60:63]
s_add_u32 s54, s5, 32768
s_and_b32 s54, s54, 0x1ffff
buffer_load_dwordx4 v[176:179], v249, s[12:15], s54 offen nt
s_or_b32 s54, s54, 0x100000
buffer_load_dwordx4 v[180:183], v249, s[12:15], s54 offen nt
s_add_u32 s54, s5, 40960
s_and_b32 s54, s54, 0x1ffff
buffer_load_dwordx4 v[184:187], v249, s[12:15], s54 offen nt
s_or_b32 s54, s54, 0x100000
buffer_load_dwordx4 v[188:191], v249, s[12:15], s54 offen nt
s_and_b32 s52, s40, 3
s_mul_i32 s52, s52, 40960
s_lshl_b32 s53, s47, 12
s_add_u32 s52, s52, s53
v_lshl_add_u32 v253, v255, 4, s52
v_xor_b32 v254, 0x1000, v253
v_pk_mul_f32 v[8:9], v[8:9], s[6:7]
v_pk_mul_f32 v[10:11], v[10:11], s[6:7]
v_pk_mul_f32 v[24:25], v[24:25], s[6:7]
v_pk_mul_f32 v[26:27], v[26:27], s[6:7]
v_pk_mul_f32 v[40:41], v[40:41], s[6:7]
v_pk_mul_f32 v[42:43], v[42:43], s[6:7]
v_pk_mul_f32 v[56:57], v[56:57], s[6:7]
v_pk_mul_f32 v[58:59], v[58:59], s[6:7]
v_cvt_pk_bf16_f32 v64, v8, v24
v_cvt_pk_bf16_f32 v65, v40, v56
v_cvt_pk_bf16_f32 v66, v9, v25
v_cvt_pk_bf16_f32 v67, v41, v57
v_cvt_pk_bf16_f32 v68, v10, v26
v_cvt_pk_bf16_f32 v69, v42, v58
v_cvt_pk_bf16_f32 v70, v11, v27
v_cvt_pk_bf16_f32 v71, v43, v59
v_pk_mul_f32 v[12:13], v[12:13], s[6:7]
v_pk_mul_f32 v[14:15], v[14:15], s[6:7]
v_pk_mul_f32 v[28:29], v[28:29], s[6:7]
v_pk_mul_f32 v[30:31], v[30:31], s[6:7]
v_pk_mul_f32 v[44:45], v[44:45], s[6:7]
v_pk_mul_f32 v[46:47], v[46:47], s[6:7]
v_pk_mul_f32 v[60:61], v[60:61], s[6:7]
v_pk_mul_f32 v[62:63], v[62:63], s[6:7]
v_cvt_pk_bf16_f32 v72, v12, v28
v_cvt_pk_bf16_f32 v73, v44, v60
v_cvt_pk_bf16_f32 v74, v13, v29
v_cvt_pk_bf16_f32 v75, v45, v61
v_cvt_pk_bf16_f32 v76, v14, v30
v_cvt_pk_bf16_f32 v77, v46, v62
v_cvt_pk_bf16_f32 v78, v15, v31
v_cvt_pk_bf16_f32 v79, v47, v63
v_permlane32_swap_b32 v64, v66
v_permlane32_swap_b32 v65, v67
v_permlane32_swap_b32 v68, v70
v_permlane32_swap_b32 v69, v71
v_permlane32_swap_b32 v72, v74
v_permlane32_swap_b32 v73, v75
v_permlane32_swap_b32 v76, v78
v_permlane32_swap_b32 v77, v79
v_permlane16_swap_b32 v64, v72
v_permlane16_swap_b32 v65, v73
v_permlane16_swap_b32 v66, v74
v_permlane16_swap_b32 v67, v75
v_permlane16_swap_b32 v68, v76
v_permlane16_swap_b32 v69, v77
v_permlane16_swap_b32 v70, v78
v_permlane16_swap_b32 v71, v79
s_barrier
ds_write_b128 v253, v[64:67] offset:32768
ds_write_b128 v253, v[68:71] offset:33792
ds_write_b128 v253, v[72:75] offset:34816
ds_write_b128 v253, v[76:79] offset:35840
s_lshl_b32 s52, s51, 2
s_add_u32 s52, s52, s50
v_lshl_add_u32 v234, v255, 8, s52
v_mov_b32 v235, 1
buffer_atomic_add v235, v234, s[36:39], 0 offen sc1
s_add_u32 s54, s5, 32768
s_and_b32 s54, s54, 0x1ffff
buffer_load_dwordx4 v[192:195], v250, s[16:19], s54 offen nt
s_or_b32 s54, s54, 0x100000
buffer_load_dwordx4 v[196:199], v250, s[16:19], s54 offen nt
s_add_u32 s54, s5, 49152
s_and_b32 s54, s54, 0x1ffff
buffer_load_dwordx4 v[200:203], v249, s[12:15], s54 offen nt
s_or_b32 s54, s54, 0x100000
buffer_load_dwordx4 v[204:207], v249, s[12:15], s54 offen nt
v_pk_mul_f32 v[0:1], v[0:1], s[6:7]
v_pk_mul_f32 v[2:3], v[2:3], s[6:7]
v_pk_mul_f32 v[16:17], v[16:17], s[6:7]
v_pk_mul_f32 v[18:19], v[18:19], s[6:7]
v_pk_mul_f32 v[32:33], v[32:33], s[6:7]
v_pk_mul_f32 v[34:35], v[34:35], s[6:7]
v_pk_mul_f32 v[48:49], v[48:49], s[6:7]
v_pk_mul_f32 v[50:51], v[50:51], s[6:7]
v_cvt_pk_bf16_f32 v128, v0, v16
v_cvt_pk_bf16_f32 v129, v32, v48
v_cvt_pk_bf16_f32 v130, v1, v17
v_cvt_pk_bf16_f32 v131, v33, v49
v_cvt_pk_bf16_f32 v132, v2, v18
v_cvt_pk_bf16_f32 v133, v34, v50
v_cvt_pk_bf16_f32 v134, v3, v19
v_cvt_pk_bf16_f32 v135, v35, v51
v_pk_mul_f32 v[4:5], v[4:5], s[6:7]
v_pk_mul_f32 v[6:7], v[6:7], s[6:7]
v_pk_mul_f32 v[20:21], v[20:21], s[6:7]
v_pk_mul_f32 v[22:23], v[22:23], s[6:7]
v_pk_mul_f32 v[36:37], v[36:37], s[6:7]
v_pk_mul_f32 v[38:39], v[38:39], s[6:7]
v_pk_mul_f32 v[52:53], v[52:53], s[6:7]
v_pk_mul_f32 v[54:55], v[54:55], s[6:7]
v_cvt_pk_bf16_f32 v136, v4, v20
v_cvt_pk_bf16_f32 v137, v36, v52
v_cvt_pk_bf16_f32 v138, v5, v21
v_cvt_pk_bf16_f32 v139, v37, v53
v_cvt_pk_bf16_f32 v140, v6, v22
v_cvt_pk_bf16_f32 v141, v38, v54
v_cvt_pk_bf16_f32 v142, v7, v23
v_cvt_pk_bf16_f32 v143, v39, v55
v_permlane32_swap_b32 v128, v130
v_permlane32_swap_b32 v129, v131
v_permlane32_swap_b32 v132, v134
v_permlane32_swap_b32 v133, v135
v_permlane32_swap_b32 v136, v138
v_permlane32_swap_b32 v137, v139
v_permlane32_swap_b32 v140, v142
v_permlane32_swap_b32 v141, v143
v_permlane16_swap_b32 v128, v136
v_permlane16_swap_b32 v129, v137
v_permlane16_swap_b32 v130, v138
v_permlane16_swap_b32 v131, v139
v_permlane16_swap_b32 v132, v140
v_permlane16_swap_b32 v133, v141
v_permlane16_swap_b32 v134, v142
v_permlane16_swap_b32 v135, v143
v_bfe_u32 v232, v255, 5, 1
v_lshlrev_b32 v232, 14, v232
v_bfe_u32 v233, v255, 4, 1
v_lshl_add_u32 v232, v233, 12, v232
v_bfe_u32 v233, v255, 3, 1
v_lshl_add_u32 v232, v233, 10, v232
v_and_b32 v233, 7, v255
v_lshl_add_u32 v232, v233, 4, v232
s_lshr_b32 s52, s50, 3
v_add_u32 v252, s52, v232
s_waitcnt vmcnt(21)
s_waitcnt lgkmcnt(0)
s_barrier
ds_read_b128 v[64:67], v236 offset:0
ds_read_b128 v[68:71], v237 offset:0
ds_read_b128 v[72:75], v238 offset:0
ds_read_b128 v[76:79], v239 offset:0
ds_read_b128 v[144:147], v254 offset:32768
ds_read_b128 v[148:151], v254 offset:33792
ds_read_b128 v[152:155], v254 offset:34816
ds_read_b128 v[156:159], v254 offset:35840
ds_read_b128 v[80:83], v240 offset:0
ds_read_b128 v[84:87], v241 offset:0
ds_read_b128 v[88:91], v242 offset:0
ds_read_b128 v[92:95], v243 offset:0
v_lshl_add_u32 v253, v255, 4, s50
v_add_u32 v254, 81920, v253
s_add_u32 s54, s5, 40960
s_and_b32 s54, s54, 0x1ffff
buffer_load_dwordx4 v[208:211], v250, s[16:19], s54 offen nt
s_or_b32 s54, s54, 0x100000
buffer_load_dwordx4 v[212:215], v250, s[16:19], s54 offen nt
s_waitcnt lgkmcnt(11)
v_mfma_f32_32x32x16_bf16 v[160:175], v[64:67], v[128:131], 0
ds_read_b128 v[64:67], v236 offset:8192
s_waitcnt lgkmcnt(11)
v_mfma_f32_32x32x16_bf16 v[160:175], v[68:71], v[132:135], v[160:175]
ds_read_b128 v[68:71], v237 offset:8192
s_waitcnt lgkmcnt(11)
v_mfma_f32_32x32x16_bf16 v[160:175], v[72:75], v[136:139], v[160:175]
ds_read_b128 v[72:75], v238 offset:8192
s_waitcnt lgkmcnt(11)
v_mfma_f32_32x32x16_bf16 v[160:175], v[76:79], v[140:143], v[160:175]
ds_read_b128 v[76:79], v239 offset:8192
s_waitcnt lgkmcnt(7)
v_mfma_f32_32x32x16_bf16 v[160:175], v[80:83], v[144:147], v[160:175]
ds_read_b128 v[80:83], v240 offset:8192
s_waitcnt lgkmcnt(7)
v_mfma_f32_32x32x16_bf16 v[160:175], v[84:87], v[148:151], v[160:175]
ds_read_b128 v[84:87], v241 offset:8192
s_waitcnt lgkmcnt(7)
v_mfma_f32_32x32x16_bf16 v[160:175], v[88:91], v[152:155], v[160:175]
ds_read_b128 v[88:91], v242 offset:8192
s_waitcnt lgkmcnt(7)
v_mfma_f32_32x32x16_bf16 v[160:175], v[92:95], v[156:159], v[160:175]
ds_read_b128 v[92:95], v243 offset:8192
s_add_u32 s54, s5, 57344
s_and_b32 s54, s54, 0x1ffff
buffer_load_dwordx4 v[216:219], v249, s[12:15], s54 offen nt
s_or_b32 s54, s54, 0x100000
buffer_load_dwordx4 v[220:223], v249, s[12:15], s54 offen nt
s_nop 5
v_max3_f32 v232, v160, v161, v162
v_max3_f32 v232, v232, v163, v164
v_max3_f32 v232, v232, v165, v166
v_max3_f32 v232, v232, v167, v168
v_max3_f32 v232, v232, v169, v170
v_max3_f32 v232, v232, v171, v172
v_max3_f32 v232, v232, v173, v174
v_max_f32 v232, v232, v175
v_mov_b32 v233, v232
s_nop 1
v_permlane32_swap_b32 v232, v233
v_max_f32 v232, v232, v233
v_sub_f32 v112, 0, v232
v_sub_f32 v113, 0, v232
v_sub_f32 v114, 0, v232
v_sub_f32 v115, 0, v232
v_sub_f32 v116, 0, v232
v_sub_f32 v117, 0, v232
v_sub_f32 v118, 0, v232
v_sub_f32 v119, 0, v232
v_sub_f32 v120, 0, v232
v_sub_f32 v121, 0, v232
v_sub_f32 v122, 0, v232
v_sub_f32 v123, 0, v232
v_sub_f32 v124, 0, v232
v_sub_f32 v125, 0, v232
v_sub_f32 v126, 0, v232
v_sub_f32 v127, 0, v232
v_add_f32 v160, v160, v112
v_add_f32 v161, v161, v112
v_add_f32 v162, v162, v112
v_add_f32 v163, v163, v112
v_add_f32 v164, v164, v112
v_add_f32 v165, v165, v112
v_add_f32 v166, v166, v112
v_add_f32 v167, v167, v112
v_add_f32 v168, v168, v112
v_add_f32 v169, v169, v112
v_add_f32 v170, v170, v112
v_add_f32 v171, v171, v112
v_add_f32 v172, v172, v112
v_add_f32 v173, v173, v112
v_add_f32 v174, v174, v112
v_add_f32 v175, v175, v112
v_exp_f32 v232, v160
v_exp_f32 v233, v161
v_exp_f32 v234, v162
v_exp_f32 v235, v163
v_add_f32 v251, v232, v233
v_cvt_pk_bf16_f32 v224, v232, v233
v_exp_f32 v232, v164
v_exp_f32 v233, v165
v_add_f32 v251, v251, v234
v_cvt_pk_bf16_f32 v225, v234, v235
v_add_f32 v251, v251, v235
v_exp_f32 v234, v166
v_exp_f32 v235, v167
v_add_f32 v251, v251, v232
v_cvt_pk_bf16_f32 v226, v232, v233
v_add_f32 v251, v251, v233
s_waitcnt vmcnt(21)
s_barrier
s_waitcnt lgkmcnt(7)
v_mfma_f32_32x32x16_bf16 v[96:111], v[64:67], v[128:131], v[112:127]
ds_read_b64_tr_b16 v[64:65], v244 offset:0
ds_read_b64_tr_b16 v[66:67], v244 offset:2048
v_exp_f32 v232, v168
v_exp_f32 v233, v169
v_add_f32 v251, v251, v234
v_cvt_pk_bf16_f32 v227, v234, v235
v_add_f32 v251, v251, v235
s_waitcnt lgkmcnt(8)
v_mfma_f32_32x32x16_bf16 v[96:111], v[68:71], v[132:135], v[96:111]
ds_read_b64_tr_b16 v[68:69], v245 offset:0
ds_read_b64_tr_b16 v[70:71], v245 offset:2048
s_waitcnt lgkmcnt(9)
v_mfma_f32_32x32x16_bf16 v[96:111], v[72:75], v[136:139], v[96:111]
ds_read_b64_tr_b16 v[72:73], v246 offset:0
ds_read_b64_tr_b16 v[74:75], v246 offset:2048
v_exp_f32 v234, v170
v_exp_f32 v235, v171
v_add_f32 v251, v251, v232
v_cvt_pk_bf16_f32 v228, v232, v233
v_add_f32 v251, v251, v233
s_waitcnt lgkmcnt(10)
v_mfma_f32_32x32x16_bf16 v[96:111], v[76:79], v[140:143], v[96:111]
ds_read_b64_tr_b16 v[76:77], v247 offset:0
ds_read_b64_tr_b16 v[78:79], v247 offset:2048
s_waitcnt lgkmcnt(11)
v_mfma_f32_32x32x16_bf16 v[96:111], v[80:83], v[144:147], v[96:111]
ds_read_b64_tr_b16 v[80:81], v244 offset:4096
ds_read_b64_tr_b16 v[82:83], v244 offset:6144
v_exp_f32 v232, v172
v_exp_f32 v233, v173
v_add_f32 v251, v251, v234
v_cvt_pk_bf16_f32 v229, v234, v235
v_add_f32 v251, v251, v235
s_waitcnt lgkmcnt(12)
v_mfma_f32_32x32x16_bf16 v[96:111], v[84:87], v[148:151], v[96:111]
ds_read_b64_tr_b16 v[84:85], v245 offset:4096
ds_read_b64_tr_b16 v[86:87], v245 offset:6144
v_exp_f32 v234, v174
v_exp_f32 v235, v175
v_add_f32 v251, v251, v232
v_cvt_pk_bf16_f32 v230, v232, v233
v_add_f32 v251, v251, v233
s_waitcnt lgkmcnt(13)
v_mfma_f32_32x32x16_bf16 v[96:111], v[88:91], v[152:155], v[96:111]
ds_read_b64_tr_b16 v[88:89], v246 offset:4096
ds_read_b64_tr_b16 v[90:91], v246 offset:6144
v_add_f32 v251, v251, v234
v_cvt_pk_bf16_f32 v231, v234, v235
v_add_f32 v251, v251, v235
s_waitcnt lgkmcnt(14)
v_mfma_f32_32x32x16_bf16 v[96:111], v[92:95], v[156:159], v[96:111]
ds_read_b64_tr_b16 v[92:93], v247 offset:4096
ds_read_b64_tr_b16 v[94:95], v247 offset:6144
v_mov_b32 v248, v251
s_waitcnt lgkmcnt(14)
v_mfma_f32_32x32x16_bf16 v[0:15], v[64:67], v[224:227], 0
ds_read_b128 v[64:67], v236 offset:16384
s_waitcnt vmcnt(12)
ds_write_b128 v253, v[176:179] offset:32768
s_waitcnt lgkmcnt(14)
v_mfma_f32_32x32x16_bf16 v[16:31], v[68:71], v[224:227], 0
ds_read_b128 v[68:71], v237 offset:16384
v_add_u32 v253, 40960, v253
s_waitcnt vmcnt(11)
ds_write_b128 v253, v[180:183] offset:32768
s_nop 1
v_subrev_u32 v253, 40960, v253
s_waitcnt lgkmcnt(14)
v_mfma_f32_32x32x16_bf16 v[32:47], v[72:75], v[224:227], 0
ds_read_b128 v[72:75], v238 offset:16384
s_waitcnt vmcnt(10)
ds_write_b128 v253, v[184:187] offset:0
s_waitcnt lgkmcnt(14)
v_mfma_f32_32x32x16_bf16 v[48:63], v[76:79], v[224:227], 0
ds_read_b128 v[76:79], v239 offset:16384
v_exp_f32 v232, v96
v_exp_f32 v233, v97
s_waitcnt vmcnt(9)
ds_write_b128 v253, v[188:191] offset:40960
s_waitcnt lgkmcnt(14)
v_mfma_f32_32x32x16_bf16 v[0:15], v[80:83], v[228:231], v[0:15]
ds_read_b128 v[80:83], v240 offset:16384
v_exp_f32 v234, v98
v_exp_f32 v235, v99
v_add_f32 v251, v232, v233
v_cvt_pk_bf16_f32 v224, v232, v233
s_waitcnt vmcnt(7)
ds_write_b128 v254, v[192:195] offset:32768
s_waitcnt lgkmcnt(14)
v_mfma_f32_32x32x16_bf16 v[16:31], v[84:87], v[228:231], v[16:31]
ds_read_b128 v[84:87], v241 offset:16384
v_exp_f32 v232, v100
v_exp_f32 v233, v101
v_add_f32 v251, v251, v234
v_cvt_pk_bf16_f32 v225, v234, v235
v_add_f32 v251, v251, v235
v_add_u32 v254, 40960, v254
s_waitcnt vmcnt(6)
ds_write_b128 v254, v[196:199] offset:32768
s_nop 1
v_subrev_u32 v254, 40960, v254
s_waitcnt lgkmcnt(14)
v_mfma_f32_32x32x16_bf16 v[32:47], v[88:91], v[228:231], v[32:47]
ds_read_b128 v[88:91], v242 offset:16384
v_exp_f32 v234, v102
v_exp_f32 v235, v103
v_add_f32 v251, v251, v232
v_cvt_pk_bf16_f32 v226, v232, v233
v_add_f32 v251, v251, v233
s_waitcnt lgkmcnt(13)
v_mfma_f32_32x32x16_bf16 v[48:63], v[92:95], v[228:231], v[48:63]
ds_read_b128 v[92:95], v243 offset:16384
s_waitcnt lgkmcnt(2)
s_barrier
v_mfma_f32_32x32x16_bf16 v[160:175], v[64:67], v[128:131], v[112:127]
ds_read_b64_tr_b16 v[64:65], v244 offset:8192
ds_read_b64_tr_b16 v[66:67], v244 offset:10240
v_exp_f32 v232, v104
v_exp_f32 v233, v105
v_add_f32 v251, v251, v234
v_cvt_pk_bf16_f32 v227, v234, v235
v_add_f32 v251, v251, v235
v_mfma_f32_32x32x16_bf16 v[160:175], v[68:71], v[132:135], v[160:175]
ds_read_b64_tr_b16 v[68:69], v245 offset:8192
ds_read_b64_tr_b16 v[70:71], v245 offset:10240
v_mfma_f32_32x32x16_bf16 v[160:175], v[72:75], v[136:139], v[160:175]
ds_read_b64_tr_b16 v[72:73], v246 offset:8192
ds_read_b64_tr_b16 v[74:75], v246 offset:10240
v_exp_f32 v234, v106
v_exp_f32 v235, v107
v_add_f32 v251, v251, v232
v_cvt_pk_bf16_f32 v228, v232, v233
v_add_f32 v251, v251, v233
v_mfma_f32_32x32x16_bf16 v[160:175], v[76:79], v[140:143], v[160:175]
ds_read_b64_tr_b16 v[76:77], v247 offset:8192
ds_read_b64_tr_b16 v[78:79], v247 offset:10240
v_mfma_f32_32x32x16_bf16 v[160:175], v[80:83], v[144:147], v[160:175]
ds_read_b64_tr_b16 v[80:81], v244 offset:12288
ds_read_b64_tr_b16 v[82:83], v244 offset:14336
v_exp_f32 v232, v108
v_exp_f32 v233, v109
v_add_f32 v251, v251, v234
v_cvt_pk_bf16_f32 v229, v234, v235
v_add_f32 v251, v251, v235
v_mfma_f32_32x32x16_bf16 v[160:175], v[84:87], v[148:151], v[160:175]
ds_read_b64_tr_b16 v[84:85], v245 offset:12288
ds_read_b64_tr_b16 v[86:87], v245 offset:14336
v_exp_f32 v234, v110
v_exp_f32 v235, v111
v_add_f32 v251, v251, v232
v_cvt_pk_bf16_f32 v230, v232, v233
v_add_f32 v251, v251, v233
s_waitcnt lgkmcnt(13)
v_mfma_f32_32x32x16_bf16 v[160:175], v[88:91], v[152:155], v[160:175]
ds_read_b64_tr_b16 v[88:89], v246 offset:12288
ds_read_b64_tr_b16 v[90:91], v246 offset:14336
v_add_f32 v251, v251, v234
v_cvt_pk_bf16_f32 v231, v234, v235
v_add_f32 v251, v251, v235
s_waitcnt lgkmcnt(14)
v_mfma_f32_32x32x16_bf16 v[160:175], v[92:95], v[156:159], v[160:175]
ds_read_b64_tr_b16 v[92:93], v247 offset:12288
ds_read_b64_tr_b16 v[94:95], v247 offset:14336
v_cmp_lt_f32 vcc, s48, v251
s_mov_b32 s49, 1
s_cbranch_vccnz FIX_1
SM_1:
v_add_f32 v248, v248, v251
s_waitcnt lgkmcnt(14)
v_mfma_f32_32x32x16_bf16 v[0:15], v[64:67], v[224:227], v[0:15]
ds_read_b128 v[64:67], v236 offset:24576
s_waitcnt vmcnt(5)
ds_write_b128 v253, v[200:203] offset:8192
s_waitcnt lgkmcnt(14)
v_mfma_f32_32x32x16_bf16 v[16:31], v[68:71], v[224:227], v[16:31]
ds_read_b128 v[68:71], v237 offset:24576
s_waitcnt vmcnt(4)
ds_write_b128 v253, v[204:207] offset:49152
s_waitcnt lgkmcnt(14)
v_mfma_f32_32x32x16_bf16 v[32:47], v[72:75], v[224:227], v[32:47]
ds_read_b128 v[72:75], v238 offset:24576
s_waitcnt vmcnt(3)
ds_write_b128 v254, v[208:211] offset:0
s_waitcnt lgkmcnt(14)
v_mfma_f32_32x32x16_bf16 v[48:63], v[76:79], v[224:227], v[48:63]
ds_read_b128 v[76:79], v239 offset:24576
v_exp_f32 v232, v160
v_exp_f32 v233, v161
s_waitcnt vmcnt(2)
ds_write_b128 v254, v[212:215] offset:40960
s_waitcnt lgkmcnt(14)
v_mfma_f32_32x32x16_bf16 v[0:15], v[80:83], v[228:231], v[0:15]
ds_read_b128 v[80:83], v240 offset:24576
v_exp_f32 v234, v162
v_exp_f32 v235, v163
v_add_f32 v251, v232, v233
v_cvt_pk_bf16_f32 v224, v232, v233
s_waitcnt lgkmcnt(13)
v_mfma_f32_32x32x16_bf16 v[16:31], v[84:87], v[228:231], v[16:31]
ds_read_b128 v[84:87], v241 offset:24576
v_exp_f32 v232, v164
v_exp_f32 v233, v165
v_add_f32 v251, v251, v234
v_cvt_pk_bf16_f32 v225, v234, v235
v_add_f32 v251, v251, v235
s_waitcnt lgkmcnt(12)
v_mfma_f32_32x32x16_bf16 v[32:47], v[88:91], v[228:231], v[32:47]
ds_read_b128 v[88:91], v242 offset:24576
v_exp_f32 v234, v166
v_exp_f32 v235, v167
v_add_f32 v251, v251, v232
v_cvt_pk_bf16_f32 v226, v232, v233
v_add_f32 v251, v251, v233
s_waitcnt lgkmcnt(11)
v_mfma_f32_32x32x16_bf16 v[48:63], v[92:95], v[228:231], v[48:63]
ds_read_b128 v[92:95], v243 offset:24576
s_waitcnt lgkmcnt(4)
s_barrier
v_mfma_f32_32x32x16_bf16 v[96:111], v[64:67], v[128:131], v[112:127]
ds_read_b64_tr_b16 v[64:65], v244 offset:16384
ds_read_b64_tr_b16 v[66:67], v244 offset:18432
v_exp_f32 v232, v168
v_exp_f32 v233, v169
v_add_f32 v251, v251, v234
v_cvt_pk_bf16_f32 v227, v234, v235
v_add_f32 v251, v251, v235
v_mfma_f32_32x32x16_bf16 v[96:111], v[68:71], v[132:135], v[96:111]
ds_read_b64_tr_b16 v[68:69], v245 offset:16384
ds_read_b64_tr_b16 v[70:71], v245 offset:18432
v_mfma_f32_32x32x16_bf16 v[96:111], v[72:75], v[136:139], v[96:111]
ds_read_b64_tr_b16 v[72:73], v246 offset:16384
ds_read_b64_tr_b16 v[74:75], v246 offset:18432
v_exp_f32 v234, v170
v_exp_f32 v235, v171
v_add_f32 v251, v251, v232
v_cvt_pk_bf16_f32 v228, v232, v233
v_add_f32 v251, v251, v233
v_mfma_f32_32x32x16_bf16 v[96:111], v[76:79], v[140:143], v[96:111]
ds_read_b64_tr_b16 v[76:77], v247 offset:16384
ds_read_b64_tr_b16 v[78:79], v247 offset:18432
s_waitcnt lgkmcnt(11)
v_mfma_f32_32x32x16_bf16 v[96:111], v[80:83], v[144:147], v[96:111]
ds_read_b64_tr_b16 v[80:81], v244 offset:20480
ds_read_b64_tr_b16 v[82:83], v244 offset:22528
v_exp_f32 v232, v172
v_exp_f32 v233, v173
v_add_f32 v251, v251, v234
v_cvt_pk_bf16_f32 v229, v234, v235
v_add_f32 v251, v251, v235
s_waitcnt lgkmcnt(12)
v_mfma_f32_32x32x16_bf16 v[96:111], v[84:87], v[148:151], v[96:111]
ds_read_b64_tr_b16 v[84:85], v245 offset:20480
ds_read_b64_tr_b16 v[86:87], v245 offset:22528
v_exp_f32 v234, v174
v_exp_f32 v235, v175
v_add_f32 v251, v251, v232
v_cvt_pk_bf16_f32 v230, v232, v233
v_add_f32 v251, v251, v233
s_waitcnt lgkmcnt(13)
v_mfma_f32_32x32x16_bf16 v[96:111], v[88:91], v[152:155], v[96:111]
ds_read_b64_tr_b16 v[88:89], v246 offset:20480
ds_read_b64_tr_b16 v[90:91], v246 offset:22528
v_add_f32 v251, v251, v234
v_cvt_pk_bf16_f32 v231, v234, v235
v_add_f32 v251, v251, v235
s_waitcnt lgkmcnt(14)
v_mfma_f32_32x32x16_bf16 v[96:111], v[92:95], v[156:159], v[96:111]
ds_read_b64_tr_b16 v[92:93], v247 offset:20480
ds_read_b64_tr_b16 v[94:95], v247 offset:22528
v_cmp_lt_f32 vcc, s48, v251
s_mov_b32 s49, 2
s_cbranch_vccnz FIX_0
SM_2:
v_add_f32 v248, v248, v251
s_waitcnt lgkmcnt(14)
v_mfma_f32_32x32x16_bf16 v[0:15], v[64:67], v[224:227], v[0:15]
ds_read_b128 v[64:67], v236 offset:32768
s_waitcnt vmcnt(1)
ds_write_b128 v253, v[216:219] offset:16384
s_waitcnt lgkmcnt(14)
v_mfma_f32_32x32x16_bf16 v[16:31], v[68:71], v[224:227], v[16:31]
ds_read_b128 v[68:71], v237 offset:32768
s_waitcnt vmcnt(0)
ds_write_b128 v253, v[220:223] offset:57344
s_waitcnt lgkmcnt(14)
v_mfma_f32_32x32x16_bf16 v[32:47], v[72:75], v[224:227], v[32:47]
ds_read_b128 v[72:75], v238 offset:32768
s_add_u32 s54, s5, 49152
s_and_b32 s54, s54, 0x1ffff
s_add_u32 m0, s50, 90112
s_nop 0
buffer_load_dwordx4 v250, s[16:19], s54 offen nt lds
s_waitcnt lgkmcnt(13)
v_mfma_f32_32x32x16_bf16 v[48:63], v[76:79], v[224:227], v[48:63]
ds_read_b128 v[76:79], v239 offset:32768
v_exp_f32 v232, v96
v_exp_f32 v233, v97
s_or_b32 s54, s54, 0x100000
s_add_u32 m0, s50, 131072
s_nop 0
buffer_load_dwordx4 v250, s[16:19], s54 offen nt lds
s_waitcnt lgkmcnt(12)
v_mfma_f32_32x32x16_bf16 v[0:15], v[80:83], v[228:231], v[0:15]
ds_read_b128 v[80:83], v240 offset:32768
v_exp_f32 v234, v98
v_exp_f32 v235, v99
v_add_f32 v251, v232, v233
v_cvt_pk_bf16_f32 v224, v232, v233
s_waitcnt lgkmcnt(11)
v_mfma_f32_32x32x16_bf16 v[16:31], v[84:87], v[228:231], v[16:31]
ds_read_b128 v[84:87], v241 offset:32768
v_exp_f32 v232, v100
v_exp_f32 v233, v101
v_add_f32 v251, v251, v234
v_cvt_pk_bf16_f32 v225, v234, v235
v_add_f32 v251, v251, v235
s_waitcnt lgkmcnt(10)
v_mfma_f32_32x32x16_bf16 v[32:47], v[88:91], v[228:231], v[32:47]
ds_read_b128 v[88:91], v242 offset:32768
v_exp_f32 v234, v102
v_exp_f32 v235, v103
v_add_f32 v251, v251, v232
v_cvt_pk_bf16_f32 v226, v232, v233
v_add_f32 v251, v251, v233
s_waitcnt lgkmcnt(9)
v_mfma_f32_32x32x16_bf16 v[48:63], v[92:95], v[228:231], v[48:63]
ds_read_b128 v[92:95], v243 offset:32768
s_waitcnt lgkmcnt(6)
s_barrier
v_mfma_f32_32x32x16_bf16 v[160:175], v[64:67], v[128:131], v[112:127]
ds_read_b64_tr_b16 v[64:65], v244 offset:24576
ds_read_b64_tr_b16 v[66:67], v244 offset:26624
v_exp_f32 v232, v104
v_exp_f32 v233, v105
v_add_f32 v251, v251, v234
v_cvt_pk_bf16_f32 v227, v234, v235
v_add_f32 v251, v251, v235
v_mfma_f32_32x32x16_bf16 v[160:175], v[68:71], v[132:135], v[160:175]
ds_read_b64_tr_b16 v[68:69], v245 offset:24576
ds_read_b64_tr_b16 v[70:71], v245 offset:26624
s_waitcnt lgkmcnt(9)
v_mfma_f32_32x32x16_bf16 v[160:175], v[72:75], v[136:139], v[160:175]
ds_read_b64_tr_b16 v[72:73], v246 offset:24576
ds_read_b64_tr_b16 v[74:75], v246 offset:26624
v_exp_f32 v234, v106
v_exp_f32 v235, v107
v_add_f32 v251, v251, v232
v_cvt_pk_bf16_f32 v228, v232, v233
v_add_f32 v251, v251, v233
s_waitcnt lgkmcnt(10)
v_mfma_f32_32x32x16_bf16 v[160:175], v[76:79], v[140:143], v[160:175]
ds_read_b64_tr_b16 v[76:77], v247 offset:24576
ds_read_b64_tr_b16 v[78:79], v247 offset:26624
s_waitcnt lgkmcnt(11)
v_mfma_f32_32x32x16_bf16 v[160:175], v[80:83], v[144:147], v[160:175]
ds_read_b64_tr_b16 v[80:81], v244 offset:28672
ds_read_b64_tr_b16 v[82:83], v244 offset:30720
v_exp_f32 v232, v108
v_exp_f32 v233, v109
v_add_f32 v251, v251, v234
v_cvt_pk_bf16_f32 v229, v234, v235
v_add_f32 v251, v251, v235
s_waitcnt lgkmcnt(12)
v_mfma_f32_32x32x16_bf16 v[160:175], v[84:87], v[148:151], v[160:175]
ds_read_b64_tr_b16 v[84:85], v245 offset:28672
ds_read_b64_tr_b16 v[86:87], v245 offset:30720
v_exp_f32 v234, v110
v_exp_f32 v235, v111
v_add_f32 v251, v251, v232
v_cvt_pk_bf16_f32 v230, v232, v233
v_add_f32 v251, v251, v233
s_waitcnt lgkmcnt(13)
v_mfma_f32_32x32x16_bf16 v[160:175], v[88:91], v[152:155], v[160:175]
ds_read_b64_tr_b16 v[88:89], v246 offset:28672
ds_read_b64_tr_b16 v[90:91], v246 offset:30720
v_add_f32 v251, v251, v234
v_cvt_pk_bf16_f32 v231, v234, v235
v_add_f32 v251, v251, v235
s_waitcnt lgkmcnt(14)
v_mfma_f32_32x32x16_bf16 v[160:175], v[92:95], v[156:159], v[160:175]
ds_read_b64_tr_b16 v[92:93], v247 offset:28672
ds_read_b64_tr_b16 v[94:95], v247 offset:30720
v_cmp_lt_f32 vcc, s48, v251
s_mov_b32 s49, 3
s_cbranch_vccnz FIX_1
SM_3:
v_add_f32 v248, v248, v251
s_waitcnt lgkmcnt(14)
v_mfma_f32_32x32x16_bf16 v[0:15], v[64:67], v[224:227], v[0:15]
ds_read_b128 v[64:67], v236 offset:0
s_add_u32 s54, s5, 65536
s_and_b32 s54, s54, 0x1ffff
s_add_u32 m0, s50, 24576
s_nop 0
buffer_load_dwordx4 v249, s[12:15], s54 offen nt lds
s_waitcnt lgkmcnt(13)
v_mfma_f32_32x32x16_bf16 v[16:31], v[68:71], v[224:227], v[16:31]
ds_read_b128 v[68:71], v237 offset:0
s_or_b32 s54, s54, 0x100000
s_add_u32 m0, s50, 65536
s_nop 0
buffer_load_dwordx4 v249, s[12:15], s54 offen nt lds
s_waitcnt lgkmcnt(12)
v_mfma_f32_32x32x16_bf16 v[32:47], v[72:75], v[224:227], v[32:47]
ds_read_b128 v[72:75], v238 offset:0
s_add_u32 s54, s5, 57344
s_and_b32 s54, s54, 0x1ffff
s_add_u32 m0, s50, 98304
s_nop 0
buffer_load_dwordx4 v250, s[16:19], s54 offen nt lds
s_waitcnt lgkmcnt(11)
v_mfma_f32_32x32x16_bf16 v[48:63], v[76:79], v[224:227], v[48:63]
ds_read_b128 v[76:79], v239 offset:0
v_exp_f32 v232, v160
v_exp_f32 v233, v161
s_or_b32 s54, s54, 0x100000
s_add_u32 m0, s50, 139264
s_nop 0
buffer_load_dwordx4 v250, s[16:19], s54 offen nt lds
s_waitcnt lgkmcnt(10)
v_mfma_f32_32x32x16_bf16 v[0:15], v[80:83], v[228:231], v[0:15]
ds_read_b128 v[80:83], v240 offset:0
v_exp_f32 v234, v162
v_exp_f32 v235, v163
v_add_f32 v251, v232, v233
v_cvt_pk_bf16_f32 v224, v232, v233
s_waitcnt lgkmcnt(9)
v_mfma_f32_32x32x16_bf16 v[16:31], v[84:87], v[228:231], v[16:31]
ds_read_b128 v[84:87], v241 offset:0
v_exp_f32 v232, v164
v_exp_f32 v233, v165
v_add_f32 v251, v251, v234
v_cvt_pk_bf16_f32 v225, v234, v235
v_add_f32 v251, v251, v235
s_waitcnt lgkmcnt(8)
v_mfma_f32_32x32x16_bf16 v[32:47], v[88:91], v[228:231], v[32:47]
ds_read_b128 v[88:91], v242 offset:0
v_exp_f32 v234, v166
v_exp_f32 v235, v167
v_add_f32 v251, v251, v232
v_cvt_pk_bf16_f32 v226, v232, v233
v_add_f32 v251, v251, v233
s_waitcnt lgkmcnt(7)
v_mfma_f32_32x32x16_bf16 v[48:63], v[92:95], v[228:231], v[48:63]
ds_read_b128 v[92:95], v243 offset:0
s_barrier
s_waitcnt lgkmcnt(7)
v_mfma_f32_32x32x16_bf16 v[96:111], v[64:67], v[128:131], v[112:127]
ds_read_b64_tr_b16 v[64:65], v244 offset:32768
ds_read_b64_tr_b16 v[66:67], v244 offset:34816
v_exp_f32 v232, v168
v_exp_f32 v233, v169
v_add_f32 v251, v251, v234
v_cvt_pk_bf16_f32 v227, v234, v235
v_add_f32 v251, v251, v235
s_waitcnt lgkmcnt(8)
v_mfma_f32_32x32x16_bf16 v[96:111], v[68:71], v[132:135], v[96:111]
ds_read_b64_tr_b16 v[68:69], v245 offset:32768
ds_read_b64_tr_b16 v[70:71], v245 offset:34816
s_waitcnt lgkmcnt(9)
v_mfma_f32_32x32x16_bf16 v[96:111], v[72:75], v[136:139], v[96:111]
ds_read_b64_tr_b16 v[72:73], v246 offset:32768
ds_read_b64_tr_b16 v[74:75], v246 offset:34816
v_exp_f32 v234, v170
v_exp_f32 v235, v171
v_add_f32 v251, v251, v232
v_cvt_pk_bf16_f32 v228, v232, v233
v_add_f32 v251, v251, v233
s_waitcnt lgkmcnt(10)
v_mfma_f32_32x32x16_bf16 v[96:111], v[76:79], v[140:143], v[96:111]
ds_read_b64_tr_b16 v[76:77], v247 offset:32768
ds_read_b64_tr_b16 v[78:79], v247 offset:34816
s_waitcnt lgkmcnt(11)
v_mfma_f32_32x32x16_bf16 v[96:111], v[80:83], v[144:147], v[96:111]
ds_read_b64_tr_b16 v[80:81], v244 offset:36864
ds_read_b64_tr_b16 v[82:83], v244 offset:38912
v_exp_f32 v232, v172
v_exp_f32 v233, v173
v_add_f32 v251, v251, v234
v_cvt_pk_bf16_f32 v229, v234, v235
v_add_f32 v251, v251, v235
s_waitcnt lgkmcnt(12)
v_mfma_f32_32x32x16_bf16 v[96:111], v[84:87], v[148:151], v[96:111]
ds_read_b64_tr_b16 v[84:85], v245 offset:36864
ds_read_b64_tr_b16 v[86:87], v245 offset:38912
v_exp_f32 v234, v174
v_exp_f32 v235, v175
v_add_f32 v251, v251, v232
v_cvt_pk_bf16_f32 v230, v232, v233
v_add_f32 v251, v251, v233
s_waitcnt lgkmcnt(13)
v_mfma_f32_32x32x16_bf16 v[96:111], v[88:91], v[152:155], v[96:111]
ds_read_b64_tr_b16 v[88:89], v246 offset:36864
ds_read_b64_tr_b16 v[90:91], v246 offset:38912
v_add_f32 v251, v251, v234
v_cvt_pk_bf16_f32 v231, v234, v235
v_add_f32 v251, v251, v235
s_waitcnt lgkmcnt(14)
v_mfma_f32_32x32x16_bf16 v[96:111], v[92:95], v[156:159], v[96:111]
ds_read_b64_tr_b16 v[92:93], v247 offset:36864
ds_read_b64_tr_b16 v[94:95], v247 offset:38912
v_cmp_lt_f32 vcc, s48, v251
s_mov_b32 s49, 4
s_cbranch_vccnz FIX_0
SM_4:
v_add_f32 v248, v248, v251
s_waitcnt lgkmcnt(14)
v_mfma_f32_32x32x16_bf16 v[0:15], v[64:67], v[224:227], v[0:15]
ds_read_b128 v[64:67], v236 offset:8192
s_add_u32 s54, s5, 73728
s_and_b32 s54, s54, 0x1ffff
s_add_u32 m0, s50, 32768
s_nop 0
buffer_load_dwordx4 v249, s[12:15], s54 offen nt lds
s_waitcnt lgkmcnt(13)
v_mfma_f32_32x32x16_bf16 v[16:31], v[68:71], v[224:227], v[16:31]
ds_read_b128 v[68:71], v237 offset:8192
s_or_b32 s54, s54, 0x100000
s_add_u32 m0, s50, 73728
s_nop 0
buffer_load_dwordx4 v249, s[12:15], s54 offen nt lds
s_waitcnt lgkmcnt(12)
v_mfma_f32_32x32x16_bf16 v[32:47], v[72:75], v[224:227], v[32:47]
ds_read_b128 v[72:75], v238 offset:8192
s_add_u32 s54, s5, 65536
s_and_b32 s54, s54, 0x1ffff
s_add_u32 m0, s50, 106496
s_nop 0
buffer_load_dwordx4 v250, s[16:19], s54 offen nt lds
s_waitcnt lgkmcnt(11)
v_mfma_f32_32x32x16_bf16 v[48:63], v[76:79], v[224:227], v[48:63]
ds_read_b128 v[76:79], v239 offset:8192
v_exp_f32 v232, v96
v_exp_f32 v233, v97
s_or_b32 s54, s54, 0x100000
s_add_u32 m0, s50, 147456
s_nop 0
buffer_load_dwordx4 v250, s[16:19], s54 offen nt lds
s_waitcnt lgkmcnt(10)
v_mfma_f32_32x32x16_bf16 v[0:15], v[80:83], v[228:231], v[0:15]
ds_read_b128 v[80:83], v240 offset:8192
v_exp_f32 v234, v98
v_exp_f32 v235, v99
v_add_f32 v251, v232, v233
v_cvt_pk_bf16_f32 v224, v232, v233
s_waitcnt lgkmcnt(9)
v_mfma_f32_32x32x16_bf16 v[16:31], v[84:87], v[228:231], v[16:31]
ds_read_b128 v[84:87], v241 offset:8192
v_exp_f32 v232, v100
v_exp_f32 v233, v101
v_add_f32 v251, v251, v234
v_cvt_pk_bf16_f32 v225, v234, v235
v_add_f32 v251, v251, v235
s_waitcnt lgkmcnt(8)
v_mfma_f32_32x32x16_bf16 v[32:47], v[88:91], v[228:231], v[32:47]
ds_read_b128 v[88:91], v242 offset:8192
v_exp_f32 v234, v102
v_exp_f32 v235, v103
v_add_f32 v251, v251, v232
v_cvt_pk_bf16_f32 v226, v232, v233
v_add_f32 v251, v251, v233
s_waitcnt lgkmcnt(7)
v_mfma_f32_32x32x16_bf16 v[48:63], v[92:95], v[228:231], v[48:63]
ds_read_b128 v[92:95], v243 offset:8192
s_barrier
s_waitcnt lgkmcnt(7)
v_mfma_f32_32x32x16_bf16 v[160:175], v[64:67], v[128:131], v[112:127]
ds_read_b64_tr_b16 v[64:65], v244 offset:0
ds_read_b64_tr_b16 v[66:67], v244 offset:2048
v_exp_f32 v232, v104
v_exp_f32 v233, v105
v_add_f32 v251, v251, v234
v_cvt_pk_bf16_f32 v227, v234, v235
v_add_f32 v251, v251, v235
s_waitcnt lgkmcnt(8)
v_mfma_f32_32x32x16_bf16 v[160:175], v[68:71], v[132:135], v[160:175]
ds_read_b64_tr_b16 v[68:69], v245 offset:0
ds_read_b64_tr_b16 v[70:71], v245 offset:2048
s_waitcnt lgkmcnt(9)
v_mfma_f32_32x32x16_bf16 v[160:175], v[72:75], v[136:139], v[160:175]
ds_read_b64_tr_b16 v[72:73], v246 offset:0
ds_read_b64_tr_b16 v[74:75], v246 offset:2048
v_exp_f32 v234, v106
v_exp_f32 v235, v107
v_add_f32 v251, v251, v232
v_cvt_pk_bf16_f32 v228, v232, v233
v_add_f32 v251, v251, v233
s_waitcnt lgkmcnt(10)
v_mfma_f32_32x32x16_bf16 v[160:175], v[76:79], v[140:143], v[160:175]
ds_read_b64_tr_b16 v[76:77], v247 offset:0
ds_read_b64_tr_b16 v[78:79], v247 offset:2048
s_waitcnt lgkmcnt(11)
v_mfma_f32_32x32x16_bf16 v[160:175], v[80:83], v[144:147], v[160:175]
ds_read_b64_tr_b16 v[80:81], v244 offset:4096
ds_read_b64_tr_b16 v[82:83], v244 offset:6144
v_exp_f32 v232, v108
v_exp_f32 v233, v109
v_add_f32 v251, v251, v234
v_cvt_pk_bf16_f32 v229, v234, v235
v_add_f32 v251, v251, v235
s_waitcnt lgkmcnt(12)
v_mfma_f32_32x32x16_bf16 v[160:175], v[84:87], v[148:151], v[160:175]
ds_read_b64_tr_b16 v[84:85], v245 offset:4096
ds_read_b64_tr_b16 v[86:87], v245 offset:6144
v_exp_f32 v234, v110
v_exp_f32 v235, v111
v_add_f32 v251, v251, v232
v_cvt_pk_bf16_f32 v230, v232, v233
v_add_f32 v251, v251, v233
s_waitcnt lgkmcnt(13)
v_mfma_f32_32x32x16_bf16 v[160:175], v[88:91], v[152:155], v[160:175]
ds_read_b64_tr_b16 v[88:89], v246 offset:4096
ds_read_b64_tr_b16 v[90:91], v246 offset:6144
v_add_f32 v251, v251, v234
v_cvt_pk_bf16_f32 v231, v234, v235
v_add_f32 v251, v251, v235
s_waitcnt lgkmcnt(14)
v_mfma_f32_32x32x16_bf16 v[160:175], v[92:95], v[156:159], v[160:175]
ds_read_b64_tr_b16 v[92:93], v247 offset:4096
ds_read_b64_tr_b16 v[94:95], v247 offset:6144
v_cmp_lt_f32 vcc, s48, v251
s_mov_b32 s49, 5
s_cbranch_vccnz FIX_1
SM_5:
v_add_f32 v248, v248, v251
s_waitcnt lgkmcnt(14)
v_mfma_f32_32x32x16_bf16 v[0:15], v[64:67], v[224:227], v[0:15]
ds_read_b128 v[64:67], v236 offset:16384
s_add_u32 s54, s5, 81920
s_and_b32 s54, s54, 0x1ffff
s_add_u32 m0, s50, 0
s_nop 0
buffer_load_dwordx4 v249, s[12:15], s54 offen nt lds
s_waitcnt lgkmcnt(13)
v_mfma_f32_32x32x16_bf16 v[16:31], v[68:71], v[224:227], v[16:31]
ds_read_b128 v[68:71], v237 offset:16384
s_or_b32 s54, s54, 0x100000
s_add_u32 m0, s50, 40960
s_nop 0
buffer_load_dwordx4 v249, s[12:15], s54 offen nt lds
s_waitcnt lgkmcnt(12)
v_mfma_f32_32x32x16_bf16 v[32:47], v[72:75], v[224:227], v[32:47]
ds_read_b128 v[72:75], v238 offset:16384
s_add_u32 s54, s5, 73728
s_and_b32 s54, s54, 0x1ffff
s_add_u32 m0, s50, 114688
s_nop 0
buffer_load_dwordx4 v250, s[16:19], s54 offen nt lds
s_waitcnt lgkmcnt(11)
v_mfma_f32_32x32x16_bf16 v[48:63], v[76:79], v[224:227], v[48:63]
ds_read_b128 v[76:79], v239 offset:16384
v_exp_f32 v232, v160
v_exp_f32 v233, v161
s_or_b32 s54, s54, 0x100000
s_add_u32 m0, s50, 155648
s_nop 0
buffer_load_dwordx4 v250, s[16:19], s54 offen nt lds
s_waitcnt lgkmcnt(10)
v_mfma_f32_32x32x16_bf16 v[0:15], v[80:83], v[228:231], v[0:15]
ds_read_b128 v[80:83], v240 offset:16384
v_exp_f32 v234, v162
v_exp_f32 v235, v163
v_add_f32 v251, v232, v233
v_cvt_pk_bf16_f32 v224, v232, v233
s_waitcnt lgkmcnt(9)
v_mfma_f32_32x32x16_bf16 v[16:31], v[84:87], v[228:231], v[16:31]
ds_read_b128 v[84:87], v241 offset:16384
v_exp_f32 v232, v164
v_exp_f32 v233, v165
v_add_f32 v251, v251, v234
v_cvt_pk_bf16_f32 v225, v234, v235
v_add_f32 v251, v251, v235
s_waitcnt lgkmcnt(8)
v_mfma_f32_32x32x16_bf16 v[32:47], v[88:91], v[228:231], v[32:47]
ds_read_b128 v[88:91], v242 offset:16384
v_exp_f32 v234, v166
v_exp_f32 v235, v167
v_add_f32 v251, v251, v232
v_cvt_pk_bf16_f32 v226, v232, v233
v_add_f32 v251, v251, v233
s_waitcnt lgkmcnt(7)
v_mfma_f32_32x32x16_bf16 v[48:63], v[92:95], v[228:231], v[48:63]
ds_read_b128 v[92:95], v243 offset:16384
s_branch L_join
L_cls1:
s_add_u32 s52, s44, 0
s_and_b32 s52, s52, 7
s_lshl_b32 s52, s52, 7
s_add_u32 m0, s50, 24576
s_nop 0
buffer_load_dwordx4 v248, s[8:11], s52 offen  lds
s_add_u32 s52, s44, 1
s_and_b32 s52, s52, 7
s_lshl_b32 s52, s52, 7
s_add_u32 m0, s50, 65536
s_nop 0
buffer_load_dwordx4 v248, s[8:11], s52 offen  lds
s_add_u32 s52, s44, 2
s_and_b32 s52, s52, 7
s_lshl_b32 s52, s52, 7
s_add_u32 m0, s50, 106496
s_nop 0
buffer_load_dwordx4 v248, s[8:11], s52 offen  lds
s_add_u32 s52, s44, 3
s_and_b32 s52, s52, 7
s_lshl_b32 s52, s52, 7
s_add_u32 m0, s50, 147456
s_nop 0
buffer_load_dwordx4 v248, s[8:11], s52 offen  lds
s_barrier
v_add_u32 v251, s61, v252
buffer_load_dwordx4 v[64:67], v251, s[20:23], 0 offen
buffer_load_dwordx4 v[68:71], v251, s[20:23], s96 offen
buffer_load_dwordx4 v[72:75], v251, s[20:23], s97 offen
buffer_load_dwordx4 v[76:79], v251, s[20:23], s98 offen
s_barrier
v_lshrrev_b32 v232, 4, v255
s_lshl_b32 s52, s40, 2
v_add_u32 v233, s52, v232
v_xor_b32 v234, v255, v233
v_and_b32 v234, 15, v234
v_lshlrev_b32 v234, 4, v234
v_lshl_add_u32 v249, v233, 8, v234
v_lshlrev_b32 v234, 2, v232
v_xor_b32 v234, v255, v234
v_and_b32 v234, 15, v234
v_lshlrev_b32 v234, 4, v234
v_lshl_add_u32 v250, v233, 8, v234
v_and_b32 v233, 15, v255
v_lshrrev_b32 v234, 1, v233
v_xor_b32 v234, v234, v232
v_lshlrev_b32 v234, 4, v234
v_lshl_add_u32 v253, v233, 7, v234
s_lshl_b32 s53, s60, 6
s_lshl_b32 s52, s47, 12
s_or_b32 s52, s52, s53
v_xor_b32 v253, s52, v253
v_xor_b32 v254, 0x1000, v253
s_lshl_b32 s62, s51, 19
s_lshl_b32 s53, s41, 16
s_add_u32 s62, s62, s53
s_lshl_b32 s53, s40, 13
s_add_u32 s62, s62, s53
s_add_u32 s54, s5, 0
s_and_b32 s54, s54, 0x1ffff
s_add_u32 m0, s50, 0
s_nop 0
buffer_load_dwordx4 v249, s[12:15], s54 offen nt lds
s_or_b32 s54, s54, 0x100000
s_add_u32 m0, s50, 40960
s_nop 0
buffer_load_dwordx4 v249, s[12:15], s54 offen nt lds
s_add_u32 s54, s5, 8192
s_and_b32 s54, s54, 0x1ffff
s_add_u32 m0, s50, 8192
s_nop 0
buffer_load_dwordx4 v249, s[12:15], s54 offen nt lds
s_or_b32 s54, s54, 0x100000
s_add_u32 m0, s50, 49152
s_nop 0
buffer_load_dwordx4 v249, s[12:15], s54 offen nt lds
s_add_u32 s54, s5, 0
s_and_b32 s54, s54, 0x1ffff
s_add_u32 m0, s50, 81920
s_nop 0
buffer_load_dwordx4 v250, s[16:19], s54 offen nt lds
s_or_b32 s54, s54, 0x100000
s_add_u32 m0, s50, 122880
s_nop 0
buffer_load_dwordx4 v250, s[16:19], s54 offen nt lds
s_add_u32 s54, s5, 16384
s_and_b32 s54, s54, 0x1ffff
s_add_u32 m0, s50, 16384
s_nop 0
buffer_load_dwordx4 v249, s[12:15], s54 offen nt lds
s_or_b32 s54, s54, 0x100000
s_add_u32 m0, s50, 57344
s_nop 0
buffer_load_dwordx4 v249, s[12:15], s54 offen nt lds
s_add_u32 s54, s5, 8192
s_and_b32 s54, s54, 0x1ffff
s_add_u32 m0, s50, 90112
s_nop 0
buffer_load_dwordx4 v250, s[16:19], s54 offen nt lds
s_or_b32 s54, s54, 0x100000
s_add_u32 m0, s50, 131072
s_nop 0
buffer_load_dwordx4 v250, s[16:19], s54 offen nt lds
s_add_u32 s54, s5, 16384
s_and_b32 s54, s54, 0x1ffff
s_add_u32 m0, s50, 98304
s_nop 0
buffer_load_dwordx4 v250, s[16:19], s54 offen nt lds
s_or_b32 s54, s54, 0x100000
s_add_u32 m0, s50, 139264
s_nop 0
buffer_load_dwordx4 v250, s[16:19], s54 offen nt lds
s_add_u32 s54, s5, 32768
s_and_b32 s54, s54, 0x1ffff
buffer_load_dwordx4 v[176:179], v249, s[12:15], s54 offen nt
s_or_b32 s54, s54, 0x100000
buffer_load_dwordx4 v[180:183], v249, s[12:15], s54 offen nt
s_add_u32 s54, s5, 40960
s_and_b32 s54, s54, 0x1ffff
buffer_load_dwordx4 v[184:187], v249, s[12:15], s54 offen nt
s_or_b32 s54, s54, 0x100000
buffer_load_dwordx4 v[188:191], v249, s[12:15], s54 offen nt
s_add_u32 s54, s5, 32768
s_and_b32 s54, s54, 0x1ffff
buffer_load_dwordx4 v[192:195], v250, s[16:19], s54 offen nt
s_or_b32 s54, s54, 0x100000
buffer_load_dwordx4 v[196:199], v250, s[16:19], s54 offen nt
s_add_u32 s54, s5, 49152
s_and_b32 s54, s54, 0x1ffff
buffer_load_dwordx4 v[200:203], v249, s[12:15], s54 offen nt
s_or_b32 s54, s54, 0x100000
buffer_load_dwordx4 v[204:207], v249, s[12:15], s54 offen nt
s_add_u32 s54, s5, 40960
s_and_b32 s54, s54, 0x1ffff
buffer_load_dwordx4 v[208:211], v250, s[16:19], s54 offen nt
s_or_b32 s54, s54, 0x100000
buffer_load_dwordx4 v[212:215], v250, s[16:19], s54 offen nt
s_add_u32 s54, s5, 57344
s_and_b32 s54, s54, 0x1ffff
buffer_load_dwordx4 v[216:219], v249, s[12:15], s54 offen nt
s_or_b32 s54, s54, 0x100000
buffer_load_dwordx4 v[220:223], v249, s[12:15], s54 offen nt
v_xor_b32 v251, 262144, v251
buffer_load_dwordx4 v[80:83], v251, s[20:23], 0 offen
buffer_load_dwordx4 v[84:87], v251, s[20:23], s96 offen
buffer_load_dwordx4 v[88:91], v251, s[20:23], s97 offen
buffer_load_dwordx4 v[92:95], v251, s[20:23], s98 offen
s_add_u32 s61, s61, 524288
s_and_b32 s61, s61, 4194303
v_add_u32 v251, s61, v252
buffer_load_dwordx4 v[96:99], v251, s[20:23], 0 offen
buffer_load_dwordx4 v[100:103], v251, s[20:23], s96 offen
buffer_load_dwordx4 v[104:107], v251, s[20:23], s97 offen
buffer_load_dwordx4 v[108:111], v251, s[20:23], s98 offen
v_and_b32 v232, 31, v255
v_lshrrev_b32 v233, 5, v255
v_and_b32 v234, 15, v255
v_xor_b32 v233, v233, v234
v_lshlrev_b32 v233, 4, v233
v_lshl_add_u32 v233, v232, 8, v233
s_lshl_b32 s52, s47, 7
v_xor_b32 v233, s52, v233
s_mul_i32 s52, s47, 40960
v_add_u32 v236, s52, v233
v_xor_b32 v237, 32, v236
v_xor_b32 v238, 64, v236
v_xor_b32 v239, 96, v236
v_xor_b32 v240, 128, v236
v_xor_b32 v241, 160, v236
v_xor_b32 v242, 192, v236
v_xor_b32 v243, 224, v236
v_bfe_u32 v232, v255, 2, 2
v_lshrrev_b32 v233, 5, v255
v_lshl_add_u32 v233, v233, 2, v232
v_lshlrev_b32 v233, 8, v233
v_lshl_add_u32 v233, v232, 6, v233
v_bfe_u32 v232, v255, 4, 1
v_lshl_add_u32 v233, v232, 5, v233
v_and_b32 v232, 3, v255
v_lshl_add_u32 v233, v232, 3, v233
s_add_u32 s52, s52, 81920
v_add_u32 v244, s52, v233
v_xor_b32 v245, 64, v244
v_xor_b32 v246, 128, v244
v_xor_b32 v247, 192, v244
s_waitcnt vmcnt(36)
s_barrier
ds_read_b128 v[160:163], v253 offset:24576
ds_read_b128 v[164:167], v253 offset:26624
ds_read_b128 v[168:171], v254 offset:24576
ds_read_b128 v[172:175], v254 offset:26624
s_waitcnt vmcnt(35)
v_cndmask_b32_dpp v148, v66, v64, vcc row_ror:8 row_mask:0xf bank_mask:0xf
s_waitcnt vmcnt(34)
v_cndmask_b32_dpp v149, v70, v68, vcc row_ror:8 row_mask:0xf bank_mask:0xf
v_mov_b32_dpp v66, v64 row_ror:8 row_mask:0xf bank_mask:0x3
v_mov_b32_dpp v70, v68 row_ror:8 row_mask:0xf bank_mask:0x3
v_perm_b32 v144, v66, v148, s45
v_perm_b32 v145, v70, v149, s45
v_perm_b32 v148, v66, v148, s46
v_perm_b32 v149, v70, v149, s46
s_waitcnt vmcnt(33)
v_cndmask_b32_dpp v150, v74, v72, vcc row_ror:8 row_mask:0xf bank_mask:0xf
s_waitcnt vmcnt(32)
v_cndmask_b32_dpp v151, v78, v76, vcc row_ror:8 row_mask:0xf bank_mask:0xf
v_mov_b32_dpp v74, v72 row_ror:8 row_mask:0xf bank_mask:0x3
v_mov_b32_dpp v78, v76 row_ror:8 row_mask:0xf bank_mask:0x3
v_perm_b32 v146, v74, v150, s45
v_perm_b32 v147, v78, v151, s45
v_perm_b32 v150, v74, v150, s46
v_perm_b32 v151, v78, v151, s46
s_waitcnt lgkmcnt(3)
v_mfma_f32_16x16x32_bf16 v[0:3], v[144:147], v[160:163], 0
v_cndmask_b32_dpp v156, v67, v65, vcc row_ror:8 row_mask:0xf bank_mask:0xf
v_cndmask_b32_dpp v157, v71, v69, vcc row_ror:8 row_mask:0xf bank_mask:0xf
s_waitcnt lgkmcnt(2)
v_mfma_f32_16x16x32_bf16 v[4:7], v[144:147], v[164:167], 0
v_mov_b32_dpp v67, v65 row_ror:8 row_mask:0xf bank_mask:0x3
v_mov_b32_dpp v71, v69 row_ror:8 row_mask:0xf bank_mask:0x3
s_waitcnt lgkmcnt(1)
v_mfma_f32_16x16x32_bf16 v[8:11], v[144:147], v[168:171], 0
v_perm_b32 v152, v67, v156, s45
v_perm_b32 v153, v71, v157, s45
s_waitcnt lgkmcnt(0)
v_mfma_f32_16x16x32_bf16 v[12:15], v[144:147], v[172:175], 0
v_perm_b32 v156, v67, v156, s46
v_perm_b32 v157, v71, v157, s46
v_mfma_f32_16x16x32_bf16 v[16:19], v[148:151], v[160:163], 0
v_cndmask_b32_dpp v158, v75, v73, vcc row_ror:8 row_mask:0xf bank_mask:0xf
v_cndmask_b32_dpp v159, v79, v77, vcc row_ror:8 row_mask:0xf bank_mask:0xf
v_mfma_f32_16x16x32_bf16 v[20:23], v[148:151], v[164:167], 0
v_mov_b32_dpp v75, v73 row_ror:8 row_mask:0xf bank_mask:0x3
v_mov_b32_dpp v79, v77 row_ror:8 row_mask:0xf bank_mask:0x3
v_mfma_f32_16x16x32_bf16 v[24:27], v[148:151], v[168:171], 0
v_perm_b32 v154, v75, v158, s45
v_perm_b32 v155, v79, v159, s45
v_mfma_f32_16x16x32_bf16 v[28:31], v[148:151], v[172:175], 0
v_perm_b32 v158, v75, v158, s46
v_perm_b32 v159, v79, v159, s46
v_mfma_f32_16x16x32_bf16 v[32:35], v[152:155], v[160:163], 0
v_xor_b32 v251, 262144, v251
buffer_load_dwordx4 v[64:67], v251, s[20:23], 0 offen
buffer_load_dwordx4 v[68:71], v251, s[20:23], s96 offen
buffer_load_dwordx4 v[72:75], v251, s[20:23], s97 offen
buffer_load_dwordx4 v[76:79], v251, s[20:23], s98 offen
s_waitcnt vmcnt(11)
v_cndmask_b32_dpp v148, v82, v80, vcc row_ror:8 row_mask:0xf bank_mask:0xf
s_waitcnt vmcnt(10)
v_cndmask_b32_dpp v149, v86, v84, vcc row_ror:8 row_mask:0xf bank_mask:0xf
v_mfma_f32_16x16x32_bf16 v[48:51], v[156:159], v[160:163], 0
v_xor_b32 v253, 64, v253
v_xor_b32 v254, 64, v254
ds_read_b128 v[160:163], v253 offset:24576
v_mov_b32_dpp v82, v80 row_ror:8 row_mask:0xf bank_mask:0x3
v_mov_b32_dpp v86, v84 row_ror:8 row_mask:0xf bank_mask:0x3
v_mfma_f32_16x16x32_bf16 v[36:39], v[152:155], v[164:167], 0
v_perm_b32 v144, v82, v148, s45
v_perm_b32 v145, v86, v149, s45
v_mfma_f32_16x16x32_bf16 v[52:55], v[156:159], v[164:167], 0
ds_read_b128 v[164:167], v253 offset:26624
v_perm_b32 v148, v82, v148, s46
v_perm_b32 v149, v86, v149, s46
v_mfma_f32_16x16x32_bf16 v[40:43], v[152:155], v[168:171], 0
s_waitcnt vmcnt(9)
v_cndmask_b32_dpp v150, v90, v88, vcc row_ror:8 row_mask:0xf bank_mask:0xf
s_waitcnt vmcnt(8)
v_cndmask_b32_dpp v151, v94, v92, vcc row_ror:8 row_mask:0xf bank_mask:0xf
v_mfma_f32_16x16x32_bf16 v[56:59], v[156:159], v[168:171], 0
ds_read_b128 v[168:171], v254 offset:24576
v_mov_b32_dpp v90, v88 row_ror:8 row_mask:0xf bank_mask:0x3
v_mov_b32_dpp v94, v92 row_ror:8 row_mask:0xf bank_mask:0x3
v_mfma_f32_16x16x32_bf16 v[44:47], v[152:155], v[172:175], 0
v_perm_b32 v146, v90, v150, s45
v_perm_b32 v147, v94, v151, s45
v_mfma_f32_16x16x32_bf16 v[60:63], v[156:159], v[172:175], 0
ds_read_b128 v[172:175], v254 offset:26624
v_perm_b32 v150, v90, v150, s46
v_perm_b32 v151, v94, v151, s46
s_add_u32 s52, s44, 4
s_and_b32 s52, s52, 7
s_lshl_b32 s52, s52, 7
s_add_u32 m0, s50, 32768
s_nop 0
buffer_load_dwordx4 v248, s[8:11], s52 offen  lds
s_add_u32 s52, s44, 5
s_and_b32 s52, s52, 7
s_lshl_b32 s52, s52, 7
s_add_u32 m0, s50, 73728
s_nop 0
buffer_load_dwordx4 v248, s[8:11], s52 offen  lds
s_add_u32 s52, s44, 6
s_and_b32 s52, s52, 7
s_lshl_b32 s52, s52, 7
s_add_u32 m0, s50, 114688
s_nop 0
buffer_load_dwordx4 v248, s[8:11], s52 offen  lds
s_add_u32 s52, s44, 7
s_and_b32 s52, s52, 7
s_lshl_b32 s52, s52, 7
s_add_u32 m0, s50, 155648
s_nop 0
buffer_load_dwordx4 v248, s[8:11], s52 offen  lds
s_waitcnt lgkmcnt(3)
v_mfma_f32_16x16x32_bf16 v[0:3], v[144:147], v[160:163], v[0:3]
v_cndmask_b32_dpp v156, v83, v81, vcc row_ror:8 row_mask:0xf bank_mask:0xf
v_cndmask_b32_dpp v157, v87, v85, vcc row_ror:8 row_mask:0xf bank_mask:0xf
s_waitcnt lgkmcnt(2)
v_mfma_f32_16x16x32_bf16 v[4:7], v[144:147], v[164:167], v[4:7]
v_mov_b32_dpp v83, v81 row_ror:8 row_mask:0xf bank_mask:0x3
v_mov_b32_dpp v87, v85 row_ror:8 row_mask:0xf bank_mask:0x3
s_waitcnt lgkmcnt(1)
v_mfma_f32_16x16x32_bf16 v[8:11], v[144:147], v[168:171], v[8:11]
v_perm_b32 v152, v83, v156, s45
v_perm_b32 v153, v87, v157, s45
s_waitcnt lgkmcnt(0)
v_mfma_f32_16x16x32_bf16 v[12:15], v[144:147], v[172:175], v[12:15]
v_perm_b32 v156, v83, v156, s46
v_perm_b32 v157, v87, v157, s46
v_mfma_f32_16x16x32_bf16 v[16:19], v[148:151], v[160:163], v[16:19]
v_cndmask_b32_dpp v158, v91, v89, vcc row_ror:8 row_mask:0xf bank_mask:0xf
v_cndmask_b32_dpp v159, v95, v93, vcc row_ror:8 row_mask:0xf bank_mask:0xf
v_mfma_f32_16x16x32_bf16 v[20:23], v[148:151], v[164:167], v[20:23]
v_mov_b32_dpp v91, v89 row_ror:8 row_mask:0xf bank_mask:0x3
v_mov_b32_dpp v95, v93 row_ror:8 row_mask:0xf bank_mask:0x3
v_mfma_f32_16x16x32_bf16 v[24:27], v[148:151], v[168:171], v[24:27]
v_perm_b32 v154, v91, v158, s45
v_perm_b32 v155, v95, v159, s45
v_mfma_f32_16x16x32_bf16 v[28:31], v[148:151], v[172:175], v[28:31]
v_perm_b32 v158, v91, v158, s46
v_perm_b32 v159, v95, v159, s46
v_mfma_f32_16x16x32_bf16 v[32:35], v[152:155], v[160:163], v[32:35]
s_add_u32 s61, s61, 524288
s_and_b32 s61, s61, 4194303
v_add_u32 v251, s61, v252
buffer_load_dwordx4 v[80:83], v251, s[20:23], 0 offen
buffer_load_dwordx4 v[84:87], v251, s[20:23], s96 offen
buffer_load_dwordx4 v[88:91], v251, s[20:23], s97 offen
buffer_load_dwordx4 v[92:95], v251, s[20:23], s98 offen
s_waitcnt vmcnt(15)
v_cndmask_b32_dpp v148, v98, v96, vcc row_ror:8 row_mask:0xf bank_mask:0xf
s_waitcnt vmcnt(14)
v_cndmask_b32_dpp v149, v102, v100, vcc row_ror:8 row_mask:0xf bank_mask:0xf
v_mfma_f32_16x16x32_bf16 v[48:51], v[156:159], v[160:163], v[48:51]
v_xor_b32 v253, 64, v253
v_add_u32 v253, 65536, v253
v_xor_b32 v254, 64, v254
v_add_u32 v254, 65536, v254
ds_read_b128 v[160:163], v253 offset:0
v_mov_b32_dpp v98, v96 row_ror:8 row_mask:0xf bank_mask:0x3
v_mov_b32_dpp v102, v100 row_ror:8 row_mask:0xf bank_mask:0x3
v_mfma_f32_16x16x32_bf16 v[36:39], v[152:155], v[164:167], v[36:39]
v_perm_b32 v144, v98, v148, s45
v_perm_b32 v145, v102, v149, s45
v_mfma_f32_16x16x32_bf16 v[52:55], v[156:159], v[164:167], v[52:55]
ds_read_b128 v[164:167], v253 offset:2048
v_perm_b32 v148, v98, v148, s46
v_perm_b32 v149, v102, v149, s46
v_mfma_f32_16x16x32_bf16 v[40:43], v[152:155], v[168:171], v[40:43]
s_waitcnt vmcnt(13)
v_cndmask_b32_dpp v150, v106, v104, vcc row_ror:8 row_mask:0xf bank_mask:0xf
s_waitcnt vmcnt(12)
v_cndmask_b32_dpp v151, v110, v108, vcc row_ror:8 row_mask:0xf bank_mask:0xf
v_mfma_f32_16x16x32_bf16 v[56:59], v[156:159], v[168:171], v[56:59]
ds_read_b128 v[168:171], v254 offset:0
v_mov_b32_dpp v106, v104 row_ror:8 row_mask:0xf bank_mask:0x3
v_mov_b32_dpp v110, v108 row_ror:8 row_mask:0xf bank_mask:0x3
v_mfma_f32_16x16x32_bf16 v[44:47], v[152:155], v[172:175], v[44:47]
v_perm_b32 v146, v106, v150, s45
v_perm_b32 v147, v110, v151, s45
v_mfma_f32_16x16x32_bf16 v[60:63], v[156:159], v[172:175], v[60:63]
ds_read_b128 v[172:175], v254 offset:2048
v_perm_b32 v150, v106, v150, s46
v_perm_b32 v151, v110, v151, s46
s_waitcnt lgkmcnt(3)
v_mfma_f32_16x16x32_bf16 v[0:3], v[144:147], v[160:163], v[0:3]
v_cndmask_b32_dpp v156, v99, v97, vcc row_ror:8 row_mask:0xf bank_mask:0xf
v_cndmask_b32_dpp v157, v103, v101, vcc row_ror:8 row_mask:0xf bank_mask:0xf
s_waitcnt lgkmcnt(2)
v_mfma_f32_16x16x32_bf16 v[4:7], v[144:147], v[164:167], v[4:7]
v_mov_b32_dpp v99, v97 row_ror:8 row_mask:0xf bank_mask:0x3
v_mov_b32_dpp v103, v101 row_ror:8 row_mask:0xf bank_mask:0x3
s_waitcnt lgkmcnt(1)
v_mfma_f32_16x16x32_bf16 v[8:11], v[144:147], v[168:171], v[8:11]
v_perm_b32 v152, v99, v156, s45
v_perm_b32 v153, v103, v157, s45
s_waitcnt lgkmcnt(0)
v_mfma_f32_16x16x32_bf16 v[12:15], v[144:147], v[172:175], v[12:15]
v_perm_b32 v156, v99, v156, s46
v_perm_b32 v157, v103, v157, s46
v_mfma_f32_16x16x32_bf16 v[16:19], v[148:151], v[160:163], v[16:19]
v_cndmask_b32_dpp v158, v107, v105, vcc row_ror:8 row_mask:0xf bank_mask:0xf
v_cndmask_b32_dpp v159, v111, v109, vcc row_ror:8 row_mask:0xf bank_mask:0xf
v_mfma_f32_16x16x32_bf16 v[20:23], v[148:151], v[164:167], v[20:23]
v_mov_b32_dpp v107, v105 row_ror:8 row_mask:0xf bank_mask:0x3
v_mov_b32_dpp v111, v109 row_ror:8 row_mask:0xf bank_mask:0x3
v_mfma_f32_16x16x32_bf16 v[24:27], v[148:151], v[168:171], v[24:27]
v_perm_b32 v154, v107, v158, s45
v_perm_b32 v155, v111, v159, s45
v_mfma_f32_16x16x32_bf16 v[28:31], v[148:151], v[172:175], v[28:31]
v_perm_b32 v158, v107, v158, s46
v_perm_b32 v159, v111, v159, s46
v_mfma_f32_16x16x32_bf16 v[32:35], v[152:155], v[160:163], v[32:35]
v_xor_b32 v251, 262144, v251
buffer_load_dwordx4 v[96:99], v251, s[20:23], 0 offen
buffer_load_dwordx4 v[100:103], v251, s[20:23], s96 offen
buffer_load_dwordx4 v[104:107], v251, s[20:23], s97 offen
buffer_load_dwordx4 v[108:111], v251, s[20:23], s98 offen
s_waitcnt vmcnt(15)
v_cndmask_b32_dpp v148, v66, v64, vcc row_ror:8 row_mask:0xf bank_mask:0xf
s_waitcnt vmcnt(14)
v_cndmask_b32_dpp v149, v70, v68, vcc row_ror:8 row_mask:0xf bank_mask:0xf
v_mfma_f32_16x16x32_bf16 v[48:51], v[156:159], v[160:163], v[48:51]
v_xor_b32 v253, 64, v253
v_xor_b32 v254, 64, v254
ds_read_b128 v[160:163], v253 offset:0
v_mov_b32_dpp v66, v64 row_ror:8 row_mask:0xf bank_mask:0x3
v_mov_b32_dpp v70, v68 row_ror:8 row_mask:0xf bank_mask:0x3
v_mfma_f32_16x16x32_bf16 v[36:39], v[152:155], v[164:167], v[36:39]
v_perm_b32 v144, v66, v148, s45
v_perm_b32 v145, v70, v149, s45
v_mfma_f32_16x16x32_bf16 v[52:55], v[156:159], v[164:167], v[52:55]
ds_read_b128 v[164:167], v253 offset:2048
v_perm_b32 v148, v66, v148, s46
v_perm_b32 v149, v70, v149, s46
v_mfma_f32_16x16x32_bf16 v[40:43], v[152:155], v[168:171], v[40:43]
s_waitcnt vmcnt(13)
v_cndmask_b32_dpp v150, v74, v72, vcc row_ror:8 row_mask:0xf bank_mask:0xf
s_waitcnt vmcnt(12)
v_cndmask_b32_dpp v151, v78, v76, vcc row_ror:8 row_mask:0xf bank_mask:0xf
v_mfma_f32_16x16x32_bf16 v[56:59], v[156:159], v[168:171], v[56:59]
ds_read_b128 v[168:171], v254 offset:0
v_mov_b32_dpp v74, v72 row_ror:8 row_mask:0xf bank_mask:0x3
v_mov_b32_dpp v78, v76 row_ror:8 row_mask:0xf bank_mask:0x3
v_mfma_f32_16x16x32_bf16 v[44:47], v[152:155], v[172:175], v[44:47]
v_perm_b32 v146, v74, v150, s45
v_perm_b32 v147, v78, v151, s45
v_mfma_f32_16x16x32_bf16 v[60:63], v[156:159], v[172:175], v[60:63]
ds_read_b128 v[172:175], v254 offset:2048
v_perm_b32 v150, v74, v150, s46
v_perm_b32 v151, v78, v151, s46
s_lshl_b32 s52, s51, 11
s_lshr_b32 s53, s50, 2
s_add_u32 s52, s52, s53
s_add_u32 s52, s52, 16777216
s_lshl_b32 s53, s41, 2
s_add_u32 s52, s52, s53
v_min_u32 v228, 1, v255
v_lshlrev_b32 v228, 30, v228
v_mov_b32 v224, 0
buffer_store_dword v224, v228, s[28:31], s52 offen sc1
s_waitcnt lgkmcnt(3)
v_mfma_f32_16x16x32_bf16 v[0:3], v[144:147], v[160:163], v[0:3]
v_cndmask_b32_dpp v156, v67, v65, vcc row_ror:8 row_mask:0xf bank_mask:0xf
v_cndmask_b32_dpp v157, v71, v69, vcc row_ror:8 row_mask:0xf bank_mask:0xf
s_waitcnt lgkmcnt(2)
v_mfma_f32_16x16x32_bf16 v[4:7], v[144:147], v[164:167], v[4:7]
v_mov_b32_dpp v67, v65 row_ror:8 row_mask:0xf bank_mask:0x3
v_mov_b32_dpp v71, v69 row_ror:8 row_mask:0xf bank_mask:0x3
s_waitcnt lgkmcnt(1)
v_mfma_f32_16x16x32_bf16 v[8:11], v[144:147], v[168:171], v[8:11]
v_perm_b32 v152, v67, v156, s45
v_perm_b32 v153, v71, v157, s45
s_waitcnt lgkmcnt(0)
v_mfma_f32_16x16x32_bf16 v[12:15], v[144:147], v[172:175], v[12:15]
v_perm_b32 v156, v67, v156, s46
v_perm_b32 v157, v71, v157, s46
v_mfma_f32_16x16x32_bf16 v[16:19], v[148:151], v[160:163], v[16:19]
v_cndmask_b32_dpp v158, v75, v73, vcc row_ror:8 row_mask:0xf bank_mask:0xf
v_cndmask_b32_dpp v159, v79, v77, vcc row_ror:8 row_mask:0xf bank_mask:0xf
v_mfma_f32_16x16x32_bf16 v[20:23], v[148:151], v[164:167], v[20:23]
v_mov_b32_dpp v75, v73 row_ror:8 row_mask:0xf bank_mask:0x3
v_mov_b32_dpp v79, v77 row_ror:8 row_mask:0xf bank_mask:0x3
v_mfma_f32_16x16x32_bf16 v[24:27], v[148:151], v[168:171], v[24:27]
v_perm_b32 v154, v75, v158, s45
v_perm_b32 v155, v79, v159, s45
v_mfma_f32_16x16x32_bf16 v[28:31], v[148:151], v[172:175], v[28:31]
v_perm_b32 v158, v75, v158, s46
v_perm_b32 v159, v79, v159, s46
v_mfma_f32_16x16x32_bf16 v[32:35], v[152:155], v[160:163], v[32:35]
s_add_u32 s61, s61, 524288
s_and_b32 s61, s61, 4194303
v_add_u32 v251, s61, v252
buffer_load_dwordx4 v[64:67], v251, s[20:23], 0 offen
buffer_load_dwordx4 v[68:71], v251, s[20:23], s96 offen
buffer_load_dwordx4 v[72:75], v251, s[20:23], s97 offen
buffer_load_dwordx4 v[76:79], v251, s[20:23], s98 offen
s_waitcnt vmcnt(12)
v_cndmask_b32_dpp v148, v82, v80, vcc row_ror:8 row_mask:0xf bank_mask:0xf
s_waitcnt vmcnt(11)
v_cndmask_b32_dpp v149, v86, v84, vcc row_ror:8 row_mask:0xf bank_mask:0xf
v_mfma_f32_16x16x32_bf16 v[48:51], v[156:159], v[160:163], v[48:51]
v_xor_b32 v253, 64, v253
v_xor_b32 v254, 64, v254
ds_read_b128 v[160:163], v253 offset:40960
v_mov_b32_dpp v82, v80 row_ror:8 row_mask:0xf bank_mask:0x3
v_mov_b32_dpp v86, v84 row_ror:8 row_mask:0xf bank_mask:0x3
v_mfma_f32_16x16x32_bf16 v[36:39], v[152:155], v[164:167], v[36:39]
v_perm_b32 v144, v82, v148, s45
v_perm_b32 v145, v86, v149, s45
v_mfma_f32_16x16x32_bf16 v[52:55], v[156:159], v[164:167], v[52:55]
ds_read_b128 v[164:167], v253 offset:43008
v_perm_b32 v148, v82, v148, s46
v_perm_b32 v149, v86, v149, s46
v_mfma_f32_16x16x32_bf16 v[40:43], v[152:155], v[168:171], v[40:43]
s_waitcnt vmcnt(10)
v_cndmask_b32_dpp v150, v90, v88, vcc row_ror:8 row_mask:0xf bank_mask:0xf
s_waitcnt vmcnt(9)
v_cndmask_b32_dpp v151, v94, v92, vcc row_ror:8 row_mask:0xf bank_mask:0xf
v_mfma_f32_16x16x32_bf16 v[56:59], v[156:159], v[168:171], v[56:59]
ds_read_b128 v[168:171], v254 offset:40960
v_mov_b32_dpp v90, v88 row_ror:8 row_mask:0xf bank_mask:0x3
v_mov_b32_dpp v94, v92 row_ror:8 row_mask:0xf bank_mask:0x3
v_mfma_f32_16x16x32_bf16 v[44:47], v[152:155], v[172:175], v[44:47]
v_perm_b32 v146, v90, v150, s45
v_perm_b32 v147, v94, v151, s45
v_mfma_f32_16x16x32_bf16 v[60:63], v[156:159], v[172:175], v[60:63]
ds_read_b128 v[172:175], v254 offset:43008
v_perm_b32 v150, v90, v150, s46
v_perm_b32 v151, v94, v151, s46
s_waitcnt lgkmcnt(3)
v_mfma_f32_16x16x32_bf16 v[0:3], v[144:147], v[160:163], v[0:3]
v_cndmask_b32_dpp v156, v83, v81, vcc row_ror:8 row_mask:0xf bank_mask:0xf
v_cndmask_b32_dpp v157, v87, v85, vcc row_ror:8 row_mask:0xf bank_mask:0xf
s_waitcnt lgkmcnt(2)
v_mfma_f32_16x16x32_bf16 v[4:7], v[144:147], v[164:167], v[4:7]
v_mov_b32_dpp v83, v81 row_ror:8 row_mask:0xf bank_mask:0x3
v_mov_b32_dpp v87, v85 row_ror:8 row_mask:0xf bank_mask:0x3
s_waitcnt lgkmcnt(1)
v_mfma_f32_16x16x32_bf16 v[8:11], v[144:147], v[168:171], v[8:11]
v_perm_b32 v152, v83, v156, s45
v_perm_b32 v153, v87, v157, s45
s_waitcnt lgkmcnt(0)
v_mfma_f32_16x16x32_bf16 v[12:15], v[144:147], v[172:175], v[12:15]
v_perm_b32 v156, v83, v156, s46
v_perm_b32 v157, v87, v157, s46
v_mfma_f32_16x16x32_bf16 v[16:19], v[148:151], v[160:163], v[16:19]
v_cndmask_b32_dpp v158, v91, v89, vcc row_ror:8 row_mask:0xf bank_mask:0xf
v_cndmask_b32_dpp v159, v95, v93, vcc row_ror:8 row_mask:0xf bank_mask:0xf
v_mfma_f32_16x16x32_bf16 v[20:23], v[148:151], v[164:167], v[20:23]
v_mov_b32_dpp v91, v89 row_ror:8 row_mask:0xf bank_mask:0x3
v_mov_b32_dpp v95, v93 row_ror:8 row_mask:0xf bank_mask:0x3
v_mfma_f32_16x16x32_bf16 v[24:27], v[148:151], v[168:171], v[24:27]
v_perm_b32 v154, v91, v158, s45
v_perm_b32 v155, v95, v159, s45
v_mfma_f32_16x16x32_bf16 v[28:31], v[148:151], v[172:175], v[28:31]
v_perm_b32 v158, v91, v158, s46
v_perm_b32 v159, v95, v159, s46
v_mfma_f32_16x16x32_bf16 v[32:35], v[152:155], v[160:163], v[32:35]
v_xor_b32 v251, 262144, v251
buffer_load_dwordx4 v[80:83], v251, s[20:23], 0 offen
buffer_load_dwordx4 v[84:87], v251, s[20:23], s96 offen
buffer_load_dwordx4 v[88:91], v251, s[20:23], s97 offen
buffer_load_dwordx4 v[92:95], v251, s[20:23], s98 offen
s_waitcnt vmcnt(12)
v_cndmask_b32_dpp v148, v98, v96, vcc row_ror:8 row_mask:0xf bank_mask:0xf
s_waitcnt vmcnt(11)
v_cndmask_b32_dpp v149, v102, v100, vcc row_ror:8 row_mask:0xf bank_mask:0xf
v_mfma_f32_16x16x32_bf16 v[48:51], v[156:159], v[160:163], v[48:51]
v_xor_b32 v253, 64, v253
v_xor_b32 v254, 64, v254
ds_read_b128 v[160:163], v253 offset:40960
v_mov_b32_dpp v98, v96 row_ror:8 row_mask:0xf bank_mask:0x3
v_mov_b32_dpp v102, v100 row_ror:8 row_mask:0xf bank_mask:0x3
v_mfma_f32_16x16x32_bf16 v[36:39], v[152:155], v[164:167], v[36:39]
v_perm_b32 v144, v98, v148, s45
v_perm_b32 v145, v102, v149, s45
v_mfma_f32_16x16x32_bf16 v[52:55], v[156:159], v[164:167], v[52:55]
ds_read_b128 v[164:167], v253 offset:43008
v_perm_b32 v148, v98, v148, s46
v_perm_b32 v149, v102, v149, s46
v_mfma_f32_16x16x32_bf16 v[40:43], v[152:155], v[168:171], v[40:43]
s_waitcnt vmcnt(10)
v_cndmask_b32_dpp v150, v106, v104, vcc row_ror:8 row_mask:0xf bank_mask:0xf
s_waitcnt vmcnt(9)
v_cndmask_b32_dpp v151, v110, v108, vcc row_ror:8 row_mask:0xf bank_mask:0xf
v_mfma_f32_16x16x32_bf16 v[56:59], v[156:159], v[168:171], v[56:59]
ds_read_b128 v[168:171], v254 offset:40960
v_mov_b32_dpp v106, v104 row_ror:8 row_mask:0xf bank_mask:0x3
v_mov_b32_dpp v110, v108 row_ror:8 row_mask:0xf bank_mask:0x3
v_mfma_f32_16x16x32_bf16 v[44:47], v[152:155], v[172:175], v[44:47]
v_perm_b32 v146, v106, v150, s45
v_perm_b32 v147, v110, v151, s45
v_mfma_f32_16x16x32_bf16 v[60:63], v[156:159], v[172:175], v[60:63]
ds_read_b128 v[172:175], v254 offset:43008
v_perm_b32 v150, v106, v150, s46
v_perm_b32 v151, v110, v151, s46
s_waitcnt lgkmcnt(3)
v_mfma_f32_16x16x32_bf16 v[0:3], v[144:147], v[160:163], v[0:3]
v_cndmask_b32_dpp v156, v99, v97, vcc row_ror:8 row_mask:0xf bank_mask:0xf
v_cndmask_b32_dpp v157, v103, v101, vcc row_ror:8 row_mask:0xf bank_mask:0xf
s_waitcnt lgkmcnt(2)
v_mfma_f32_16x16x32_bf16 v[4:7], v[144:147], v[164:167], v[4:7]
v_mov_b32_dpp v99, v97 row_ror:8 row_mask:0xf bank_mask:0x3
v_mov_b32_dpp v103, v101 row_ror:8 row_mask:0xf bank_mask:0x3
s_waitcnt lgkmcnt(1)
v_mfma_f32_16x16x32_bf16 v[8:11], v[144:147], v[168:171], v[8:11]
v_perm_b32 v152, v99, v156, s45
v_perm_b32 v153, v103, v157, s45
s_waitcnt lgkmcnt(0)
v_mfma_f32_16x16x32_bf16 v[12:15], v[144:147], v[172:175], v[12:15]
v_perm_b32 v156, v99, v156, s46
v_perm_b32 v157, v103, v157, s46
v_mfma_f32_16x16x32_bf16 v[16:19], v[148:151], v[160:163], v[16:19]
v_cndmask_b32_dpp v158, v107, v105, vcc row_ror:8 row_mask:0xf bank_mask:0xf
v_cndmask_b32_dpp v159, v111, v109, vcc row_ror:8 row_mask:0xf bank_mask:0xf
v_mfma_f32_16x16x32_bf16 v[20:23], v[148:151], v[164:167], v[20:23]
v_mov_b32_dpp v107, v105 row_ror:8 row_mask:0xf bank_mask:0x3
v_mov_b32_dpp v111, v109 row_ror:8 row_mask:0xf bank_mask:0x3
v_mfma_f32_16x16x32_bf16 v[24:27], v[148:151], v[168:171], v[24:27]
v_perm_b32 v154, v107, v158, s45
v_perm_b32 v155, v111, v159, s45
v_mfma_f32_16x16x32_bf16 v[28:31], v[148:151], v[172:175], v[28:31]
v_perm_b32 v158, v107, v158, s46
v_perm_b32 v159, v111, v159, s46
v_mfma_f32_16x16x32_bf16 v[32:35], v[152:155], v[160:163], v[32:35]
s_add_u32 s61, s61, 524288
s_and_b32 s61, s61, 4194303
v_add_u32 v251, s61, v252
buffer_load_dwordx4 v[96:99], v251, s[20:23], 0 offen
buffer_load_dwordx4 v[100:103], v251, s[20:23], s96 offen
buffer_load_dwordx4 v[104:107], v251, s[20:23], s97 offen
buffer_load_dwordx4 v[108:111], v251, s[20:23], s98 offen
s_waitcnt vmcnt(11)
v_cndmask_b32_dpp v148, v66, v64, vcc row_ror:8 row_mask:0xf bank_mask:0xf
s_waitcnt vmcnt(10)
v_cndmask_b32_dpp v149, v70, v68, vcc row_ror:8 row_mask:0xf bank_mask:0xf
v_mfma_f32_16x16x32_bf16 v[48:51], v[156:159], v[160:163], v[48:51]
v_xor_b32 v253, 64, v253
v_add_u32 v253, 81920, v253
v_xor_b32 v254, 64, v254
v_add_u32 v254, 81920, v254
ds_read_b128 v[160:163], v253 offset:0
v_mov_b32_dpp v66, v64 row_ror:8 row_mask:0xf bank_mask:0x3
v_mov_b32_dpp v70, v68 row_ror:8 row_mask:0xf bank_mask:0x3
v_mfma_f32_16x16x32_bf16 v[36:39], v[152:155], v[164:167], v[36:39]
v_perm_b32 v144, v66, v148, s45
v_perm_b32 v145, v70, v149, s45
v_mfma_f32_16x16x32_bf16 v[52:55], v[156:159], v[164:167], v[52:55]
ds_read_b128 v[164:167], v253 offset:2048
v_perm_b32 v148, v66, v148, s46
v_perm_b32 v149, v70, v149, s46
v_mfma_f32_16x16x32_bf16 v[40:43], v[152:155], v[168:171], v[40:43]
s_waitcnt vmcnt(9)
v_cndmask_b32_dpp v150, v74, v72, vcc row_ror:8 row_mask:0xf bank_mask:0xf
s_waitcnt vmcnt(8)
v_cndmask_b32_dpp v151, v78, v76, vcc row_ror:8 row_mask:0xf bank_mask:0xf
v_mfma_f32_16x16x32_bf16 v[56:59], v[156:159], v[168:171], v[56:59]
ds_read_b128 v[168:171], v254 offset:0
v_mov_b32_dpp v74, v72 row_ror:8 row_mask:0xf bank_mask:0x3
v_mov_b32_dpp v78, v76 row_ror:8 row_mask:0xf bank_mask:0x3
v_mfma_f32_16x16x32_bf16 v[44:47], v[152:155], v[172:175], v[44:47]
v_perm_b32 v146, v74, v150, s45
v_perm_b32 v147, v78, v151, s45
v_mfma_f32_16x16x32_bf16 v[60:63], v[156:159], v[172:175], v[60:63]
ds_read_b128 v[172:175], v254 offset:2048
v_perm_b32 v150, v74, v150, s46
v_perm_b32 v151, v78, v151, s46
s_waitcnt lgkmcnt(3)
v_mfma_f32_16x16x32_bf16 v[0:3], v[144:147], v[160:163], v[0:3]
v_cndmask_b32_dpp v156, v67, v65, vcc row_ror:8 row_mask:0xf bank_mask:0xf
v_cndmask_b32_dpp v157, v71, v69, vcc row_ror:8 row_mask:0xf bank_mask:0xf
s_waitcnt lgkmcnt(2)
v_mfma_f32_16x16x32_bf16 v[4:7], v[144:147], v[164:167], v[4:7]
v_mov_b32_dpp v67, v65 row_ror:8 row_mask:0xf bank_mask:0x3
v_mov_b32_dpp v71, v69 row_ror:8 row_mask:0xf bank_mask:0x3
s_waitcnt lgkmcnt(1)
v_mfma_f32_16x16x32_bf16 v[8:11], v[144:147], v[168:171], v[8:11]
v_perm_b32 v152, v67, v156, s45
v_perm_b32 v153, v71, v157, s45
s_waitcnt lgkmcnt(0)
v_mfma_f32_16x16x32_bf16 v[12:15], v[144:147], v[172:175], v[12:15]
v_perm_b32 v156, v67, v156, s46
v_perm_b32 v157, v71, v157, s46
v_mfma_f32_16x16x32_bf16 v[16:19], v[148:151], v[160:163], v[16:19]
v_cndmask_b32_dpp v158, v75, v73, vcc row_ror:8 row_mask:0xf bank_mask:0xf
v_cndmask_b32_dpp v159, v79, v77, vcc row_ror:8 row_mask:0xf bank_mask:0xf
v_mfma_f32_16x16x32_bf16 v[20:23], v[148:151], v[164:167], v[20:23]
v_mov_b32_dpp v75, v73 row_ror:8 row_mask:0xf bank_mask:0x3
v_mov_b32_dpp v79, v77 row_ror:8 row_mask:0xf bank_mask:0x3
v_mfma_f32_16x16x32_bf16 v[24:27], v[148:151], v[168:171], v[24:27]
v_perm_b32 v154, v75, v158, s45
v_perm_b32 v155, v79, v159, s45
v_mfma_f32_16x16x32_bf16 v[28:31], v[148:151], v[172:175], v[28:31]
v_perm_b32 v158, v75, v158, s46
v_perm_b32 v159, v79, v159, s46
v_mfma_f32_16x16x32_bf16 v[32:35], v[152:155], v[160:163], v[32:35]
v_xor_b32 v251, 262144, v251
buffer_load_dwordx4 v[64:67], v251, s[20:23], 0 offen
buffer_load_dwordx4 v[68:71], v251, s[20:23], s96 offen
buffer_load_dwordx4 v[72:75], v251, s[20:23], s97 offen
buffer_load_dwordx4 v[76:79], v251, s[20:23], s98 offen
s_waitcnt vmcnt(11)
v_cndmask_b32_dpp v148, v82, v80, vcc row_ror:8 row_mask:0xf bank_mask:0xf
s_waitcnt vmcnt(10)
v_cndmask_b32_dpp v149, v86, v84, vcc row_ror:8 row_mask:0xf bank_mask:0xf
v_mfma_f32_16x16x32_bf16 v[48:51], v[156:159], v[160:163], v[48:51]
v_xor_b32 v253, 64, v253
v_xor_b32 v254, 64, v254
ds_read_b128 v[160:163], v253 offset:0
v_mov_b32_dpp v82, v80 row_ror:8 row_mask:0xf bank_mask:0x3
v_mov_b32_dpp v86, v84 row_ror:8 row_mask:0xf bank_mask:0x3
v_mfma_f32_16x16x32_bf16 v[36:39], v[152:155], v[164:167], v[36:39]
v_perm_b32 v144, v82, v148, s45
v_perm_b32 v145, v86, v149, s45
v_mfma_f32_16x16x32_bf16 v[52:55], v[156:159], v[164:167], v[52:55]
ds_read_b128 v[164:167], v253 offset:2048
v_perm_b32 v148, v82, v148, s46
v_perm_b32 v149, v86, v149, s46
v_mfma_f32_16x16x32_bf16 v[40:43], v[152:155], v[168:171], v[40:43]
s_waitcnt vmcnt(9)
v_cndmask_b32_dpp v150, v90, v88, vcc row_ror:8 row_mask:0xf bank_mask:0xf
s_waitcnt vmcnt(8)
v_cndmask_b32_dpp v151, v94, v92, vcc row_ror:8 row_mask:0xf bank_mask:0xf
v_mfma_f32_16x16x32_bf16 v[56:59], v[156:159], v[168:171], v[56:59]
ds_read_b128 v[168:171], v254 offset:0
v_mov_b32_dpp v90, v88 row_ror:8 row_mask:0xf bank_mask:0x3
v_mov_b32_dpp v94, v92 row_ror:8 row_mask:0xf bank_mask:0x3
v_mfma_f32_16x16x32_bf16 v[44:47], v[152:155], v[172:175], v[44:47]
v_perm_b32 v146, v90, v150, s45
v_perm_b32 v147, v94, v151, s45
v_mfma_f32_16x16x32_bf16 v[60:63], v[156:159], v[172:175], v[60:63]
ds_read_b128 v[172:175], v254 offset:2048
v_perm_b32 v150, v90, v150, s46
v_perm_b32 v151, v94, v151, s46
s_waitcnt lgkmcnt(3)
v_mfma_f32_16x16x32_bf16 v[0:3], v[144:147], v[160:163], v[0:3]
v_cndmask_b32_dpp v156, v83, v81, vcc row_ror:8 row_mask:0xf bank_mask:0xf
v_cndmask_b32_dpp v157, v87, v85, vcc row_ror:8 row_mask:0xf bank_mask:0xf
s_waitcnt lgkmcnt(2)
v_mfma_f32_16x16x32_bf16 v[4:7], v[144:147], v[164:167], v[4:7]
v_mov_b32_dpp v83, v81 row_ror:8 row_mask:0xf bank_mask:0x3
v_mov_b32_dpp v87, v85 row_ror:8 row_mask:0xf bank_mask:0x3
s_waitcnt lgkmcnt(1)
v_mfma_f32_16x16x32_bf16 v[8:11], v[144:147], v[168:171], v[8:11]
v_perm_b32 v152, v83, v156, s45
v_perm_b32 v153, v87, v157, s45
s_waitcnt lgkmcnt(0)
v_mfma_f32_16x16x32_bf16 v[12:15], v[144:147], v[172:175], v[12:15]
v_perm_b32 v156, v83, v156, s46
v_perm_b32 v157, v87, v157, s46
v_mfma_f32_16x16x32_bf16 v[16:19], v[148:151], v[160:163], v[16:19]
v_cndmask_b32_dpp v158, v91, v89, vcc row_ror:8 row_mask:0xf bank_mask:0xf
v_cndmask_b32_dpp v159, v95, v93, vcc row_ror:8 row_mask:0xf bank_mask:0xf
v_mfma_f32_16x16x32_bf16 v[20:23], v[148:151], v[164:167], v[20:23]
v_mov_b32_dpp v91, v89 row_ror:8 row_mask:0xf bank_mask:0x3
v_mov_b32_dpp v95, v93 row_ror:8 row_mask:0xf bank_mask:0x3
v_mfma_f32_16x16x32_bf16 v[24:27], v[148:151], v[168:171], v[24:27]
v_perm_b32 v154, v91, v158, s45
v_perm_b32 v155, v95, v159, s45
v_mfma_f32_16x16x32_bf16 v[28:31], v[148:151], v[172:175], v[28:31]
v_perm_b32 v158, v91, v158, s46
v_perm_b32 v159, v95, v159, s46
v_mfma_f32_16x16x32_bf16 v[32:35], v[152:155], v[160:163], v[32:35]
s_barrier
s_add_u32 s61, s61, 524288
s_and_b32 s61, s61, 4194303
v_add_u32 v251, s61, v252
buffer_load_dwordx4 v[80:83], v251, s[20:23], 0 offen
buffer_load_dwordx4 v[84:87], v251, s[20:23], s96 offen
buffer_load_dwordx4 v[88:91], v251, s[20:23], s97 offen
buffer_load_dwordx4 v[92:95], v251, s[20:23], s98 offen
s_waitcnt vmcnt(11)
v_cndmask_b32_dpp v148, v98, v96, vcc row_ror:8 row_mask:0xf bank_mask:0xf
s_waitcnt vmcnt(10)
v_cndmask_b32_dpp v149, v102, v100, vcc row_ror:8 row_mask:0xf bank_mask:0xf
v_mfma_f32_16x16x32_bf16 v[48:51], v[156:159], v[160:163], v[48:51]
v_xor_b32 v253, 64, v253
v_add_u32 v253, 4294852608, v253
v_xor_b32 v254, 64, v254
v_add_u32 v254, 4294852608, v254
ds_read_b128 v[160:163], v253 offset:0
v_mov_b32_dpp v98, v96 row_ror:8 row_mask:0xf bank_mask:0x3
v_mov_b32_dpp v102, v100 row_ror:8 row_mask:0xf bank_mask:0x3
v_mfma_f32_16x16x32_bf16 v[36:39], v[152:155], v[164:167], v[36:39]
v_perm_b32 v144, v98, v148, s45
v_perm_b32 v145, v102, v149, s45
v_mfma_f32_16x16x32_bf16 v[52:55], v[156:159], v[164:167], v[52:55]
ds_read_b128 v[164:167], v253 offset:2048
v_perm_b32 v148, v98, v148, s46
v_perm_b32 v149, v102, v149, s46
v_mfma_f32_16x16x32_bf16 v[40:43], v[152:155], v[168:171], v[40:43]
s_waitcnt vmcnt(9)
v_cndmask_b32_dpp v150, v106, v104, vcc row_ror:8 row_mask:0xf bank_mask:0xf
s_waitcnt vmcnt(8)
v_cndmask_b32_dpp v151, v110, v108, vcc row_ror:8 row_mask:0xf bank_mask:0xf
v_mfma_f32_16x16x32_bf16 v[56:59], v[156:159], v[168:171], v[56:59]
ds_read_b128 v[168:171], v254 offset:0
v_mov_b32_dpp v106, v104 row_ror:8 row_mask:0xf bank_mask:0x3
v_mov_b32_dpp v110, v108 row_ror:8 row_mask:0xf bank_mask:0x3
v_mfma_f32_16x16x32_bf16 v[44:47], v[152:155], v[172:175], v[44:47]
v_perm_b32 v146, v106, v150, s45
v_perm_b32 v147, v110, v151, s45
v_mfma_f32_16x16x32_bf16 v[60:63], v[156:159], v[172:175], v[60:63]
ds_read_b128 v[172:175], v254 offset:2048
v_perm_b32 v150, v106, v150, s46
v_perm_b32 v151, v110, v151, s46
s_waitcnt lgkmcnt(3)
v_mfma_f32_16x16x32_bf16 v[0:3], v[144:147], v[160:163], v[0:3]
v_cndmask_b32_dpp v156, v99, v97, vcc row_ror:8 row_mask:0xf bank_mask:0xf
v_cndmask_b32_dpp v157, v103, v101, vcc row_ror:8 row_mask:0xf bank_mask:0xf
s_waitcnt lgkmcnt(2)
v_mfma_f32_16x16x32_bf16 v[4:7], v[144:147], v[164:167], v[4:7]
v_mov_b32_dpp v99, v97 row_ror:8 row_mask:0xf bank_mask:0x3
v_mov_b32_dpp v103, v101 row_ror:8 row_mask:0xf bank_mask:0x3
s_waitcnt lgkmcnt(1)
v_mfma_f32_16x16x32_bf16 v[8:11], v[144:147], v[168:171], v[8:11]
v_perm_b32 v152, v99, v156, s45
v_perm_b32 v153, v103, v157, s45
s_waitcnt lgkmcnt(0)
v_mfma_f32_16x16x32_bf16 v[12:15], v[144:147], v[172:175], v[12:15]
v_perm_b32 v156, v99, v156, s46
v_perm_b32 v157, v103, v157, s46
v_mfma_f32_16x16x32_bf16 v[16:19], v[148:151], v[160:163], v[16:19]
v_cndmask_b32_dpp v158, v107, v105, vcc row_ror:8 row_mask:0xf bank_mask:0xf
v_cndmask_b32_dpp v159, v111, v109, vcc row_ror:8 row_mask:0xf bank_mask:0xf
v_mfma_f32_16x16x32_bf16 v[20:23], v[148:151], v[164:167], v[20:23]
v_mov_b32_dpp v107, v105 row_ror:8 row_mask:0xf bank_mask:0x3
v_mov_b32_dpp v111, v109 row_ror:8 row_mask:0xf bank_mask:0x3
v_mfma_f32_16x16x32_bf16 v[24:27], v[148:151], v[168:171], v[24:27]
v_perm_b32 v154, v107, v158, s45
v_perm_b32 v155, v111, v159, s45
v_mfma_f32_16x16x32_bf16 v[28:31], v[148:151], v[172:175], v[28:31]
v_perm_b32 v158, v107, v158, s46
v_perm_b32 v159, v111, v159, s46
v_mfma_f32_16x16x32_bf16 v[32:35], v[152:155], v[160:163], v[32:35]
v_xor_b32 v251, 262144, v251
buffer_load_dwordx4 v[96:99], v251, s[20:23], 0 offen
buffer_load_dwordx4 v[100:103], v251, s[20:23], s96 offen
buffer_load_dwordx4 v[104:107], v251, s[20:23], s97 offen
buffer_load_dwordx4 v[108:111], v251, s[20:23], s98 offen
s_waitcnt vmcnt(11)
v_cndmask_b32_dpp v148, v66, v64, vcc row_ror:8 row_mask:0xf bank_mask:0xf
s_waitcnt vmcnt(10)
v_cndmask_b32_dpp v149, v70, v68, vcc row_ror:8 row_mask:0xf bank_mask:0xf
v_mfma_f32_16x16x32_bf16 v[48:51], v[156:159], v[160:163], v[48:51]
v_xor_b32 v253, 64, v253
v_xor_b32 v254, 64, v254
ds_read_b128 v[160:163], v253 offset:0
v_mov_b32_dpp v66, v64 row_ror:8 row_mask:0xf bank_mask:0x3
v_mov_b32_dpp v70, v68 row_ror:8 row_mask:0xf bank_mask:0x3
v_mfma_f32_16x16x32_bf16 v[36:39], v[152:155], v[164:167], v[36:39]
v_perm_b32 v144, v66, v148, s45
v_perm_b32 v145, v70, v149, s45
v_mfma_f32_16x16x32_bf16 v[52:55], v[156:159], v[164:167], v[52:55]
ds_read_b128 v[164:167], v253 offset:2048
v_perm_b32 v148, v66, v148, s46
v_perm_b32 v149, v70, v149, s46
v_mfma_f32_16x16x32_bf16 v[40:43], v[152:155], v[168:171], v[40:43]
s_waitcnt vmcnt(9)
v_cndmask_b32_dpp v150, v74, v72, vcc row_ror:8 row_mask:0xf bank_mask:0xf
s_waitcnt vmcnt(8)
v_cndmask_b32_dpp v151, v78, v76, vcc row_ror:8 row_mask:0xf bank_mask:0xf
v_mfma_f32_16x16x32_bf16 v[56:59], v[156:159], v[168:171], v[56:59]
ds_read_b128 v[168:171], v254 offset:0
v_mov_b32_dpp v74, v72 row_ror:8 row_mask:0xf bank_mask:0x3
v_mov_b32_dpp v78, v76 row_ror:8 row_mask:0xf bank_mask:0x3
v_mfma_f32_16x16x32_bf16 v[44:47], v[152:155], v[172:175], v[44:47]
v_perm_b32 v146, v74, v150, s45
v_perm_b32 v147, v78, v151, s45
v_mfma_f32_16x16x32_bf16 v[60:63], v[156:159], v[172:175], v[60:63]
ds_read_b128 v[172:175], v254 offset:2048
v_perm_b32 v150, v74, v150, s46
v_perm_b32 v151, v78, v151, s46
s_waitcnt lgkmcnt(3)
v_mfma_f32_16x16x32_bf16 v[0:3], v[144:147], v[160:163], v[0:3]
v_cndmask_b32_dpp v156, v67, v65, vcc row_ror:8 row_mask:0xf bank_mask:0xf
v_cndmask_b32_dpp v157, v71, v69, vcc row_ror:8 row_mask:0xf bank_mask:0xf
s_waitcnt lgkmcnt(2)
v_mfma_f32_16x16x32_bf16 v[4:7], v[144:147], v[164:167], v[4:7]
v_mov_b32_dpp v67, v65 row_ror:8 row_mask:0xf bank_mask:0x3
v_mov_b32_dpp v71, v69 row_ror:8 row_mask:0xf bank_mask:0x3
s_waitcnt lgkmcnt(1)
v_mfma_f32_16x16x32_bf16 v[8:11], v[144:147], v[168:171], v[8:11]
v_perm_b32 v152, v67, v156, s45
v_perm_b32 v153, v71, v157, s45
s_waitcnt lgkmcnt(0)
v_mfma_f32_16x16x32_bf16 v[12:15], v[144:147], v[172:175], v[12:15]
v_perm_b32 v156, v67, v156, s46
v_perm_b32 v157, v71, v157, s46
v_mfma_f32_16x16x32_bf16 v[16:19], v[148:151], v[160:163], v[16:19]
v_cndmask_b32_dpp v158, v75, v73, vcc row_ror:8 row_mask:0xf bank_mask:0xf
v_cndmask_b32_dpp v159, v79, v77, vcc row_ror:8 row_mask:0xf bank_mask:0xf
v_mfma_f32_16x16x32_bf16 v[20:23], v[148:151], v[164:167], v[20:23]
v_mov_b32_dpp v75, v73 row_ror:8 row_mask:0xf bank_mask:0x3
v_mov_b32_dpp v79, v77 row_ror:8 row_mask:0xf bank_mask:0x3
v_mfma_f32_16x16x32_bf16 v[24:27], v[148:151], v[168:171], v[24:27]
v_perm_b32 v154, v75, v158, s45
v_perm_b32 v155, v79, v159, s45
v_mfma_f32_16x16x32_bf16 v[28:31], v[148:151], v[172:175], v[28:31]
v_perm_b32 v158, v75, v158, s46
v_perm_b32 v159, v79, v159, s46
v_mfma_f32_16x16x32_bf16 v[32:35], v[152:155], v[160:163], v[32:35]
s_add_u32 s61, s61, 524288
s_and_b32 s61, s61, 4194303
v_add_u32 v251, s61, v252
buffer_load_dwordx4 v[64:67], v251, s[20:23], 0 offen
buffer_load_dwordx4 v[68:71], v251, s[20:23], s96 offen
buffer_load_dwordx4 v[72:75], v251, s[20:23], s97 offen
buffer_load_dwordx4 v[76:79], v251, s[20:23], s98 offen
s_waitcnt vmcnt(11)
v_cndmask_b32_dpp v148, v82, v80, vcc row_ror:8 row_mask:0xf bank_mask:0xf
s_waitcnt vmcnt(10)
v_cndmask_b32_dpp v149, v86, v84, vcc row_ror:8 row_mask:0xf bank_mask:0xf
v_mfma_f32_16x16x32_bf16 v[48:51], v[156:159], v[160:163], v[48:51]
v_xor_b32 v253, 64, v253
v_xor_b32 v254, 64, v254
ds_read_b128 v[160:163], v253 offset:40960
v_mov_b32_dpp v82, v80 row_ror:8 row_mask:0xf bank_mask:0x3
v_mov_b32_dpp v86, v84 row_ror:8 row_mask:0xf bank_mask:0x3
v_mfma_f32_16x16x32_bf16 v[36:39], v[152:155], v[164:167], v[36:39]
v_perm_b32 v144, v82, v148, s45
v_perm_b32 v145, v86, v149, s45
v_mfma_f32_16x16x32_bf16 v[52:55], v[156:159], v[164:167], v[52:55]
ds_read_b128 v[164:167], v253 offset:43008
v_perm_b32 v148, v82, v148, s46
v_perm_b32 v149, v86, v149, s46
v_mfma_f32_16x16x32_bf16 v[40:43], v[152:155], v[168:171], v[40:43]
s_waitcnt vmcnt(9)
v_cndmask_b32_dpp v150, v90, v88, vcc row_ror:8 row_mask:0xf bank_mask:0xf
s_waitcnt vmcnt(8)
v_cndmask_b32_dpp v151, v94, v92, vcc row_ror:8 row_mask:0xf bank_mask:0xf
v_mfma_f32_16x16x32_bf16 v[56:59], v[156:159], v[168:171], v[56:59]
ds_read_b128 v[168:171], v254 offset:40960
v_mov_b32_dpp v90, v88 row_ror:8 row_mask:0xf bank_mask:0x3
v_mov_b32_dpp v94, v92 row_ror:8 row_mask:0xf bank_mask:0x3
v_mfma_f32_16x16x32_bf16 v[44:47], v[152:155], v[172:175], v[44:47]
v_perm_b32 v146, v90, v150, s45
v_perm_b32 v147, v94, v151, s45
v_mfma_f32_16x16x32_bf16 v[60:63], v[156:159], v[172:175], v[60:63]
ds_read_b128 v[172:175], v254 offset:43008
v_perm_b32 v150, v90, v150, s46
v_perm_b32 v151, v94, v151, s46
s_waitcnt lgkmcnt(3)
v_mfma_f32_16x16x32_bf16 v[0:3], v[144:147], v[160:163], v[0:3]
v_cndmask_b32_dpp v156, v83, v81, vcc row_ror:8 row_mask:0xf bank_mask:0xf
v_cndmask_b32_dpp v157, v87, v85, vcc row_ror:8 row_mask:0xf bank_mask:0xf
s_waitcnt lgkmcnt(2)
v_mfma_f32_16x16x32_bf16 v[4:7], v[144:147], v[164:167], v[4:7]
v_mov_b32_dpp v83, v81 row_ror:8 row_mask:0xf bank_mask:0x3
v_mov_b32_dpp v87, v85 row_ror:8 row_mask:0xf bank_mask:0x3
s_waitcnt lgkmcnt(1)
v_mfma_f32_16x16x32_bf16 v[8:11], v[144:147], v[168:171], v[8:11]
v_perm_b32 v152, v83, v156, s45
v_perm_b32 v153, v87, v157, s45
s_waitcnt lgkmcnt(0)
v_mfma_f32_16x16x32_bf16 v[12:15], v[144:147], v[172:175], v[12:15]
v_perm_b32 v156, v83, v156, s46
v_perm_b32 v157, v87, v157, s46
v_mfma_f32_16x16x32_bf16 v[16:19], v[148:151], v[160:163], v[16:19]
v_cndmask_b32_dpp v158, v91, v89, vcc row_ror:8 row_mask:0xf bank_mask:0xf
v_cndmask_b32_dpp v159, v95, v93, vcc row_ror:8 row_mask:0xf bank_mask:0xf
v_mfma_f32_16x16x32_bf16 v[20:23], v[148:151], v[164:167], v[20:23]
v_mov_b32_dpp v91, v89 row_ror:8 row_mask:0xf bank_mask:0x3
v_mov_b32_dpp v95, v93 row_ror:8 row_mask:0xf bank_mask:0x3
v_mfma_f32_16x16x32_bf16 v[24:27], v[148:151], v[168:171], v[24:27]
v_perm_b32 v154, v91, v158, s45
v_perm_b32 v155, v95, v159, s45
v_mfma_f32_16x16x32_bf16 v[28:31], v[148:151], v[172:175], v[28:31]
v_perm_b32 v158, v91, v158, s46
v_perm_b32 v159, v95, v159, s46
v_mfma_f32_16x16x32_bf16 v[32:35], v[152:155], v[160:163], v[32:35]
v_xor_b32 v251, 262144, v251
buffer_load_dwordx4 v[80:83], v251, s[20:23], 0 offen
buffer_load_dwordx4 v[84:87], v251, s[20:23], s96 offen
buffer_load_dwordx4 v[88:91], v251, s[20:23], s97 offen
buffer_load_dwordx4 v[92:95], v251, s[20:23], s98 offen
s_waitcnt vmcnt(11)
v_cndmask_b32_dpp v148, v98, v96, vcc row_ror:8 row_mask:0xf bank_mask:0xf
s_waitcnt vmcnt(10)
v_cndmask_b32_dpp v149, v102, v100, vcc row_ror:8 row_mask:0xf bank_mask:0xf
v_mfma_f32_16x16x32_bf16 v[48:51], v[156:159], v[160:163], v[48:51]
v_xor_b32 v253, 64, v253
v_xor_b32 v254, 64, v254
ds_read_b128 v[160:163], v253 offset:40960
v_mov_b32_dpp v98, v96 row_ror:8 row_mask:0xf bank_mask:0x3
v_mov_b32_dpp v102, v100 row_ror:8 row_mask:0xf bank_mask:0x3
v_mfma_f32_16x16x32_bf16 v[36:39], v[152:155], v[164:167], v[36:39]
v_perm_b32 v144, v98, v148, s45
v_perm_b32 v145, v102, v149, s45
v_mfma_f32_16x16x32_bf16 v[52:55], v[156:159], v[164:167], v[52:55]
ds_read_b128 v[164:167], v253 offset:43008
v_perm_b32 v148, v98, v148, s46
v_perm_b32 v149, v102, v149, s46
v_mfma_f32_16x16x32_bf16 v[40:43], v[152:155], v[168:171], v[40:43]
s_waitcnt vmcnt(9)
v_cndmask_b32_dpp v150, v106, v104, vcc row_ror:8 row_mask:0xf bank_mask:0xf
s_waitcnt vmcnt(8)
v_cndmask_b32_dpp v151, v110, v108, vcc row_ror:8 row_mask:0xf bank_mask:0xf
v_mfma_f32_16x16x32_bf16 v[56:59], v[156:159], v[168:171], v[56:59]
ds_read_b128 v[168:171], v254 offset:40960
v_mov_b32_dpp v106, v104 row_ror:8 row_mask:0xf bank_mask:0x3
v_mov_b32_dpp v110, v108 row_ror:8 row_mask:0xf bank_mask:0x3
v_mfma_f32_16x16x32_bf16 v[44:47], v[152:155], v[172:175], v[44:47]
v_perm_b32 v146, v106, v150, s45
v_perm_b32 v147, v110, v151, s45
v_mfma_f32_16x16x32_bf16 v[60:63], v[156:159], v[172:175], v[60:63]
ds_read_b128 v[172:175], v254 offset:43008
v_perm_b32 v150, v106, v150, s46
v_perm_b32 v151, v110, v151, s46
s_waitcnt lgkmcnt(3)
v_mfma_f32_16x16x32_bf16 v[0:3], v[144:147], v[160:163], v[0:3]
v_cndmask_b32_dpp v156, v99, v97, vcc row_ror:8 row_mask:0xf bank_mask:0xf
v_cndmask_b32_dpp v157, v103, v101, vcc row_ror:8 row_mask:0xf bank_mask:0xf
s_waitcnt lgkmcnt(2)
v_mfma_f32_16x16x32_bf16 v[4:7], v[144:147], v[164:167], v[4:7]
v_mov_b32_dpp v99, v97 row_ror:8 row_mask:0xf bank_mask:0x3
v_mov_b32_dpp v103, v101 row_ror:8 row_mask:0xf bank_mask:0x3
s_waitcnt lgkmcnt(1)
v_mfma_f32_16x16x32_bf16 v[8:11], v[144:147], v[168:171], v[8:11]
v_perm_b32 v152, v99, v156, s45
v_perm_b32 v153, v103, v157, s45
s_waitcnt lgkmcnt(0)
v_mfma_f32_16x16x32_bf16 v[12:15], v[144:147], v[172:175], v[12:15]
v_perm_b32 v156, v99, v156, s46
v_perm_b32 v157, v103, v157, s46
v_mfma_f32_16x16x32_bf16 v[16:19], v[148:151], v[160:163], v[16:19]
v_cndmask_b32_dpp v158, v107, v105, vcc row_ror:8 row_mask:0xf bank_mask:0xf
v_cndmask_b32_dpp v159, v111, v109, vcc row_ror:8 row_mask:0xf bank_mask:0xf
v_mfma_f32_16x16x32_bf16 v[20:23], v[148:151], v[164:167], v[20:23]
v_mov_b32_dpp v107, v105 row_ror:8 row_mask:0xf bank_mask:0x3
v_mov_b32_dpp v111, v109 row_ror:8 row_mask:0xf bank_mask:0x3
v_mfma_f32_16x16x32_bf16 v[24:27], v[148:151], v[168:171], v[24:27]
v_perm_b32 v154, v107, v158, s45
v_perm_b32 v155, v111, v159, s45
v_mfma_f32_16x16x32_bf16 v[28:31], v[148:151], v[172:175], v[28:31]
v_perm_b32 v158, v107, v158, s46
v_perm_b32 v159, v111, v159, s46
v_mfma_f32_16x16x32_bf16 v[32:35], v[152:155], v[160:163], v[32:35]
s_add_u32 s61, s61, 524288
s_and_b32 s61, s61, 4194303
v_add_u32 v251, s61, v252
buffer_load_dwordx4 v[96:99], v251, s[20:23], 0 offen
buffer_load_dwordx4 v[100:103], v251, s[20:23], s96 offen
buffer_load_dwordx4 v[104:107], v251, s[20:23], s97 offen
buffer_load_dwordx4 v[108:111], v251, s[20:23], s98 offen
s_waitcnt vmcnt(11)
v_cndmask_b32_dpp v148, v66, v64, vcc row_ror:8 row_mask:0xf bank_mask:0xf
s_waitcnt vmcnt(10)
v_cndmask_b32_dpp v149, v70, v68, vcc row_ror:8 row_mask:0xf bank_mask:0xf
v_mfma_f32_16x16x32_bf16 v[48:51], v[156:159], v[160:163], v[48:51]
v_xor_b32 v253, 64, v253
v_add_u32 v253, 81920, v253
v_xor_b32 v254, 64, v254
v_add_u32 v254, 81920, v254
ds_read_b128 v[160:163], v253 offset:0
v_mov_b32_dpp v66, v64 row_ror:8 row_mask:0xf bank_mask:0x3
v_mov_b32_dpp v70, v68 row_ror:8 row_mask:0xf bank_mask:0x3
v_mfma_f32_16x16x32_bf16 v[36:39], v[152:155], v[164:167], v[36:39]
v_perm_b32 v144, v66, v148, s45
v_perm_b32 v145, v70, v149, s45
v_mfma_f32_16x16x32_bf16 v[52:55], v[156:159], v[164:167], v[52:55]
ds_read_b128 v[164:167], v253 offset:2048
v_perm_b32 v148, v66, v148, s46
v_perm_b32 v149, v70, v149, s46
v_mfma_f32_16x16x32_bf16 v[40:43], v[152:155], v[168:171], v[40:43]
s_waitcnt vmcnt(9)
v_cndmask_b32_dpp v150, v74, v72, vcc row_ror:8 row_mask:0xf bank_mask:0xf
s_waitcnt vmcnt(8)
v_cndmask_b32_dpp v151, v78, v76, vcc row_ror:8 row_mask:0xf bank_mask:0xf
v_mfma_f32_16x16x32_bf16 v[56:59], v[156:159], v[168:171], v[56:59]
ds_read_b128 v[168:171], v254 offset:0
v_mov_b32_dpp v74, v72 row_ror:8 row_mask:0xf bank_mask:0x3
v_mov_b32_dpp v78, v76 row_ror:8 row_mask:0xf bank_mask:0x3
v_mfma_f32_16x16x32_bf16 v[44:47], v[152:155], v[172:175], v[44:47]
v_perm_b32 v146, v74, v150, s45
v_perm_b32 v147, v78, v151, s45
v_mfma_f32_16x16x32_bf16 v[60:63], v[156:159], v[172:175], v[60:63]
ds_read_b128 v[172:175], v254 offset:2048
v_perm_b32 v150, v74, v150, s46
v_perm_b32 v151, v78, v151, s46
s_waitcnt lgkmcnt(3)
v_mfma_f32_16x16x32_bf16 v[0:3], v[144:147], v[160:163], v[0:3]
v_cndmask_b32_dpp v156, v67, v65, vcc row_ror:8 row_mask:0xf bank_mask:0xf
v_cndmask_b32_dpp v157, v71, v69, vcc row_ror:8 row_mask:0xf bank_mask:0xf
s_waitcnt lgkmcnt(2)
v_mfma_f32_16x16x32_bf16 v[4:7], v[144:147], v[164:167], v[4:7]
v_mov_b32_dpp v67, v65 row_ror:8 row_mask:0xf bank_mask:0x3
v_mov_b32_dpp v71, v69 row_ror:8 row_mask:0xf bank_mask:0x3
s_waitcnt lgkmcnt(1)
v_mfma_f32_16x16x32_bf16 v[8:11], v[144:147], v[168:171], v[8:11]
v_perm_b32 v152, v67, v156, s45
v_perm_b32 v153, v71, v157, s45
s_waitcnt lgkmcnt(0)
v_mfma_f32_16x16x32_bf16 v[12:15], v[144:147], v[172:175], v[12:15]
v_perm_b32 v156, v67, v156, s46
v_perm_b32 v157, v71, v157, s46
v_mfma_f32_16x16x32_bf16 v[16:19], v[148:151], v[160:163], v[16:19]
v_cndmask_b32_dpp v158, v75, v73, vcc row_ror:8 row_mask:0xf bank_mask:0xf
v_cndmask_b32_dpp v159, v79, v77, vcc row_ror:8 row_mask:0xf bank_mask:0xf
v_mfma_f32_16x16x32_bf16 v[20:23], v[148:151], v[164:167], v[20:23]
v_mov_b32_dpp v75, v73 row_ror:8 row_mask:0xf bank_mask:0x3
v_mov_b32_dpp v79, v77 row_ror:8 row_mask:0xf bank_mask:0x3
v_mfma_f32_16x16x32_bf16 v[24:27], v[148:151], v[168:171], v[24:27]
v_perm_b32 v154, v75, v158, s45
v_perm_b32 v155, v79, v159, s45
v_mfma_f32_16x16x32_bf16 v[28:31], v[148:151], v[172:175], v[28:31]
v_perm_b32 v158, v75, v158, s46
v_perm_b32 v159, v79, v159, s46
v_mfma_f32_16x16x32_bf16 v[32:35], v[152:155], v[160:163], v[32:35]
v_xor_b32 v251, 262144, v251
buffer_load_dwordx4 v[64:67], v251, s[20:23], 0 offen
buffer_load_dwordx4 v[68:71], v251, s[20:23], s96 offen
buffer_load_dwordx4 v[72:75], v251, s[20:23], s97 offen
buffer_load_dwordx4 v[76:79], v251, s[20:23], s98 offen
s_waitcnt vmcnt(11)
v_cndmask_b32_dpp v148, v82, v80, vcc row_ror:8 row_mask:0xf bank_mask:0xf
s_waitcnt vmcnt(10)
v_cndmask_b32_dpp v149, v86, v84, vcc row_ror:8 row_mask:0xf bank_mask:0xf
v_mfma_f32_16x16x32_bf16 v[48:51], v[156:159], v[160:163], v[48:51]
v_xor_b32 v253, 64, v253
v_xor_b32 v254, 64, v254
ds_read_b128 v[160:163], v253 offset:0
v_mov_b32_dpp v82, v80 row_ror:8 row_mask:0xf bank_mask:0x3
v_mov_b32_dpp v86, v84 row_ror:8 row_mask:0xf bank_mask:0x3
v_mfma_f32_16x16x32_bf16 v[36:39], v[152:155], v[164:167], v[36:39]
v_perm_b32 v144, v82, v148, s45
v_perm_b32 v145, v86, v149, s45
v_mfma_f32_16x16x32_bf16 v[52:55], v[156:159], v[164:167], v[52:55]
ds_read_b128 v[164:167], v253 offset:2048
v_perm_b32 v148, v82, v148, s46
v_perm_b32 v149, v86, v149, s46
v_mfma_f32_16x16x32_bf16 v[40:43], v[152:155], v[168:171], v[40:43]
s_waitcnt vmcnt(9)
v_cndmask_b32_dpp v150, v90, v88, vcc row_ror:8 row_mask:0xf bank_mask:0xf
s_waitcnt vmcnt(8)
v_cndmask_b32_dpp v151, v94, v92, vcc row_ror:8 row_mask:0xf bank_mask:0xf
v_mfma_f32_16x16x32_bf16 v[56:59], v[156:159], v[168:171], v[56:59]
ds_read_b128 v[168:171], v254 offset:0
v_mov_b32_dpp v90, v88 row_ror:8 row_mask:0xf bank_mask:0x3
v_mov_b32_dpp v94, v92 row_ror:8 row_mask:0xf bank_mask:0x3
v_mfma_f32_16x16x32_bf16 v[44:47], v[152:155], v[172:175], v[44:47]
v_perm_b32 v146, v90, v150, s45
v_perm_b32 v147, v94, v151, s45
v_mfma_f32_16x16x32_bf16 v[60:63], v[156:159], v[172:175], v[60:63]
ds_read_b128 v[172:175], v254 offset:2048
v_perm_b32 v150, v90, v150, s46
v_perm_b32 v151, v94, v151, s46
s_add_u32 s54, s5, 24576
s_and_b32 s54, s54, 0x1ffff
s_add_u32 m0, s50, 24576
s_nop 0
buffer_load_dwordx4 v249, s[12:15], s54 offen nt lds
s_or_b32 s54, s54, 0x100000
s_add_u32 m0, s50, 65536
s_nop 0
buffer_load_dwordx4 v249, s[12:15], s54 offen nt lds
s_add_u32 s54, s5, 24576
s_and_b32 s54, s54, 0x1ffff
s_add_u32 m0, s50, 106496
s_nop 0
buffer_load_dwordx4 v250, s[16:19], s54 offen nt lds
s_or_b32 s54, s54, 0x100000
s_add_u32 m0, s50, 147456
s_nop 0
buffer_load_dwordx4 v250, s[16:19], s54 offen nt lds
s_waitcnt lgkmcnt(3)
v_mfma_f32_16x16x32_bf16 v[0:3], v[144:147], v[160:163], v[0:3]
v_cndmask_b32_dpp v156, v83, v81, vcc row_ror:8 row_mask:0xf bank_mask:0xf
v_cndmask_b32_dpp v157, v87, v85, vcc row_ror:8 row_mask:0xf bank_mask:0xf
s_waitcnt lgkmcnt(2)
v_mfma_f32_16x16x32_bf16 v[4:7], v[144:147], v[164:167], v[4:7]
v_mov_b32_dpp v83, v81 row_ror:8 row_mask:0xf bank_mask:0x3
v_mov_b32_dpp v87, v85 row_ror:8 row_mask:0xf bank_mask:0x3
s_waitcnt lgkmcnt(1)
v_mfma_f32_16x16x32_bf16 v[8:11], v[144:147], v[168:171], v[8:11]
v_perm_b32 v152, v83, v156, s45
v_perm_b32 v153, v87, v157, s45
s_waitcnt lgkmcnt(0)
v_mfma_f32_16x16x32_bf16 v[12:15], v[144:147], v[172:175], v[12:15]
v_perm_b32 v156, v83, v156, s46
v_perm_b32 v157, v87, v157, s46
v_mfma_f32_16x16x32_bf16 v[16:19], v[148:151], v[160:163], v[16:19]
v_cndmask_b32_dpp v158, v91, v89, vcc row_ror:8 row_mask:0xf bank_mask:0xf
v_cndmask_b32_dpp v159, v95, v93, vcc row_ror:8 row_mask:0xf bank_mask:0xf
v_mfma_f32_16x16x32_bf16 v[20:23], v[148:151], v[164:167], v[20:23]
v_mov_b32_dpp v91, v89 row_ror:8 row_mask:0xf bank_mask:0x3
v_mov_b32_dpp v95, v93 row_ror:8 row_mask:0xf bank_mask:0x3
v_mfma_f32_16x16x32_bf16 v[24:27], v[148:151], v[168:171], v[24:27]
v_perm_b32 v154, v91, v158, s45
v_perm_b32 v155, v95, v159, s45
v_mfma_f32_16x16x32_bf16 v[28:31], v[148:151], v[172:175], v[28:31]
v_perm_b32 v158, v91, v158, s46
v_perm_b32 v159, v95, v159, s46
v_mfma_f32_16x16x32_bf16 v[32:35], v[152:155], v[160:163], v[32:35]
s_waitcnt vmcnt(11)
v_cndmask_b32_dpp v148, v98, v96, vcc row_ror:8 row_mask:0xf bank_mask:0xf
s_waitcnt vmcnt(10)
v_cndmask_b32_dpp v149, v102, v100, vcc row_ror:8 row_mask:0xf bank_mask:0xf
v_mfma_f32_16x16x32_bf16 v[48:51], v[156:159], v[160:163], v[48:51]
v_xor_b32 v253, 64, v253
v_xor_b32 v254, 64, v254
ds_read_b128 v[160:163], v253 offset:40960
v_mov_b32_dpp v98, v96 row_ror:8 row_mask:0xf bank_mask:0x3
v_mov_b32_dpp v102, v100 row_ror:8 row_mask:0xf bank_mask:0x3
v_mfma_f32_16x16x32_bf16 v[36:39], v[152:155], v[164:167], v[36:39]
v_perm_b32 v144, v98, v148, s45
v_perm_b32 v145, v102, v149, s45
v_mfma_f32_16x16x32_bf16 v[52:55], v[156:159], v[164:167], v[52:55]
ds_read_b128 v[164:167], v253 offset:43008
v_perm_b32 v148, v98, v148, s46
v_perm_b32 v149, v102, v149, s46
v_mfma_f32_16x16x32_bf16 v[40:43], v[152:155], v[168:171], v[40:43]
s_waitcnt vmcnt(9)
v_cndmask_b32_dpp v150, v106, v104, vcc row_ror:8 row_mask:0xf bank_mask:0xf
s_waitcnt vmcnt(8)
v_cndmask_b32_dpp v151, v110, v108, vcc row_ror:8 row_mask:0xf bank_mask:0xf
v_mfma_f32_16x16x32_bf16 v[56:59], v[156:159], v[168:171], v[56:59]
ds_read_b128 v[168:171], v254 offset:40960
v_mov_b32_dpp v106, v104 row_ror:8 row_mask:0xf bank_mask:0x3
v_mov_b32_dpp v110, v108 row_ror:8 row_mask:0xf bank_mask:0x3
v_mfma_f32_16x16x32_bf16 v[44:47], v[152:155], v[172:175], v[44:47]
v_perm_b32 v146, v106, v150, s45
v_perm_b32 v147, v110, v151, s45
v_mfma_f32_16x16x32_bf16 v[60:63], v[156:159], v[172:175], v[60:63]
ds_read_b128 v[172:175], v254 offset:43008
v_perm_b32 v150, v106, v150, s46
v_perm_b32 v151, v110, v151, s46
s_waitcnt lgkmcnt(3)
v_mfma_f32_16x16x32_bf16 v[0:3], v[144:147], v[160:163], v[0:3]
v_cndmask_b32_dpp v156, v99, v97, vcc row_ror:8 row_mask:0xf bank_mask:0xf
v_cndmask_b32_dpp v157, v103, v101, vcc row_ror:8 row_mask:0xf bank_mask:0xf
s_waitcnt lgkmcnt(2)
v_mfma_f32_16x16x32_bf16 v[4:7], v[144:147], v[164:167], v[4:7]
v_mov_b32_dpp v99, v97 row_ror:8 row_mask:0xf bank_mask:0x3
v_mov_b32_dpp v103, v101 row_ror:8 row_mask:0xf bank_mask:0x3
s_waitcnt lgkmcnt(1)
v_mfma_f32_16x16x32_bf16 v[8:11], v[144:147], v[168:171], v[8:11]
v_perm_b32 v152, v99, v156, s45
v_perm_b32 v153, v103, v157, s45
s_waitcnt lgkmcnt(0)
v_mfma_f32_16x16x32_bf16 v[12:15], v[144:147], v[172:175], v[12:15]
v_perm_b32 v156, v99, v156, s46
v_perm_b32 v157, v103, v157, s46
v_mfma_f32_16x16x32_bf16 v[16:19], v[148:151], v[160:163], v[16:19]
v_cndmask_b32_dpp v158, v107, v105, vcc row_ror:8 row_mask:0xf bank_mask:0xf
v_cndmask_b32_dpp v159, v111, v109, vcc row_ror:8 row_mask:0xf bank_mask:0xf
v_mfma_f32_16x16x32_bf16 v[20:23], v[148:151], v[164:167], v[20:23]
v_mov_b32_dpp v107, v105 row_ror:8 row_mask:0xf bank_mask:0x3
v_mov_b32_dpp v111, v109 row_ror:8 row_mask:0xf bank_mask:0x3
v_mfma_f32_16x16x32_bf16 v[24:27], v[148:151], v[168:171], v[24:27]
v_perm_b32 v154, v107, v158, s45
v_perm_b32 v155, v111, v159, s45
v_mfma_f32_16x16x32_bf16 v[28:31], v[148:151], v[172:175], v[28:31]
v_perm_b32 v158, v107, v158, s46
v_perm_b32 v159, v111, v159, s46
v_mfma_f32_16x16x32_bf16 v[32:35], v[152:155], v[160:163], v[32:35]
s_waitcnt vmcnt(7)
v_cndmask_b32_dpp v148, v66, v64, vcc row_ror:8 row_mask:0xf bank_mask:0xf
s_waitcnt vmcnt(6)
v_cndmask_b32_dpp v149, v70, v68, vcc row_ror:8 row_mask:0xf bank_mask:0xf
v_mfma_f32_16x16x32_bf16 v[48:51], v[156:159], v[160:163], v[48:51]
v_xor_b32 v253, 64, v253
v_xor_b32 v254, 64, v254
ds_read_b128 v[160:163], v253 offset:40960
v_mov_b32_dpp v66, v64 row_ror:8 row_mask:0xf bank_mask:0x3
v_mov_b32_dpp v70, v68 row_ror:8 row_mask:0xf bank_mask:0x3
v_mfma_f32_16x16x32_bf16 v[36:39], v[152:155], v[164:167], v[36:39]
v_perm_b32 v144, v66, v148, s45
v_perm_b32 v145, v70, v149, s45
v_mfma_f32_16x16x32_bf16 v[52:55], v[156:159], v[164:167], v[52:55]
ds_read_b128 v[164:167], v253 offset:43008
v_perm_b32 v148, v66, v148, s46
v_perm_b32 v149, v70, v149, s46
v_mfma_f32_16x16x32_bf16 v[40:43], v[152:155], v[168:171], v[40:43]
s_waitcnt vmcnt(5)
v_cndmask_b32_dpp v150, v74, v72, vcc row_ror:8 row_mask:0xf bank_mask:0xf
s_waitcnt vmcnt(4)
v_cndmask_b32_dpp v151, v78, v76, vcc row_ror:8 row_mask:0xf bank_mask:0xf
v_mfma_f32_16x16x32_bf16 v[56:59], v[156:159], v[168:171], v[56:59]
ds_read_b128 v[168:171], v254 offset:40960
v_mov_b32_dpp v74, v72 row_ror:8 row_mask:0xf bank_mask:0x3
v_mov_b32_dpp v78, v76 row_ror:8 row_mask:0xf bank_mask:0x3
v_mfma_f32_16x16x32_bf16 v[44:47], v[152:155], v[172:175], v[44:47]
v_perm_b32 v146, v74, v150, s45
v_perm_b32 v147, v78, v151, s45
v_mfma_f32_16x16x32_bf16 v[60:63], v[156:159], v[172:175], v[60:63]
ds_read_b128 v[172:175], v254 offset:43008
v_perm_b32 v150, v74, v150, s46
v_perm_b32 v151, v78, v151, s46
s_waitcnt lgkmcnt(3)
v_mfma_f32_16x16x32_bf16 v[0:3], v[144:147], v[160:163], v[0:3]
v_cndmask_b32_dpp v156, v67, v65, vcc row_ror:8 row_mask:0xf bank_mask:0xf
v_cndmask_b32_dpp v157, v71, v69, vcc row_ror:8 row_mask:0xf bank_mask:0xf
s_waitcnt lgkmcnt(2)
v_mfma_f32_16x16x32_bf16 v[4:7], v[144:147], v[164:167], v[4:7]
v_mov_b32_dpp v67, v65 row_ror:8 row_mask:0xf bank_mask:0x3
v_mov_b32_dpp v71, v69 row_ror:8 row_mask:0xf bank_mask:0x3
s_waitcnt lgkmcnt(1)
v_mfma_f32_16x16x32_bf16 v[8:11], v[144:147], v[168:171], v[8:11]
v_perm_b32 v152, v67, v156, s45
v_perm_b32 v153, v71, v157, s45
s_waitcnt lgkmcnt(0)
v_mfma_f32_16x16x32_bf16 v[12:15], v[144:147], v[172:175], v[12:15]
v_perm_b32 v156, v67, v156, s46
v_perm_b32 v157, v71, v157, s46
v_mfma_f32_16x16x32_bf16 v[16:19], v[148:151], v[160:163], v[16:19]
v_cndmask_b32_dpp v158, v75, v73, vcc row_ror:8 row_mask:0xf bank_mask:0xf
v_cndmask_b32_dpp v159, v79, v77, vcc row_ror:8 row_mask:0xf bank_mask:0xf
v_mfma_f32_16x16x32_bf16 v[20:23], v[148:151], v[164:167], v[20:23]
v_mov_b32_dpp v75, v73 row_ror:8 row_mask:0xf bank_mask:0x3
v_mov_b32_dpp v79, v77 row_ror:8 row_mask:0xf bank_mask:0x3
v_mfma_f32_16x16x32_bf16 v[24:27], v[148:151], v[168:171], v[24:27]
v_perm_b32 v154, v75, v158, s45
v_perm_b32 v155, v79, v159, s45
v_mfma_f32_16x16x32_bf16 v[28:31], v[148:151], v[172:175], v[28:31]
v_perm_b32 v158, v75, v158, s46
v_perm_b32 v159, v79, v159, s46
v_mfma_f32_16x16x32_bf16 v[32:35], v[152:155], v[160:163], v[32:35]
s_nop 0
v_mfma_f32_16x16x32_bf16 v[48:51], v[156:159], v[160:163], v[48:51]
v_mfma_f32_16x16x32_bf16 v[36:39], v[152:155], v[164:167], v[36:39]
v_mfma_f32_16x16x32_bf16 v[52:55], v[156:159], v[164:167], v[52:55]
v_mfma_f32_16x16x32_bf16 v[40:43], v[152:155], v[168:171], v[40:43]
v_mfma_f32_16x16x32_bf16 v[56:59], v[156:159], v[168:171], v[56:59]
v_mfma_f32_16x16x32_bf16 v[44:47], v[152:155], v[172:175], v[44:47]
v_mfma_f32_16x16x32_bf16 v[60:63], v[156:159], v[172:175], v[60:63]
s_and_b32 s52, s40, 3
s_mul_i32 s52, s52, 40960
s_lshl_b32 s53, s47, 12
s_add_u32 s52, s52, s53
v_lshl_add_u32 v253, v255, 4, s52
v_xor_b32 v254, 0x1000, v253
v_pk_mul_f32 v[8:9], v[8:9], s[6:7]
v_pk_mul_f32 v[10:11], v[10:11], s[6:7]
v_pk_mul_f32 v[24:25], v[24:25], s[6:7]
v_pk_mul_f32 v[26:27], v[26:27], s[6:7]
v_pk_mul_f32 v[40:41], v[40:41], s[6:7]
v_pk_mul_f32 v[42:43], v[42:43], s[6:7]
v_pk_mul_f32 v[56:57], v[56:57], s[6:7]
v_pk_mul_f32 v[58:59], v[58:59], s[6:7]
v_cvt_pk_bf16_f32 v64, v8, v24
v_cvt_pk_bf16_f32 v65, v40, v56
v_cvt_pk_bf16_f32 v66, v9, v25
v_cvt_pk_bf16_f32 v67, v41, v57
v_cvt_pk_bf16_f32 v68, v10, v26
v_cvt_pk_bf16_f32 v69, v42, v58
v_cvt_pk_bf16_f32 v70, v11, v27
v_cvt_pk_bf16_f32 v71, v43, v59
v_pk_mul_f32 v[12:13], v[12:13], s[6:7]
v_pk_mul_f32 v[14:15], v[14:15], s[6:7]
v_pk_mul_f32 v[28:29], v[28:29], s[6:7]
v_pk_mul_f32 v[30:31], v[30:31], s[6:7]
v_pk_mul_f32 v[44:45], v[44:45], s[6:7]
v_pk_mul_f32 v[46:47], v[46:47], s[6:7]
v_pk_mul_f32 v[60:61], v[60:61], s[6:7]
v_pk_mul_f32 v[62:63], v[62:63], s[6:7]
v_cvt_pk_bf16_f32 v72, v12, v28
v_cvt_pk_bf16_f32 v73, v44, v60
v_cvt_pk_bf16_f32 v74, v13, v29
v_cvt_pk_bf16_f32 v75, v45, v61
v_cvt_pk_bf16_f32 v76, v14, v30
v_cvt_pk_bf16_f32 v77, v46, v62
v_cvt_pk_bf16_f32 v78, v15, v31
v_cvt_pk_bf16_f32 v79, v47, v63
v_permlane32_swap_b32 v64, v66
v_permlane32_swap_b32 v65, v67
v_permlane32_swap_b32 v68, v70
v_permlane32_swap_b32 v69, v71
v_permlane32_swap_b32 v72, v74
v_permlane32_swap_b32 v73, v75
v_permlane32_swap_b32 v76, v78
v_permlane32_swap_b32 v77, v79
v_permlane16_swap_b32 v64, v72
v_permlane16_swap_b32 v65, v73
v_permlane16_swap_b32 v66, v74
v_permlane16_swap_b32 v67, v75
v_permlane16_swap_b32 v68, v76
v_permlane16_swap_b32 v69, v77
v_permlane16_swap_b32 v70, v78
v_permlane16_swap_b32 v71, v79
s_barrier
ds_write_b128 v253, v[64:67] offset:32768
ds_write_b128 v253, v[68:71] offset:33792
ds_write_b128 v253, v[72:75] offset:34816
ds_write_b128 v253, v[76:79] offset:35840
s_lshl_b32 s52, s51, 2
s_add_u32 s52, s52, s50
v_lshl_add_u32 v234, v255, 8, s52
v_mov_b32 v235, 1
buffer_atomic_add v235, v234, s[36:39], 0 offen sc1
v_pk_mul_f32 v[0:1], v[0:1], s[6:7]
v_pk_mul_f32 v[2:3], v[2:3], s[6:7]
v_pk_mul_f32 v[16:17], v[16:17], s[6:7]
v_pk_mul_f32 v[18:19], v[18:19], s[6:7]
v_pk_mul_f32 v[32:33], v[32:33], s[6:7]
v_pk_mul_f32 v[34:35], v[34:35], s[6:7]
v_pk_mul_f32 v[48:49], v[48:49], s[6:7]
v_pk_mul_f32 v[50:51], v[50:51], s[6:7]
v_cvt_pk_bf16_f32 v128, v0, v16
v_cvt_pk_bf16_f32 v129, v32, v48
v_cvt_pk_bf16_f32 v130, v1, v17
v_cvt_pk_bf16_f32 v131, v33, v49
v_cvt_pk_bf16_f32 v132, v2, v18
v_cvt_pk_bf16_f32 v133, v34, v50
v_cvt_pk_bf16_f32 v134, v3, v19
v_cvt_pk_bf16_f32 v135, v35, v51
v_pk_mul_f32 v[4:5], v[4:5], s[6:7]
v_pk_mul_f32 v[6:7], v[6:7], s[6:7]
v_pk_mul_f32 v[20:21], v[20:21], s[6:7]
v_pk_mul_f32 v[22:23], v[22:23], s[6:7]
v_pk_mul_f32 v[36:37], v[36:37], s[6:7]
v_pk_mul_f32 v[38:39], v[38:39], s[6:7]
v_pk_mul_f32 v[52:53], v[52:53], s[6:7]
v_pk_mul_f32 v[54:55], v[54:55], s[6:7]
v_cvt_pk_bf16_f32 v136, v4, v20
v_cvt_pk_bf16_f32 v137, v36, v52
v_cvt_pk_bf16_f32 v138, v5, v21
v_cvt_pk_bf16_f32 v139, v37, v53
v_cvt_pk_bf16_f32 v140, v6, v22
v_cvt_pk_bf16_f32 v141, v38, v54
v_cvt_pk_bf16_f32 v142, v7, v23
v_cvt_pk_bf16_f32 v143, v39, v55
v_permlane32_swap_b32 v128, v130
v_permlane32_swap_b32 v129, v131
v_permlane32_swap_b32 v132, v134
v_permlane32_swap_b32 v133, v135
v_permlane32_swap_b32 v136, v138
v_permlane32_swap_b32 v137, v139
v_permlane32_swap_b32 v140, v142
v_permlane32_swap_b32 v141, v143
v_permlane16_swap_b32 v128, v136
v_permlane16_swap_b32 v129, v137
v_permlane16_swap_b32 v130, v138
v_permlane16_swap_b32 v131, v139
v_permlane16_swap_b32 v132, v140
v_permlane16_swap_b32 v133, v141
v_permlane16_swap_b32 v134, v142
v_permlane16_swap_b32 v135, v143
v_bfe_u32 v232, v255, 5, 1
v_lshlrev_b32 v232, 14, v232
v_bfe_u32 v233, v255, 4, 1
v_lshl_add_u32 v232, v233, 12, v232
v_bfe_u32 v233, v255, 3, 1
v_lshl_add_u32 v232, v233, 10, v232
v_and_b32 v233, 7, v255
v_lshl_add_u32 v232, v233, 4, v232
s_lshr_b32 s52, s50, 3
v_add_u32 v252, s52, v232
s_waitcnt lgkmcnt(0)
s_barrier
ds_read_b128 v[64:67], v236 offset:0
ds_read_b128 v[68:71], v237 offset:0
ds_read_b128 v[72:75], v238 offset:0
ds_read_b128 v[76:79], v239 offset:0
ds_read_b128 v[144:147], v254 offset:32768
ds_read_b128 v[148:151], v254 offset:33792
ds_read_b128 v[152:155], v254 offset:34816
ds_read_b128 v[156:159], v254 offset:35840
ds_read_b128 v[80:83], v240 offset:0
ds_read_b128 v[84:87], v241 offset:0
ds_read_b128 v[88:91], v242 offset:0
ds_read_b128 v[92:95], v243 offset:0
v_lshl_add_u32 v253, v255, 4, s50
v_add_u32 v254, 81920, v253
s_waitcnt lgkmcnt(11)
v_mfma_f32_32x32x16_bf16 v[160:175], v[64:67], v[128:131], 0
ds_read_b128 v[64:67], v236 offset:8192
s_waitcnt lgkmcnt(11)
v_mfma_f32_32x32x16_bf16 v[160:175], v[68:71], v[132:135], v[160:175]
ds_read_b128 v[68:71], v237 offset:8192
s_waitcnt lgkmcnt(11)
v_mfma_f32_32x32x16_bf16 v[160:175], v[72:75], v[136:139], v[160:175]
ds_read_b128 v[72:75], v238 offset:8192
s_waitcnt lgkmcnt(11)
v_mfma_f32_32x32x16_bf16 v[160:175], v[76:79], v[140:143], v[160:175]
ds_read_b128 v[76:79], v239 offset:8192
s_waitcnt lgkmcnt(7)
v_mfma_f32_32x32x16_bf16 v[160:175], v[80:83], v[144:147], v[160:175]
ds_read_b128 v[80:83], v240 offset:8192
s_waitcnt lgkmcnt(7)
v_mfma_f32_32x32x16_bf16 v[160:175], v[84:87], v[148:151], v[160:175]
ds_read_b128 v[84:87], v241 offset:8192
s_waitcnt lgkmcnt(7)
v_mfma_f32_32x32x16_bf16 v[160:175], v[88:91], v[152:155], v[160:175]
ds_read_b128 v[88:91], v242 offset:8192
s_waitcnt lgkmcnt(7)
v_mfma_f32_32x32x16_bf16 v[160:175], v[92:95], v[156:159], v[160:175]
ds_read_b128 v[92:95], v243 offset:8192
s_nop 10
v_max3_f32 v232, v160, v161, v162
v_max3_f32 v232, v232, v163, v164
v_max3_f32 v232, v232, v165, v166
v_max3_f32 v232, v232, v167, v168
v_max3_f32 v232, v232, v169, v170
v_max3_f32 v232, v232, v171, v172
v_max3_f32 v232, v232, v173, v174
v_max_f32 v232, v232, v175
v_mov_b32 v233, v232
s_nop 1
v_permlane32_swap_b32 v232, v233
v_max_f32 v232, v232, v233
v_sub_f32 v112, 0, v232
v_sub_f32 v113, 0, v232
v_sub_f32 v114, 0, v232
v_sub_f32 v115, 0, v232
v_sub_f32 v116, 0, v232
v_sub_f32 v117, 0, v232
v_sub_f32 v118, 0, v232
v_sub_f32 v119, 0, v232
v_sub_f32 v120, 0, v232
v_sub_f32 v121, 0, v232
v_sub_f32 v122, 0, v232
v_sub_f32 v123, 0, v232
v_sub_f32 v124, 0, v232
v_sub_f32 v125, 0, v232
v_sub_f32 v126, 0, v232
v_sub_f32 v127, 0, v232
v_add_f32 v160, v160, v112
v_add_f32 v161, v161, v112
v_add_f32 v162, v162, v112
v_add_f32 v163, v163, v112
v_add_f32 v164, v164, v112
v_add_f32 v165, v165, v112
v_add_f32 v166, v166, v112
v_add_f32 v167, v167, v112
v_add_f32 v168, v168, v112
v_add_f32 v169, v169, v112
v_add_f32 v170, v170, v112
v_add_f32 v171, v171, v112
v_add_f32 v172, v172, v112
v_add_f32 v173, v173, v112
v_add_f32 v174, v174, v112
v_add_f32 v175, v175, v112
v_exp_f32 v232, v160
v_exp_f32 v233, v161
v_exp_f32 v234, v162
v_exp_f32 v235, v163
v_add_f32 v251, v232, v233
v_cvt_pk_bf16_f32 v224, v232, v233
v_exp_f32 v232, v164
v_exp_f32 v233, v165
v_add_f32 v251, v251, v234
v_cvt_pk_bf16_f32 v225, v234, v235
v_add_f32 v251, v251, v235
v_exp_f32 v234, v166
v_exp_f32 v235, v167
v_add_f32 v251, v251, v232
v_cvt_pk_bf16_f32 v226, v232, v233
v_add_f32 v251, v251, v233
s_barrier
s_waitcnt lgkmcnt(7)
v_mfma_f32_32x32x16_bf16 v[96:111], v[64:67], v[128:131], v[112:127]
ds_read_b64_tr_b16 v[64:65], v244 offset:0
ds_read_b64_tr_b16 v[66:67], v244 offset:2048
v_exp_f32 v232, v168
v_exp_f32 v233, v169
v_add_f32 v251, v251, v234
v_cvt_pk_bf16_f32 v227, v234, v235
v_add_f32 v251, v251, v235
s_waitcnt lgkmcnt(8)
v_mfma_f32_32x32x16_bf16 v[96:111], v[68:71], v[132:135], v[96:111]
ds_read_b64_tr_b16 v[68:69], v245 offset:0
ds_read_b64_tr_b16 v[70:71], v245 offset:2048
s_waitcnt lgkmcnt(9)
v_mfma_f32_32x32x16_bf16 v[96:111], v[72:75], v[136:139], v[96:111]
ds_read_b64_tr_b16 v[72:73], v246 offset:0
ds_read_b64_tr_b16 v[74:75], v246 offset:2048
v_exp_f32 v234, v170
v_exp_f32 v235, v171
v_add_f32 v251, v251, v232
v_cvt_pk_bf16_f32 v228, v232, v233
v_add_f32 v251, v251, v233
s_waitcnt lgkmcnt(10)
v_mfma_f32_32x32x16_bf16 v[96:111], v[76:79], v[140:143], v[96:111]
ds_read_b64_tr_b16 v[76:77], v247 offset:0
ds_read_b64_tr_b16 v[78:79], v247 offset:2048
s_waitcnt lgkmcnt(11)
v_mfma_f32_32x32x16_bf16 v[96:111], v[80:83], v[144:147], v[96:111]
ds_read_b64_tr_b16 v[80:81], v244 offset:4096
ds_read_b64_tr_b16 v[82:83], v244 offset:6144
v_exp_f32 v232, v172
v_exp_f32 v233, v173
v_add_f32 v251, v251, v234
v_cvt_pk_bf16_f32 v229, v234, v235
v_add_f32 v251, v251, v235
s_waitcnt lgkmcnt(12)
v_mfma_f32_32x32x16_bf16 v[96:111], v[84:87], v[148:151], v[96:111]
ds_read_b64_tr_b16 v[84:85], v245 offset:4096
ds_read_b64_tr_b16 v[86:87], v245 offset:6144
v_exp_f32 v234, v174
v_exp_f32 v235, v175
v_add_f32 v251, v251, v232
v_cvt_pk_bf16_f32 v230, v232, v233
v_add_f32 v251, v251, v233
s_waitcnt lgkmcnt(13)
v_mfma_f32_32x32x16_bf16 v[96:111], v[88:91], v[152:155], v[96:111]
ds_read_b64_tr_b16 v[88:89], v246 offset:4096
ds_read_b64_tr_b16 v[90:91], v246 offset:6144
v_add_f32 v251, v251, v234
v_cvt_pk_bf16_f32 v231, v234, v235
v_add_f32 v251, v251, v235
s_waitcnt lgkmcnt(14)
v_mfma_f32_32x32x16_bf16 v[96:111], v[92:95], v[156:159], v[96:111]
ds_read_b64_tr_b16 v[92:93], v247 offset:4096
ds_read_b64_tr_b16 v[94:95], v247 offset:6144
v_mov_b32 v248, v251
s_waitcnt lgkmcnt(14)
v_mfma_f32_32x32x16_bf16 v[0:15], v[64:67], v[224:227], 0
ds_read_b128 v[64:67], v236 offset:16384
ds_write_b128 v253, v[176:179] offset:32768
s_waitcnt lgkmcnt(14)
v_mfma_f32_32x32x16_bf16 v[16:31], v[68:71], v[224:227], 0
ds_read_b128 v[68:71], v237 offset:16384
v_add_u32 v253, 40960, v253
ds_write_b128 v253, v[180:183] offset:32768
s_nop 1
v_subrev_u32 v253, 40960, v253
s_waitcnt lgkmcnt(14)
v_mfma_f32_32x32x16_bf16 v[32:47], v[72:75], v[224:227], 0
ds_read_b128 v[72:75], v238 offset:16384
ds_write_b128 v253, v[184:187] offset:0
s_waitcnt lgkmcnt(14)
v_mfma_f32_32x32x16_bf16 v[48:63], v[76:79], v[224:227], 0
ds_read_b128 v[76:79], v239 offset:16384
v_exp_f32 v232, v96
v_exp_f32 v233, v97
ds_write_b128 v253, v[188:191] offset:40960
s_waitcnt lgkmcnt(14)
v_mfma_f32_32x32x16_bf16 v[0:15], v[80:83], v[228:231], v[0:15]
ds_read_b128 v[80:83], v240 offset:16384
v_exp_f32 v234, v98
v_exp_f32 v235, v99
v_add_f32 v251, v232, v233
v_cvt_pk_bf16_f32 v224, v232, v233
ds_write_b128 v254, v[192:195] offset:32768
s_waitcnt lgkmcnt(14)
v_mfma_f32_32x32x16_bf16 v[16:31], v[84:87], v[228:231], v[16:31]
ds_read_b128 v[84:87], v241 offset:16384
v_exp_f32 v232, v100
v_exp_f32 v233, v101
v_add_f32 v251, v251, v234
v_cvt_pk_bf16_f32 v225, v234, v235
v_add_f32 v251, v251, v235
v_add_u32 v254, 40960, v254
ds_write_b128 v254, v[196:199] offset:32768
s_nop 1
v_subrev_u32 v254, 40960, v254
s_waitcnt lgkmcnt(14)
v_mfma_f32_32x32x16_bf16 v[32:47], v[88:91], v[228:231], v[32:47]
ds_read_b128 v[88:91], v242 offset:16384
v_exp_f32 v234, v102
v_exp_f32 v235, v103
v_add_f32 v251, v251, v232
v_cvt_pk_bf16_f32 v226, v232, v233
v_add_f32 v251, v251, v233
s_waitcnt lgkmcnt(13)
v_mfma_f32_32x32x16_bf16 v[48:63], v[92:95], v[228:231], v[48:63]
ds_read_b128 v[92:95], v243 offset:16384
s_waitcnt vmcnt(3)
s_waitcnt lgkmcnt(2)
s_barrier
v_mfma_f32_32x32x16_bf16 v[160:175], v[64:67], v[128:131], v[112:127]
ds_read_b64_tr_b16 v[64:65], v244 offset:8192
ds_read_b64_tr_b16 v[66:67], v244 offset:10240
v_exp_f32 v232, v104
v_exp_f32 v233, v105
v_add_f32 v251, v251, v234
v_cvt_pk_bf16_f32 v227, v234, v235
v_add_f32 v251, v251, v235
v_mfma_f32_32x32x16_bf16 v[160:175], v[68:71], v[132:135], v[160:175]
ds_read_b64_tr_b16 v[68:69], v245 offset:8192
ds_read_b64_tr_b16 v[70:71], v245 offset:10240
v_mfma_f32_32x32x16_bf16 v[160:175], v[72:75], v[136:139], v[160:175]
ds_read_b64_tr_b16 v[72:73], v246 offset:8192
ds_read_b64_tr_b16 v[74:75], v246 offset:10240
v_exp_f32 v234, v106
v_exp_f32 v235, v107
v_add_f32 v251, v251, v232
v_cvt_pk_bf16_f32 v228, v232, v233
v_add_f32 v251, v251, v233
v_mfma_f32_32x32x16_bf16 v[160:175], v[76:79], v[140:143], v[160:175]
ds_read_b64_tr_b16 v[76:77], v247 offset:8192
ds_read_b64_tr_b16 v[78:79], v247 offset:10240
v_mfma_f32_32x32x16_bf16 v[160:175], v[80:83], v[144:147], v[160:175]
ds_read_b64_tr_b16 v[80:81], v244 offset:12288
ds_read_b64_tr_b16 v[82:83], v244 offset:14336
v_exp_f32 v232, v108
v_exp_f32 v233, v109
v_add_f32 v251, v251, v234
v_cvt_pk_bf16_f32 v229, v234, v235
v_add_f32 v251, v251, v235
v_mfma_f32_32x32x16_bf16 v[160:175], v[84:87], v[148:151], v[160:175]
ds_read_b64_tr_b16 v[84:85], v245 offset:12288
ds_read_b64_tr_b16 v[86:87], v245 offset:14336
v_exp_f32 v234, v110
v_exp_f32 v235, v111
v_add_f32 v251, v251, v232
v_cvt_pk_bf16_f32 v230, v232, v233
v_add_f32 v251, v251, v233
s_waitcnt lgkmcnt(13)
v_mfma_f32_32x32x16_bf16 v[160:175], v[88:91], v[152:155], v[160:175]
ds_read_b64_tr_b16 v[88:89], v246 offset:12288
ds_read_b64_tr_b16 v[90:91], v246 offset:14336
v_add_f32 v251, v251, v234
v_cvt_pk_bf16_f32 v231, v234, v235
v_add_f32 v251, v251, v235
s_waitcnt lgkmcnt(14)
v_mfma_f32_32x32x16_bf16 v[160:175], v[92:95], v[156:159], v[160:175]
ds_read_b64_tr_b16 v[92:93], v247 offset:12288
ds_read_b64_tr_b16 v[94:95], v247 offset:14336
v_cmp_lt_f32 vcc, s48, v251
s_mov_b32 s49, 17
s_cbranch_vccnz FIX_1
SM_17:
v_add_f32 v248, v248, v251
s_waitcnt lgkmcnt(14)
v_mfma_f32_32x32x16_bf16 v[0:15], v[64:67], v[224:227], v[0:15]
ds_read_b128 v[64:67], v236 offset:24576
ds_write_b128 v253, v[200:203] offset:8192
s_waitcnt lgkmcnt(14)
v_mfma_f32_32x32x16_bf16 v[16:31], v[68:71], v[224:227], v[16:31]
ds_read_b128 v[68:71], v237 offset:24576
ds_write_b128 v253, v[204:207] offset:49152
s_waitcnt lgkmcnt(14)
v_mfma_f32_32x32x16_bf16 v[32:47], v[72:75], v[224:227], v[32:47]
ds_read_b128 v[72:75], v238 offset:24576
ds_write_b128 v254, v[208:211] offset:0
s_waitcnt lgkmcnt(14)
v_mfma_f32_32x32x16_bf16 v[48:63], v[76:79], v[224:227], v[48:63]
ds_read_b128 v[76:79], v239 offset:24576
v_exp_f32 v232, v160
v_exp_f32 v233, v161
ds_write_b128 v254, v[212:215] offset:40960
s_waitcnt lgkmcnt(14)
v_mfma_f32_32x32x16_bf16 v[0:15], v[80:83], v[228:231], v[0:15]
ds_read_b128 v[80:83], v240 offset:24576
v_exp_f32 v234, v162
v_exp_f32 v235, v163
v_add_f32 v251, v232, v233
v_cvt_pk_bf16_f32 v224, v232, v233
s_waitcnt lgkmcnt(13)
v_mfma_f32_32x32x16_bf16 v[16:31], v[84:87], v[228:231], v[16:31]
ds_read_b128 v[84:87], v241 offset:24576
v_exp_f32 v232, v164
v_exp_f32 v233, v165
v_add_f32 v251, v251, v234
v_cvt_pk_bf16_f32 v225, v234, v235
v_add_f32 v251, v251, v235
s_waitcnt lgkmcnt(12)
v_mfma_f32_32x32x16_bf16 v[32:47], v[88:91], v[228:231], v[32:47]
ds_read_b128 v[88:91], v242 offset:24576
v_exp_f32 v234, v166
v_exp_f32 v235, v167
v_add_f32 v251, v251, v232
v_cvt_pk_bf16_f32 v226, v232, v233
v_add_f32 v251, v251, v233
s_waitcnt lgkmcnt(11)
v_mfma_f32_32x32x16_bf16 v[48:63], v[92:95], v[228:231], v[48:63]
ds_read_b128 v[92:95], v243 offset:24576
s_waitcnt lgkmcnt(4)
s_barrier
v_mfma_f32_32x32x16_bf16 v[96:111], v[64:67], v[128:131], v[112:127]
ds_read_b64_tr_b16 v[64:65], v244 offset:16384
ds_read_b64_tr_b16 v[66:67], v244 offset:18432
v_exp_f32 v232, v168
v_exp_f32 v233, v169
v_add_f32 v251, v251, v234
v_cvt_pk_bf16_f32 v227, v234, v235
v_add_f32 v251, v251, v235
v_mfma_f32_32x32x16_bf16 v[96:111], v[68:71], v[132:135], v[96:111]
ds_read_b64_tr_b16 v[68:69], v245 offset:16384
ds_read_b64_tr_b16 v[70:71], v245 offset:18432
v_mfma_f32_32x32x16_bf16 v[96:111], v[72:75], v[136:139], v[96:111]
ds_read_b64_tr_b16 v[72:73], v246 offset:16384
ds_read_b64_tr_b16 v[74:75], v246 offset:18432
v_exp_f32 v234, v170
v_exp_f32 v235, v171
v_add_f32 v251, v251, v232
v_cvt_pk_bf16_f32 v228, v232, v233
v_add_f32 v251, v251, v233
v_mfma_f32_32x32x16_bf16 v[96:111], v[76:79], v[140:143], v[96:111]
ds_read_b64_tr_b16 v[76:77], v247 offset:16384
ds_read_b64_tr_b16 v[78:79], v247 offset:18432
s_waitcnt lgkmcnt(11)
v_mfma_f32_32x32x16_bf16 v[96:111], v[80:83], v[144:147], v[96:111]
ds_read_b64_tr_b16 v[80:81], v244 offset:20480
ds_read_b64_tr_b16 v[82:83], v244 offset:22528
v_exp_f32 v232, v172
v_exp_f32 v233, v173
v_add_f32 v251, v251, v234
v_cvt_pk_bf16_f32 v229, v234, v235
v_add_f32 v251, v251, v235
s_waitcnt lgkmcnt(12)
v_mfma_f32_32x32x16_bf16 v[96:111], v[84:87], v[148:151], v[96:111]
ds_read_b64_tr_b16 v[84:85], v245 offset:20480
ds_read_b64_tr_b16 v[86:87], v245 offset:22528
v_exp_f32 v234, v174
v_exp_f32 v235, v175
v_add_f32 v251, v251, v232
v_cvt_pk_bf16_f32 v230, v232, v233
v_add_f32 v251, v251, v233
s_waitcnt lgkmcnt(13)
v_mfma_f32_32x32x16_bf16 v[96:111], v[88:91], v[152:155], v[96:111]
ds_read_b64_tr_b16 v[88:89], v246 offset:20480
ds_read_b64_tr_b16 v[90:91], v246 offset:22528
v_add_f32 v251, v251, v234
v_cvt_pk_bf16_f32 v231, v234, v235
v_add_f32 v251, v251, v235
s_waitcnt lgkmcnt(14)
v_mfma_f32_32x32x16_bf16 v[96:111], v[92:95], v[156:159], v[96:111]
ds_read_b64_tr_b16 v[92:93], v247 offset:20480
ds_read_b64_tr_b16 v[94:95], v247 offset:22528
v_cmp_lt_f32 vcc, s48, v251
s_mov_b32 s49, 18
s_cbranch_vccnz FIX_0
SM_18:
v_add_f32 v248, v248, v251
s_waitcnt lgkmcnt(14)
v_mfma_f32_32x32x16_bf16 v[0:15], v[64:67], v[224:227], v[0:15]
ds_read_b128 v[64:67], v236 offset:32768
ds_write_b128 v253, v[216:219] offset:16384
s_waitcnt lgkmcnt(14)
v_mfma_f32_32x32x16_bf16 v[16:31], v[68:71], v[224:227], v[16:31]
ds_read_b128 v[68:71], v237 offset:32768
ds_write_b128 v253, v[220:223] offset:57344
s_waitcnt lgkmcnt(14)
v_mfma_f32_32x32x16_bf16 v[32:47], v[72:75], v[224:227], v[32:47]
ds_read_b128 v[72:75], v238 offset:32768
s_add_u32 s54, s5, 49152
s_and_b32 s54, s54, 0x1ffff
s_add_u32 m0, s50, 90112
s_nop 0
buffer_load_dwordx4 v250, s[16:19], s54 offen nt lds
s_waitcnt lgkmcnt(13)
v_mfma_f32_32x32x16_bf16 v[48:63], v[76:79], v[224:227], v[48:63]
ds_read_b128 v[76:79], v239 offset:32768
v_exp_f32 v232, v96
v_exp_f32 v233, v97
s_or_b32 s54, s54, 0x100000
s_add_u32 m0, s50, 131072
s_nop 0
buffer_load_dwordx4 v250, s[16:19], s54 offen nt lds
s_waitcnt lgkmcnt(12)
v_mfma_f32_32x32x16_bf16 v[0:15], v[80:83], v[228:231], v[0:15]
ds_read_b128 v[80:83], v240 offset:32768
v_exp_f32 v234, v98
v_exp_f32 v235, v99
v_add_f32 v251, v232, v233
v_cvt_pk_bf16_f32 v224, v232, v233
s_waitcnt lgkmcnt(11)
v_mfma_f32_32x32x16_bf16 v[16:31], v[84:87], v[228:231], v[16:31]
ds_read_b128 v[84:87], v241 offset:32768
v_exp_f32 v232, v100
v_exp_f32 v233, v101
v_add_f32 v251, v251, v234
v_cvt_pk_bf16_f32 v225, v234, v235
v_add_f32 v251, v251, v235
s_waitcnt lgkmcnt(10)
v_mfma_f32_32x32x16_bf16 v[32:47], v[88:91], v[228:231], v[32:47]
ds_read_b128 v[88:91], v242 offset:32768
v_exp_f32 v234, v102
v_exp_f32 v235, v103
v_add_f32 v251, v251, v232
v_cvt_pk_bf16_f32 v226, v232, v233
v_add_f32 v251, v251, v233
s_waitcnt lgkmcnt(9)
v_mfma_f32_32x32x16_bf16 v[48:63], v[92:95], v[228:231], v[48:63]
ds_read_b128 v[92:95], v243 offset:32768
s_waitcnt vmcnt(3)
s_waitcnt lgkmcnt(6)
s_barrier
v_mfma_f32_32x32x16_bf16 v[160:175], v[64:67], v[128:131], v[112:127]
ds_read_b64_tr_b16 v[64:65], v244 offset:24576
ds_read_b64_tr_b16 v[66:67], v244 offset:26624
v_exp_f32 v232, v104
v_exp_f32 v233, v105
v_add_f32 v251, v251, v234
v_cvt_pk_bf16_f32 v227, v234, v235
v_add_f32 v251, v251, v235
v_mfma_f32_32x32x16_bf16 v[160:175], v[68:71], v[132:135], v[160:175]
ds_read_b64_tr_b16 v[68:69], v245 offset:24576
ds_read_b64_tr_b16 v[70:71], v245 offset:26624
s_waitcnt lgkmcnt(9)
v_mfma_f32_32x32x16_bf16 v[160:175], v[72:75], v[136:139], v[160:175]
ds_read_b64_tr_b16 v[72:73], v246 offset:24576
ds_read_b64_tr_b16 v[74:75], v246 offset:26624
v_exp_f32 v234, v106
v_exp_f32 v235, v107
v_add_f32 v251, v251, v232
v_cvt_pk_bf16_f32 v228, v232, v233
v_add_f32 v251, v251, v233
s_waitcnt lgkmcnt(10)
v_mfma_f32_32x32x16_bf16 v[160:175], v[76:79], v[140:143], v[160:175]
ds_read_b64_tr_b16 v[76:77], v247 offset:24576
ds_read_b64_tr_b16 v[78:79], v247 offset:26624
s_waitcnt lgkmcnt(11)
v_mfma_f32_32x32x16_bf16 v[160:175], v[80:83], v[144:147], v[160:175]
ds_read_b64_tr_b16 v[80:81], v244 offset:28672
ds_read_b64_tr_b16 v[82:83], v244 offset:30720
v_exp_f32 v232, v108
v_exp_f32 v233, v109
v_add_f32 v251, v251, v234
v_cvt_pk_bf16_f32 v229, v234, v235
v_add_f32 v251, v251, v235
s_waitcnt lgkmcnt(12)
v_mfma_f32_32x32x16_bf16 v[160:175], v[84:87], v[148:151], v[160:175]
ds_read_b64_tr_b16 v[84:85], v245 offset:28672
ds_read_b64_tr_b16 v[86:87], v245 offset:30720
v_exp_f32 v234, v110
v_exp_f32 v235, v111
v_add_f32 v251, v251, v232
v_cvt_pk_bf16_f32 v230, v232, v233
v_add_f32 v251, v251, v233
s_waitcnt lgkmcnt(13)
v_mfma_f32_32x32x16_bf16 v[160:175], v[88:91], v[152:155], v[160:175]
ds_read_b64_tr_b16 v[88:89], v246 offset:28672
ds_read_b64_tr_b16 v[90:91], v246 offset:30720
v_add_f32 v251, v251, v234
v_cvt_pk_bf16_f32 v231, v234, v235
v_add_f32 v251, v251, v235
s_waitcnt lgkmcnt(14)
v_mfma_f32_32x32x16_bf16 v[160:175], v[92:95], v[156:159], v[160:175]
ds_read_b64_tr_b16 v[92:93], v247 offset:28672
ds_read_b64_tr_b16 v[94:95], v247 offset:30720
v_cmp_lt_f32 vcc, s48, v251
s_mov_b32 s49, 19
s_cbranch_vccnz FIX_1
SM_19:
v_add_f32 v248, v248, v251
s_waitcnt lgkmcnt(14)
v_mfma_f32_32x32x16_bf16 v[0:15], v[64:67], v[224:227], v[0:15]
ds_read_b128 v[64:67], v236 offset:0
s_add_u32 s54, s5, 65536
s_and_b32 s54, s54, 0x1ffff
s_add_u32 m0, s50, 24576
s_nop 0
buffer_load_dwordx4 v249, s[12:15], s54 offen nt lds
s_waitcnt lgkmcnt(13)
v_mfma_f32_32x32x16_bf16 v[16:31], v[68:71], v[224:227], v[16:31]
ds_read_b128 v[68:71], v237 offset:0
s_or_b32 s54, s54, 0x100000
s_add_u32 m0, s50, 65536
s_nop 0
buffer_load_dwordx4 v249, s[12:15], s54 offen nt lds
s_waitcnt lgkmcnt(12)
v_mfma_f32_32x32x16_bf16 v[32:47], v[72:75], v[224:227], v[32:47]
ds_read_b128 v[72:75], v238 offset:0
s_add_u32 s54, s5, 57344
s_and_b32 s54, s54, 0x1ffff
s_add_u32 m0, s50, 98304
s_nop 0
buffer_load_dwordx4 v250, s[16:19], s54 offen nt lds
s_waitcnt lgkmcnt(11)
v_mfma_f32_32x32x16_bf16 v[48:63], v[76:79], v[224:227], v[48:63]
ds_read_b128 v[76:79], v239 offset:0
v_exp_f32 v232, v160
v_exp_f32 v233, v161
s_or_b32 s54, s54, 0x100000
s_add_u32 m0, s50, 139264
s_nop 0
buffer_load_dwordx4 v250, s[16:19], s54 offen nt lds
s_waitcnt lgkmcnt(10)
v_mfma_f32_32x32x16_bf16 v[0:15], v[80:83], v[228:231], v[0:15]
ds_read_b128 v[80:83], v240 offset:0
v_exp_f32 v234, v162
v_exp_f32 v235, v163
v_add_f32 v251, v232, v233
v_cvt_pk_bf16_f32 v224, v232, v233
s_waitcnt lgkmcnt(9)
v_mfma_f32_32x32x16_bf16 v[16:31], v[84:87], v[228:231], v[16:31]
ds_read_b128 v[84:87], v241 offset:0
v_exp_f32 v232, v164
v_exp_f32 v233, v165
v_add_f32 v251, v251, v234
v_cvt_pk_bf16_f32 v225, v234, v235
v_add_f32 v251, v251, v235
s_waitcnt lgkmcnt(8)
v_mfma_f32_32x32x16_bf16 v[32:47], v[88:91], v[228:231], v[32:47]
ds_read_b128 v[88:91], v242 offset:0
v_exp_f32 v234, v166
v_exp_f32 v235, v167
v_add_f32 v251, v251, v232
v_cvt_pk_bf16_f32 v226, v232, v233
v_add_f32 v251, v251, v233
s_waitcnt lgkmcnt(7)
v_mfma_f32_32x32x16_bf16 v[48:63], v[92:95], v[228:231], v[48:63]
ds_read_b128 v[92:95], v243 offset:0
s_barrier
s_waitcnt lgkmcnt(7)
v_mfma_f32_32x32x16_bf16 v[96:111], v[64:67], v[128:131], v[112:127]
ds_read_b64_tr_b16 v[64:65], v244 offset:32768
ds_read_b64_tr_b16 v[66:67], v244 offset:34816
v_exp_f32 v232, v168
v_exp_f32 v233, v169
v_add_f32 v251, v251, v234
v_cvt_pk_bf16_f32 v227, v234, v235
v_add_f32 v251, v251, v235
s_waitcnt lgkmcnt(8)
v_mfma_f32_32x32x16_bf16 v[96:111], v[68:71], v[132:135], v[96:111]
ds_read_b64_tr_b16 v[68:69], v245 offset:32768
ds_read_b64_tr_b16 v[70:71], v245 offset:34816
s_waitcnt lgkmcnt(9)
v_mfma_f32_32x32x16_bf16 v[96:111], v[72:75], v[136:139], v[96:111]
ds_read_b64_tr_b16 v[72:73], v246 offset:32768
ds_read_b64_tr_b16 v[74:75], v246 offset:34816
v_exp_f32 v234, v170
v_exp_f32 v235, v171
v_add_f32 v251, v251, v232
v_cvt_pk_bf16_f32 v228, v232, v233
v_add_f32 v251, v251, v233
s_waitcnt lgkmcnt(10)
v_mfma_f32_32x32x16_bf16 v[96:111], v[76:79], v[140:143], v[96:111]
ds_read_b64_tr_b16 v[76:77], v247 offset:32768
ds_read_b64_tr_b16 v[78:79], v247 offset:34816
s_waitcnt lgkmcnt(11)
v_mfma_f32_32x32x16_bf16 v[96:111], v[80:83], v[144:147], v[96:111]
ds_read_b64_tr_b16 v[80:81], v244 offset:36864
ds_read_b64_tr_b16 v[82:83], v244 offset:38912
v_exp_f32 v232, v172
v_exp_f32 v233, v173
v_add_f32 v251, v251, v234
v_cvt_pk_bf16_f32 v229, v234, v235
v_add_f32 v251, v251, v235
s_waitcnt lgkmcnt(12)
v_mfma_f32_32x32x16_bf16 v[96:111], v[84:87], v[148:151], v[96:111]
ds_read_b64_tr_b16 v[84:85], v245 offset:36864
ds_read_b64_tr_b16 v[86:87], v245 offset:38912
v_exp_f32 v234, v174
v_exp_f32 v235, v175
v_add_f32 v251, v251, v232
v_cvt_pk_bf16_f32 v230, v232, v233
v_add_f32 v251, v251, v233
s_waitcnt lgkmcnt(13)
v_mfma_f32_32x32x16_bf16 v[96:111], v[88:91], v[152:155], v[96:111]
ds_read_b64_tr_b16 v[88:89], v246 offset:36864
ds_read_b64_tr_b16 v[90:91], v246 offset:38912
v_add_f32 v251, v251, v234
v_cvt_pk_bf16_f32 v231, v234, v235
v_add_f32 v251, v251, v235
s_waitcnt lgkmcnt(14)
v_mfma_f32_32x32x16_bf16 v[96:111], v[92:95], v[156:159], v[96:111]
ds_read_b64_tr_b16 v[92:93], v247 offset:36864
ds_read_b64_tr_b16 v[94:95], v247 offset:38912
v_cmp_lt_f32 vcc, s48, v251
s_mov_b32 s49, 20
s_cbranch_vccnz FIX_0
SM_20:
v_add_f32 v248, v248, v251
s_waitcnt lgkmcnt(14)
v_mfma_f32_32x32x16_bf16 v[0:15], v[64:67], v[224:227], v[0:15]
ds_read_b128 v[64:67], v236 offset:8192
s_add_u32 s54, s5, 73728
s_and_b32 s54, s54, 0x1ffff
s_add_u32 m0, s50, 32768
s_nop 0
buffer_load_dwordx4 v249, s[12:15], s54 offen nt lds
s_waitcnt lgkmcnt(13)
v_mfma_f32_32x32x16_bf16 v[16:31], v[68:71], v[224:227], v[16:31]
ds_read_b128 v[68:71], v237 offset:8192
s_or_b32 s54, s54, 0x100000
s_add_u32 m0, s50, 73728
s_nop 0
buffer_load_dwordx4 v249, s[12:15], s54 offen nt lds
s_waitcnt lgkmcnt(12)
v_mfma_f32_32x32x16_bf16 v[32:47], v[72:75], v[224:227], v[32:47]
ds_read_b128 v[72:75], v238 offset:8192
s_add_u32 s54, s5, 65536
s_and_b32 s54, s54, 0x1ffff
s_add_u32 m0, s50, 106496
s_nop 0
buffer_load_dwordx4 v250, s[16:19], s54 offen nt lds
s_waitcnt lgkmcnt(11)
v_mfma_f32_32x32x16_bf16 v[48:63], v[76:79], v[224:227], v[48:63]
ds_read_b128 v[76:79], v239 offset:8192
v_exp_f32 v232, v96
v_exp_f32 v233, v97
s_or_b32 s54, s54, 0x100000
s_add_u32 m0, s50, 147456
s_nop 0
buffer_load_dwordx4 v250, s[16:19], s54 offen nt lds
s_waitcnt lgkmcnt(10)
v_mfma_f32_32x32x16_bf16 v[0:15], v[80:83], v[228:231], v[0:15]
ds_read_b128 v[80:83], v240 offset:8192
v_exp_f32 v234, v98
v_exp_f32 v235, v99
v_add_f32 v251, v232, v233
v_cvt_pk_bf16_f32 v224, v232, v233
s_waitcnt lgkmcnt(9)
v_mfma_f32_32x32x16_bf16 v[16:31], v[84:87], v[228:231], v[16:31]
ds_read_b128 v[84:87], v241 offset:8192
v_exp_f32 v232, v100
v_exp_f32 v233, v101
v_add_f32 v251, v251, v234
v_cvt_pk_bf16_f32 v225, v234, v235
v_add_f32 v251, v251, v235
s_waitcnt lgkmcnt(8)
v_mfma_f32_32x32x16_bf16 v[32:47], v[88:91], v[228:231], v[32:47]
ds_read_b128 v[88:91], v242 offset:8192
v_exp_f32 v234, v102
v_exp_f32 v235, v103
v_add_f32 v251, v251, v232
v_cvt_pk_bf16_f32 v226, v232, v233
v_add_f32 v251, v251, v233
s_waitcnt lgkmcnt(7)
v_mfma_f32_32x32x16_bf16 v[48:63], v[92:95], v[228:231], v[48:63]
ds_read_b128 v[92:95], v243 offset:8192
s_barrier
s_waitcnt lgkmcnt(7)
v_mfma_f32_32x32x16_bf16 v[160:175], v[64:67], v[128:131], v[112:127]
ds_read_b64_tr_b16 v[64:65], v244 offset:0
ds_read_b64_tr_b16 v[66:67], v244 offset:2048
v_exp_f32 v232, v104
v_exp_f32 v233, v105
v_add_f32 v251, v251, v234
v_cvt_pk_bf16_f32 v227, v234, v235
v_add_f32 v251, v251, v235
s_waitcnt lgkmcnt(8)
v_mfma_f32_32x32x16_bf16 v[160:175], v[68:71], v[132:135], v[160:175]
ds_read_b64_tr_b16 v[68:69], v245 offset:0
ds_read_b64_tr_b16 v[70:71], v245 offset:2048
s_waitcnt lgkmcnt(9)
v_mfma_f32_32x32x16_bf16 v[160:175], v[72:75], v[136:139], v[160:175]
ds_read_b64_tr_b16 v[72:73], v246 offset:0
ds_read_b64_tr_b16 v[74:75], v246 offset:2048
v_exp_f32 v234, v106
v_exp_f32 v235, v107
v_add_f32 v251, v251, v232
v_cvt_pk_bf16_f32 v228, v232, v233
v_add_f32 v251, v251, v233
s_waitcnt lgkmcnt(10)
v_mfma_f32_32x32x16_bf16 v[160:175], v[76:79], v[140:143], v[160:175]
ds_read_b64_tr_b16 v[76:77], v247 offset:0
ds_read_b64_tr_b16 v[78:79], v247 offset:2048
s_waitcnt lgkmcnt(11)
v_mfma_f32_32x32x16_bf16 v[160:175], v[80:83], v[144:147], v[160:175]
ds_read_b64_tr_b16 v[80:81], v244 offset:4096
ds_read_b64_tr_b16 v[82:83], v244 offset:6144
v_exp_f32 v232, v108
v_exp_f32 v233, v109
v_add_f32 v251, v251, v234
v_cvt_pk_bf16_f32 v229, v234, v235
v_add_f32 v251, v251, v235
s_waitcnt lgkmcnt(12)
v_mfma_f32_32x32x16_bf16 v[160:175], v[84:87], v[148:151], v[160:175]
ds_read_b64_tr_b16 v[84:85], v245 offset:4096
ds_read_b64_tr_b16 v[86:87], v245 offset:6144
v_exp_f32 v234, v110
v_exp_f32 v235, v111
v_add_f32 v251, v251, v232
v_cvt_pk_bf16_f32 v230, v232, v233
v_add_f32 v251, v251, v233
s_waitcnt lgkmcnt(13)
v_mfma_f32_32x32x16_bf16 v[160:175], v[88:91], v[152:155], v[160:175]
ds_read_b64_tr_b16 v[88:89], v246 offset:4096
ds_read_b64_tr_b16 v[90:91], v246 offset:6144
v_add_f32 v251, v251, v234
v_cvt_pk_bf16_f32 v231, v234, v235
v_add_f32 v251, v251, v235
s_waitcnt lgkmcnt(14)
v_mfma_f32_32x32x16_bf16 v[160:175], v[92:95], v[156:159], v[160:175]
ds_read_b64_tr_b16 v[92:93], v247 offset:4096
ds_read_b64_tr_b16 v[94:95], v247 offset:6144
v_cmp_lt_f32 vcc, s48, v251
s_mov_b32 s49, 21
s_cbranch_vccnz FIX_1
SM_21:
v_add_f32 v248, v248, v251
s_waitcnt lgkmcnt(14)
v_mfma_f32_32x32x16_bf16 v[0:15], v[64:67], v[224:227], v[0:15]
ds_read_b128 v[64:67], v236 offset:16384
s_add_u32 s54, s5, 81920
s_and_b32 s54, s54, 0x1ffff
s_add_u32 m0, s50, 0
s_nop 0
buffer_load_dwordx4 v249, s[12:15], s54 offen nt lds
s_waitcnt lgkmcnt(13)
v_mfma_f32_32x32x16_bf16 v[16:31], v[68:71], v[224:227], v[16:31]
ds_read_b128 v[68:71], v237 offset:16384
s_or_b32 s54, s54, 0x100000
s_add_u32 m0, s50, 40960
s_nop 0
buffer_load_dwordx4 v249, s[12:15], s54 offen nt lds
s_waitcnt lgkmcnt(12)
v_mfma_f32_32x32x16_bf16 v[32:47], v[72:75], v[224:227], v[32:47]
ds_read_b128 v[72:75], v238 offset:16384
s_add_u32 s54, s5, 73728
s_and_b32 s54, s54, 0x1ffff
s_add_u32 m0, s50, 114688
s_nop 0
buffer_load_dwordx4 v250, s[16:19], s54 offen nt lds
s_waitcnt lgkmcnt(11)
v_mfma_f32_32x32x16_bf16 v[48:63], v[76:79], v[224:227], v[48:63]
ds_read_b128 v[76:79], v239 offset:16384
v_exp_f32 v232, v160
v_exp_f32 v233, v161
s_or_b32 s54, s54, 0x100000
s_add_u32 m0, s50, 155648
s_nop 0
buffer_load_dwordx4 v250, s[16:19], s54 offen nt lds
s_waitcnt lgkmcnt(10)
v_mfma_f32_32x32x16_bf16 v[0:15], v[80:83], v[228:231], v[0:15]
ds_read_b128 v[80:83], v240 offset:16384
v_exp_f32 v234, v162
v_exp_f32 v235, v163
v_add_f32 v251, v232, v233
v_cvt_pk_bf16_f32 v224, v232, v233
s_waitcnt lgkmcnt(9)
v_mfma_f32_32x32x16_bf16 v[16:31], v[84:87], v[228:231], v[16:31]
ds_read_b128 v[84:87], v241 offset:16384
v_exp_f32 v232, v164
v_exp_f32 v233, v165
v_add_f32 v251, v251, v234
v_cvt_pk_bf16_f32 v225, v234, v235
v_add_f32 v251, v251, v235
s_waitcnt lgkmcnt(8)
v_mfma_f32_32x32x16_bf16 v[32:47], v[88:91], v[228:231], v[32:47]
ds_read_b128 v[88:91], v242 offset:16384
v_exp_f32 v234, v166
v_exp_f32 v235, v167
v_add_f32 v251, v251, v232
v_cvt_pk_bf16_f32 v226, v232, v233
v_add_f32 v251, v251, v233
s_waitcnt lgkmcnt(7)
v_mfma_f32_32x32x16_bf16 v[48:63], v[92:95], v[228:231], v[48:63]
ds_read_b128 v[92:95], v243 offset:16384
L_join:
s_waitcnt vmcnt(10)
s_barrier
s_waitcnt lgkmcnt(7)
v_mfma_f32_32x32x16_bf16 v[96:111], v[64:67], v[128:131], v[112:127]
ds_read_b64_tr_b16 v[64:65], v244 offset:8192
ds_read_b64_tr_b16 v[66:67], v244 offset:10240
v_exp_f32 v232, v168
v_exp_f32 v233, v169
v_add_f32 v251, v251, v234
v_cvt_pk_bf16_f32 v227, v234, v235
v_add_f32 v251, v251, v235
s_waitcnt lgkmcnt(8)
v_mfma_f32_32x32x16_bf16 v[96:111], v[68:71], v[132:135], v[96:111]
ds_read_b64_tr_b16 v[68:69], v245 offset:8192
ds_read_b64_tr_b16 v[70:71], v245 offset:10240
s_waitcnt lgkmcnt(9)
v_mfma_f32_32x32x16_bf16 v[96:111], v[72:75], v[136:139], v[96:111]
ds_read_b64_tr_b16 v[72:73], v246 offset:8192
ds_read_b64_tr_b16 v[74:75], v246 offset:10240
v_exp_f32 v234, v170
v_exp_f32 v235, v171
v_add_f32 v251, v251, v232
v_cvt_pk_bf16_f32 v228, v232, v233
v_add_f32 v251, v251, v233
s_waitcnt lgkmcnt(10)
v_mfma_f32_32x32x16_bf16 v[96:111], v[76:79], v[140:143], v[96:111]
ds_read_b64_tr_b16 v[76:77], v247 offset:8192
ds_read_b64_tr_b16 v[78:79], v247 offset:10240
s_waitcnt lgkmcnt(11)
v_mfma_f32_32x32x16_bf16 v[96:111], v[80:83], v[144:147], v[96:111]
ds_read_b64_tr_b16 v[80:81], v244 offset:12288
ds_read_b64_tr_b16 v[82:83], v244 offset:14336
v_exp_f32 v232, v172
v_exp_f32 v233, v173
v_add_f32 v251, v251, v234
v_cvt_pk_bf16_f32 v229, v234, v235
v_add_f32 v251, v251, v235
s_waitcnt lgkmcnt(12)
v_mfma_f32_32x32x16_bf16 v[96:111], v[84:87], v[148:151], v[96:111]
ds_read_b64_tr_b16 v[84:85], v245 offset:12288
ds_read_b64_tr_b16 v[86:87], v245 offset:14336
v_exp_f32 v234, v174
v_exp_f32 v235, v175
v_add_f32 v251, v251, v232
v_cvt_pk_bf16_f32 v230, v232, v233
v_add_f32 v251, v251, v233
s_waitcnt lgkmcnt(13)
v_mfma_f32_32x32x16_bf16 v[96:111], v[88:91], v[152:155], v[96:111]
ds_read_b64_tr_b16 v[88:89], v246 offset:12288
ds_read_b64_tr_b16 v[90:91], v246 offset:14336
v_add_f32 v251, v251, v234
v_cvt_pk_bf16_f32 v231, v234, v235
v_add_f32 v251, v251, v235
s_waitcnt lgkmcnt(14)
v_mfma_f32_32x32x16_bf16 v[96:111], v[92:95], v[156:159], v[96:111]
ds_read_b64_tr_b16 v[92:93], v247 offset:12288
ds_read_b64_tr_b16 v[94:95], v247 offset:14336
v_cmp_lt_f32 vcc, s48, v251
s_mov_b32 s49, 6
s_cbranch_vccnz FIX_0
SM_6:
v_add_f32 v248, v248, v251
s_waitcnt lgkmcnt(14)
v_mfma_f32_32x32x16_bf16 v[0:15], v[64:67], v[224:227], v[0:15]
ds_read_b128 v[64:67], v236 offset:24576
s_add_u32 s54, s5, 90112
s_and_b32 s54, s54, 0x1ffff
s_add_u32 m0, s50, 8192
s_nop 0
buffer_load_dwordx4 v249, s[12:15], s54 offen nt lds
s_waitcnt lgkmcnt(13)
v_mfma_f32_32x32x16_bf16 v[16:31], v[68:71], v[224:227], v[16:31]
ds_read_b128 v[68:71], v237 offset:24576
s_or_b32 s54, s54, 0x100000
s_add_u32 m0, s50, 49152
s_nop 0
buffer_load_dwordx4 v249, s[12:15], s54 offen nt lds
s_waitcnt lgkmcnt(12)
v_mfma_f32_32x32x16_bf16 v[32:47], v[72:75], v[224:227], v[32:47]
ds_read_b128 v[72:75], v238 offset:24576
s_add_u32 s54, s5, 81920
s_and_b32 s54, s54, 0x1ffff
s_add_u32 m0, s50, 81920
s_nop 0
buffer_load_dwordx4 v250, s[16:19], s54 offen nt lds
s_waitcnt lgkmcnt(11)
v_mfma_f32_32x32x16_bf16 v[48:63], v[76:79], v[224:227], v[48:63]
ds_read_b128 v[76:79], v239 offset:24576
v_exp_f32 v232, v96
v_exp_f32 v233, v97
s_or_b32 s54, s54, 0x100000
s_add_u32 m0, s50, 122880
s_nop 0
buffer_load_dwordx4 v250, s[16:19], s54 offen nt lds
s_waitcnt lgkmcnt(10)
v_mfma_f32_32x32x16_bf16 v[0:15], v[80:83], v[228:231], v[0:15]
ds_read_b128 v[80:83], v240 offset:24576
v_exp_f32 v234, v98
v_exp_f32 v235, v99
v_add_f32 v251, v232, v233
v_cvt_pk_bf16_f32 v224, v232, v233
s_waitcnt lgkmcnt(9)
v_mfma_f32_32x32x16_bf16 v[16:31], v[84:87], v[228:231], v[16:31]
ds_read_b128 v[84:87], v241 offset:24576
v_exp_f32 v232, v100
v_exp_f32 v233, v101
v_add_f32 v251, v251, v234
v_cvt_pk_bf16_f32 v225, v234, v235
v_add_f32 v251, v251, v235
s_waitcnt lgkmcnt(8)
v_mfma_f32_32x32x16_bf16 v[32:47], v[88:91], v[228:231], v[32:47]
ds_read_b128 v[88:91], v242 offset:24576
v_exp_f32 v234, v102
v_exp_f32 v235, v103
v_add_f32 v251, v251, v232
v_cvt_pk_bf16_f32 v226, v232, v233
v_add_f32 v251, v251, v233
s_waitcnt lgkmcnt(7)
v_mfma_f32_32x32x16_bf16 v[48:63], v[92:95], v[228:231], v[48:63]
ds_read_b128 v[92:95], v243 offset:24576
s_waitcnt vmcnt(10)
s_barrier
s_waitcnt lgkmcnt(7)
v_mfma_f32_32x32x16_bf16 v[160:175], v[64:67], v[128:131], v[112:127]
ds_read_b64_tr_b16 v[64:65], v244 offset:16384
ds_read_b64_tr_b16 v[66:67], v244 offset:18432
v_exp_f32 v232, v104
v_exp_f32 v233, v105
v_add_f32 v251, v251, v234
v_cvt_pk_bf16_f32 v227, v234, v235
v_add_f32 v251, v251, v235
s_waitcnt lgkmcnt(8)
v_mfma_f32_32x32x16_bf16 v[160:175], v[68:71], v[132:135], v[160:175]
ds_read_b64_tr_b16 v[68:69], v245 offset:16384
ds_read_b64_tr_b16 v[70:71], v245 offset:18432
s_waitcnt lgkmcnt(9)
v_mfma_f32_32x32x16_bf16 v[160:175], v[72:75], v[136:139], v[160:175]
ds_read_b64_tr_b16 v[72:73], v246 offset:16384
ds_read_b64_tr_b16 v[74:75], v246 offset:18432
v_exp_f32 v234, v106
v_exp_f32 v235, v107
v_add_f32 v251, v251, v232
v_cvt_pk_bf16_f32 v228, v232, v233
v_add_f32 v251, v251, v233
s_waitcnt lgkmcnt(10)
v_mfma_f32_32x32x16_bf16 v[160:175], v[76:79], v[140:143], v[160:175]
ds_read_b64_tr_b16 v[76:77], v247 offset:16384
ds_read_b64_tr_b16 v[78:79], v247 offset:18432
s_waitcnt lgkmcnt(11)
v_mfma_f32_32x32x16_bf16 v[160:175], v[80:83], v[144:147], v[160:175]
ds_read_b64_tr_b16 v[80:81], v244 offset:20480
ds_read_b64_tr_b16 v[82:83], v244 offset:22528
v_exp_f32 v232, v108
v_exp_f32 v233, v109
v_add_f32 v251, v251, v234
v_cvt_pk_bf16_f32 v229, v234, v235
v_add_f32 v251, v251, v235
s_waitcnt lgkmcnt(12)
v_mfma_f32_32x32x16_bf16 v[160:175], v[84:87], v[148:151], v[160:175]
ds_read_b64_tr_b16 v[84:85], v245 offset:20480
ds_read_b64_tr_b16 v[86:87], v245 offset:22528
v_exp_f32 v234, v110
v_exp_f32 v235, v111
v_add_f32 v251, v251, v232
v_cvt_pk_bf16_f32 v230, v232, v233
v_add_f32 v251, v251, v233
s_waitcnt lgkmcnt(13)
v_mfma_f32_32x32x16_bf16 v[160:175], v[88:91], v[152:155], v[160:175]
ds_read_b64_tr_b16 v[88:89], v246 offset:20480
ds_read_b64_tr_b16 v[90:91], v246 offset:22528
v_add_f32 v251, v251, v234
v_cvt_pk_bf16_f32 v231, v234, v235
v_add_f32 v251, v251, v235
s_waitcnt lgkmcnt(14)
v_mfma_f32_32x32x16_bf16 v[160:175], v[92:95], v[156:159], v[160:175]
ds_read_b64_tr_b16 v[92:93], v247 offset:20480
ds_read_b64_tr_b16 v[94:95], v247 offset:22528
v_cmp_lt_f32 vcc, s48, v251
s_mov_b32 s49, 7
s_cbranch_vccnz FIX_1
SM_7:
v_add_f32 v248, v248, v251
s_waitcnt lgkmcnt(14)
v_mfma_f32_32x32x16_bf16 v[0:15], v[64:67], v[224:227], v[0:15]
ds_read_b128 v[64:67], v236 offset:32768
s_add_u32 s54, s5, 98304
s_and_b32 s54, s54, 0x1ffff
s_add_u32 m0, s50, 16384
s_nop 0
buffer_load_dwordx4 v249, s[12:15], s54 offen nt lds
s_waitcnt lgkmcnt(13)
v_mfma_f32_32x32x16_bf16 v[16:31], v[68:71], v[224:227], v[16:31]
ds_read_b128 v[68:71], v237 offset:32768
s_or_b32 s54, s54, 0x100000
s_add_u32 m0, s50, 57344
s_nop 0
buffer_load_dwordx4 v249, s[12:15], s54 offen nt lds
s_waitcnt lgkmcnt(12)
v_mfma_f32_32x32x16_bf16 v[32:47], v[72:75], v[224:227], v[32:47]
ds_read_b128 v[72:75], v238 offset:32768
s_add_u32 s54, s5, 90112
s_and_b32 s54, s54, 0x1ffff
s_add_u32 m0, s50, 90112
s_nop 0
buffer_load_dwordx4 v250, s[16:19], s54 offen nt lds
s_waitcnt lgkmcnt(11)
v_mfma_f32_32x32x16_bf16 v[48:63], v[76:79], v[224:227], v[48:63]
ds_read_b128 v[76:79], v239 offset:32768
v_exp_f32 v232, v160
v_exp_f32 v233, v161
s_or_b32 s54, s54, 0x100000
s_add_u32 m0, s50, 131072
s_nop 0
buffer_load_dwordx4 v250, s[16:19], s54 offen nt lds
s_waitcnt lgkmcnt(10)
v_mfma_f32_32x32x16_bf16 v[0:15], v[80:83], v[228:231], v[0:15]
ds_read_b128 v[80:83], v240 offset:32768
v_exp_f32 v234, v162
v_exp_f32 v235, v163
v_add_f32 v251, v232, v233
v_cvt_pk_bf16_f32 v224, v232, v233
s_waitcnt lgkmcnt(9)
v_mfma_f32_32x32x16_bf16 v[16:31], v[84:87], v[228:231], v[16:31]
ds_read_b128 v[84:87], v241 offset:32768
v_exp_f32 v232, v164
v_exp_f32 v233, v165
v_add_f32 v251, v251, v234
v_cvt_pk_bf16_f32 v225, v234, v235
v_add_f32 v251, v251, v235
s_waitcnt lgkmcnt(8)
v_mfma_f32_32x32x16_bf16 v[32:47], v[88:91], v[228:231], v[32:47]
ds_read_b128 v[88:91], v242 offset:32768
v_exp_f32 v234, v166
v_exp_f32 v235, v167
v_add_f32 v251, v251, v232
v_cvt_pk_bf16_f32 v226, v232, v233
v_add_f32 v251, v251, v233
s_waitcnt lgkmcnt(7)
v_mfma_f32_32x32x16_bf16 v[48:63], v[92:95], v[228:231], v[48:63]
ds_read_b128 v[92:95], v243 offset:32768
s_waitcnt vmcnt(10)
s_barrier
s_waitcnt lgkmcnt(7)
v_mfma_f32_32x32x16_bf16 v[96:111], v[64:67], v[128:131], v[112:127]
ds_read_b64_tr_b16 v[64:65], v244 offset:24576
ds_read_b64_tr_b16 v[66:67], v244 offset:26624
v_exp_f32 v232, v168
v_exp_f32 v233, v169
v_add_f32 v251, v251, v234
v_cvt_pk_bf16_f32 v227, v234, v235
v_add_f32 v251, v251, v235
s_waitcnt lgkmcnt(8)
v_mfma_f32_32x32x16_bf16 v[96:111], v[68:71], v[132:135], v[96:111]
ds_read_b64_tr_b16 v[68:69], v245 offset:24576
ds_read_b64_tr_b16 v[70:71], v245 offset:26624
s_waitcnt lgkmcnt(9)
v_mfma_f32_32x32x16_bf16 v[96:111], v[72:75], v[136:139], v[96:111]
ds_read_b64_tr_b16 v[72:73], v246 offset:24576
ds_read_b64_tr_b16 v[74:75], v246 offset:26624
v_exp_f32 v234, v170
v_exp_f32 v235, v171
v_add_f32 v251, v251, v232
v_cvt_pk_bf16_f32 v228, v232, v233
v_add_f32 v251, v251, v233
s_waitcnt lgkmcnt(10)
v_mfma_f32_32x32x16_bf16 v[96:111], v[76:79], v[140:143], v[96:111]
ds_read_b64_tr_b16 v[76:77], v247 offset:24576
ds_read_b64_tr_b16 v[78:79], v247 offset:26624
s_waitcnt lgkmcnt(11)
v_mfma_f32_32x32x16_bf16 v[96:111], v[80:83], v[144:147], v[96:111]
ds_read_b64_tr_b16 v[80:81], v244 offset:28672
ds_read_b64_tr_b16 v[82:83], v244 offset:30720
v_exp_f32 v232, v172
v_exp_f32 v233, v173
v_add_f32 v251, v251, v234
v_cvt_pk_bf16_f32 v229, v234, v235
v_add_f32 v251, v251, v235
s_waitcnt lgkmcnt(12)
v_mfma_f32_32x32x16_bf16 v[96:111], v[84:87], v[148:151], v[96:111]
ds_read_b64_tr_b16 v[84:85], v245 offset:28672
ds_read_b64_tr_b16 v[86:87], v245 offset:30720
v_exp_f32 v234, v174
v_exp_f32 v235, v175
v_add_f32 v251, v251, v232
v_cvt_pk_bf16_f32 v230, v232, v233
v_add_f32 v251, v251, v233
s_waitcnt lgkmcnt(13)
v_mfma_f32_32x32x16_bf16 v[96:111], v[88:91], v[152:155], v[96:111]
ds_read_b64_tr_b16 v[88:89], v246 offset:28672
ds_read_b64_tr_b16 v[90:91], v246 offset:30720
v_add_f32 v251, v251, v234
v_cvt_pk_bf16_f32 v231, v234, v235
v_add_f32 v251, v251, v235
s_waitcnt lgkmcnt(14)
v_mfma_f32_32x32x16_bf16 v[96:111], v[92:95], v[156:159], v[96:111]
ds_read_b64_tr_b16 v[92:93], v247 offset:28672
ds_read_b64_tr_b16 v[94:95], v247 offset:30720
v_cmp_lt_f32 vcc, s48, v251
s_mov_b32 s49, 8
s_cbranch_vccnz FIX_0
SM_8:
v_add_f32 v248, v248, v251
s_waitcnt lgkmcnt(14)
v_mfma_f32_32x32x16_bf16 v[0:15], v[64:67], v[224:227], v[0:15]
ds_read_b128 v[64:67], v236 offset:0
s_add_u32 s54, s5, 106496
s_and_b32 s54, s54, 0x1ffff
s_add_u32 m0, s50, 24576
s_nop 0
buffer_load_dwordx4 v249, s[12:15], s54 offen nt lds
s_waitcnt lgkmcnt(13)
v_mfma_f32_32x32x16_bf16 v[16:31], v[68:71], v[224:227], v[16:31]
ds_read_b128 v[68:71], v237 offset:0
s_or_b32 s54, s54, 0x100000
s_add_u32 m0, s50, 65536
s_nop 0
buffer_load_dwordx4 v249, s[12:15], s54 offen nt lds
s_waitcnt lgkmcnt(12)
v_mfma_f32_32x32x16_bf16 v[32:47], v[72:75], v[224:227], v[32:47]
ds_read_b128 v[72:75], v238 offset:0
s_add_u32 s54, s5, 98304
s_and_b32 s54, s54, 0x1ffff
s_add_u32 m0, s50, 98304
s_nop 0
buffer_load_dwordx4 v250, s[16:19], s54 offen nt lds
s_waitcnt lgkmcnt(11)
v_mfma_f32_32x32x16_bf16 v[48:63], v[76:79], v[224:227], v[48:63]
ds_read_b128 v[76:79], v239 offset:0
v_exp_f32 v232, v96
v_exp_f32 v233, v97
s_or_b32 s54, s54, 0x100000
s_add_u32 m0, s50, 139264
s_nop 0
buffer_load_dwordx4 v250, s[16:19], s54 offen nt lds
s_waitcnt lgkmcnt(10)
v_mfma_f32_32x32x16_bf16 v[0:15], v[80:83], v[228:231], v[0:15]
ds_read_b128 v[80:83], v240 offset:0
v_exp_f32 v234, v98
v_exp_f32 v235, v99
v_add_f32 v251, v232, v233
v_cvt_pk_bf16_f32 v224, v232, v233
s_waitcnt lgkmcnt(9)
v_mfma_f32_32x32x16_bf16 v[16:31], v[84:87], v[228:231], v[16:31]
ds_read_b128 v[84:87], v241 offset:0
v_exp_f32 v232, v100
v_exp_f32 v233, v101
v_add_f32 v251, v251, v234
v_cvt_pk_bf16_f32 v225, v234, v235
v_add_f32 v251, v251, v235
s_waitcnt lgkmcnt(8)
v_mfma_f32_32x32x16_bf16 v[32:47], v[88:91], v[228:231], v[32:47]
ds_read_b128 v[88:91], v242 offset:0
v_exp_f32 v234, v102
v_exp_f32 v235, v103
v_add_f32 v251, v251, v232
v_cvt_pk_bf16_f32 v226, v232, v233
v_add_f32 v251, v251, v233
s_waitcnt lgkmcnt(7)
v_mfma_f32_32x32x16_bf16 v[48:63], v[92:95], v[228:231], v[48:63]
ds_read_b128 v[92:95], v243 offset:0
s_waitcnt vmcnt(10)
s_barrier
s_waitcnt lgkmcnt(7)
v_mfma_f32_32x32x16_bf16 v[160:175], v[64:67], v[128:131], v[112:127]
ds_read_b64_tr_b16 v[64:65], v244 offset:32768
ds_read_b64_tr_b16 v[66:67], v244 offset:34816
v_exp_f32 v232, v104
v_exp_f32 v233, v105
v_add_f32 v251, v251, v234
v_cvt_pk_bf16_f32 v227, v234, v235
v_add_f32 v251, v251, v235
s_waitcnt lgkmcnt(8)
v_mfma_f32_32x32x16_bf16 v[160:175], v[68:71], v[132:135], v[160:175]
ds_read_b64_tr_b16 v[68:69], v245 offset:32768
ds_read_b64_tr_b16 v[70:71], v245 offset:34816
s_waitcnt lgkmcnt(9)
v_mfma_f32_32x32x16_bf16 v[160:175], v[72:75], v[136:139], v[160:175]
ds_read_b64_tr_b16 v[72:73], v246 offset:32768
ds_read_b64_tr_b16 v[74:75], v246 offset:34816
v_exp_f32 v234, v106
v_exp_f32 v235, v107
v_add_f32 v251, v251, v232
v_cvt_pk_bf16_f32 v228, v232, v233
v_add_f32 v251, v251, v233
s_waitcnt lgkmcnt(10)
v_mfma_f32_32x32x16_bf16 v[160:175], v[76:79], v[140:143], v[160:175]
ds_read_b64_tr_b16 v[76:77], v247 offset:32768
ds_read_b64_tr_b16 v[78:79], v247 offset:34816
s_waitcnt lgkmcnt(11)
v_mfma_f32_32x32x16_bf16 v[160:175], v[80:83], v[144:147], v[160:175]
ds_read_b64_tr_b16 v[80:81], v244 offset:36864
ds_read_b64_tr_b16 v[82:83], v244 offset:38912
v_exp_f32 v232, v108
v_exp_f32 v233, v109
v_add_f32 v251, v251, v234
v_cvt_pk_bf16_f32 v229, v234, v235
v_add_f32 v251, v251, v235
s_waitcnt lgkmcnt(12)
v_mfma_f32_32x32x16_bf16 v[160:175], v[84:87], v[148:151], v[160:175]
ds_read_b64_tr_b16 v[84:85], v245 offset:36864
ds_read_b64_tr_b16 v[86:87], v245 offset:38912
v_exp_f32 v234, v110
v_exp_f32 v235, v111
v_add_f32 v251, v251, v232
v_cvt_pk_bf16_f32 v230, v232, v233
v_add_f32 v251, v251, v233
s_waitcnt lgkmcnt(13)
v_mfma_f32_32x32x16_bf16 v[160:175], v[88:91], v[152:155], v[160:175]
ds_read_b64_tr_b16 v[88:89], v246 offset:36864
ds_read_b64_tr_b16 v[90:91], v246 offset:38912
v_add_f32 v251, v251, v234
v_cvt_pk_bf16_f32 v231, v234, v235
v_add_f32 v251, v251, v235
s_waitcnt lgkmcnt(14)
v_mfma_f32_32x32x16_bf16 v[160:175], v[92:95], v[156:159], v[160:175]
ds_read_b64_tr_b16 v[92:93], v247 offset:36864
ds_read_b64_tr_b16 v[94:95], v247 offset:38912
v_cmp_lt_f32 vcc, s48, v251
s_mov_b32 s49, 9
s_cbranch_vccnz FIX_1
SM_9:
v_add_f32 v248, v248, v251
s_waitcnt lgkmcnt(14)
v_mfma_f32_32x32x16_bf16 v[0:15], v[64:67], v[224:227], v[0:15]
ds_read_b128 v[64:67], v236 offset:8192
s_add_u32 s54, s5, 114688
s_and_b32 s54, s54, 0x1ffff
s_add_u32 m0, s50, 32768
s_nop 0
buffer_load_dwordx4 v249, s[12:15], s54 offen nt lds
s_waitcnt lgkmcnt(13)
v_mfma_f32_32x32x16_bf16 v[16:31], v[68:71], v[224:227], v[16:31]
ds_read_b128 v[68:71], v237 offset:8192
s_or_b32 s54, s54, 0x100000
s_add_u32 m0, s50, 73728
s_nop 0
buffer_load_dwordx4 v249, s[12:15], s54 offen nt lds
s_waitcnt lgkmcnt(12)
v_mfma_f32_32x32x16_bf16 v[32:47], v[72:75], v[224:227], v[32:47]
ds_read_b128 v[72:75], v238 offset:8192
s_add_u32 s54, s5, 106496
s_and_b32 s54, s54, 0x1ffff
s_add_u32 m0, s50, 106496
s_nop 0
buffer_load_dwordx4 v250, s[16:19], s54 offen nt lds
s_waitcnt lgkmcnt(11)
v_mfma_f32_32x32x16_bf16 v[48:63], v[76:79], v[224:227], v[48:63]
ds_read_b128 v[76:79], v239 offset:8192
v_exp_f32 v232, v160
v_exp_f32 v233, v161
s_or_b32 s54, s54, 0x100000
s_add_u32 m0, s50, 147456
s_nop 0
buffer_load_dwordx4 v250, s[16:19], s54 offen nt lds
s_waitcnt lgkmcnt(10)
v_mfma_f32_32x32x16_bf16 v[0:15], v[80:83], v[228:231], v[0:15]
ds_read_b128 v[80:83], v240 offset:8192
v_exp_f32 v234, v162
v_exp_f32 v235, v163
v_add_f32 v251, v232, v233
v_cvt_pk_bf16_f32 v224, v232, v233
s_waitcnt lgkmcnt(9)
v_mfma_f32_32x32x16_bf16 v[16:31], v[84:87], v[228:231], v[16:31]
ds_read_b128 v[84:87], v241 offset:8192
v_exp_f32 v232, v164
v_exp_f32 v233, v165
v_add_f32 v251, v251, v234
v_cvt_pk_bf16_f32 v225, v234, v235
v_add_f32 v251, v251, v235
s_waitcnt lgkmcnt(8)
v_mfma_f32_32x32x16_bf16 v[32:47], v[88:91], v[228:231], v[32:47]
ds_read_b128 v[88:91], v242 offset:8192
v_exp_f32 v234, v166
v_exp_f32 v235, v167
v_add_f32 v251, v251, v232
v_cvt_pk_bf16_f32 v226, v232, v233
v_add_f32 v251, v251, v233
s_waitcnt lgkmcnt(7)
v_mfma_f32_32x32x16_bf16 v[48:63], v[92:95], v[228:231], v[48:63]
ds_read_b128 v[92:95], v243 offset:8192
s_waitcnt vmcnt(10)
s_barrier
s_waitcnt lgkmcnt(7)
v_mfma_f32_32x32x16_bf16 v[96:111], v[64:67], v[128:131], v[112:127]
ds_read_b64_tr_b16 v[64:65], v244 offset:0
ds_read_b64_tr_b16 v[66:67], v244 offset:2048
v_exp_f32 v232, v168
v_exp_f32 v233, v169
v_add_f32 v251, v251, v234
v_cvt_pk_bf16_f32 v227, v234, v235
v_add_f32 v251, v251, v235
s_waitcnt lgkmcnt(8)
v_mfma_f32_32x32x16_bf16 v[96:111], v[68:71], v[132:135], v[96:111]
ds_read_b64_tr_b16 v[68:69], v245 offset:0
ds_read_b64_tr_b16 v[70:71], v245 offset:2048
s_waitcnt lgkmcnt(9)
v_mfma_f32_32x32x16_bf16 v[96:111], v[72:75], v[136:139], v[96:111]
ds_read_b64_tr_b16 v[72:73], v246 offset:0
ds_read_b64_tr_b16 v[74:75], v246 offset:2048
v_exp_f32 v234, v170
v_exp_f32 v235, v171
v_add_f32 v251, v251, v232
v_cvt_pk_bf16_f32 v228, v232, v233
v_add_f32 v251, v251, v233
s_waitcnt lgkmcnt(10)
v_mfma_f32_32x32x16_bf16 v[96:111], v[76:79], v[140:143], v[96:111]
ds_read_b64_tr_b16 v[76:77], v247 offset:0
ds_read_b64_tr_b16 v[78:79], v247 offset:2048
s_waitcnt lgkmcnt(11)
v_mfma_f32_32x32x16_bf16 v[96:111], v[80:83], v[144:147], v[96:111]
ds_read_b64_tr_b16 v[80:81], v244 offset:4096
ds_read_b64_tr_b16 v[82:83], v244 offset:6144
v_exp_f32 v232, v172
v_exp_f32 v233, v173
v_add_f32 v251, v251, v234
v_cvt_pk_bf16_f32 v229, v234, v235
v_add_f32 v251, v251, v235
s_waitcnt lgkmcnt(12)
v_mfma_f32_32x32x16_bf16 v[96:111], v[84:87], v[148:151], v[96:111]
ds_read_b64_tr_b16 v[84:85], v245 offset:4096
ds_read_b64_tr_b16 v[86:87], v245 offset:6144
v_exp_f32 v234, v174
v_exp_f32 v235, v175
v_add_f32 v251, v251, v232
v_cvt_pk_bf16_f32 v230, v232, v233
v_add_f32 v251, v251, v233
s_waitcnt lgkmcnt(13)
v_mfma_f32_32x32x16_bf16 v[96:111], v[88:91], v[152:155], v[96:111]
ds_read_b64_tr_b16 v[88:89], v246 offset:4096
ds_read_b64_tr_b16 v[90:91], v246 offset:6144
v_add_f32 v251, v251, v234
v_cvt_pk_bf16_f32 v231, v234, v235
v_add_f32 v251, v251, v235
s_waitcnt lgkmcnt(14)
v_mfma_f32_32x32x16_bf16 v[96:111], v[92:95], v[156:159], v[96:111]
ds_read_b64_tr_b16 v[92:93], v247 offset:4096
ds_read_b64_tr_b16 v[94:95], v247 offset:6144
v_cmp_lt_f32 vcc, s48, v251
s_mov_b32 s49, 10
s_cbranch_vccnz FIX_0
SM_10:
v_add_f32 v248, v248, v251
s_waitcnt lgkmcnt(14)
v_mfma_f32_32x32x16_bf16 v[0:15], v[64:67], v[224:227], v[0:15]
ds_read_b128 v[64:67], v236 offset:16384
s_add_u32 s54, s5, 122880
s_and_b32 s54, s54, 0x1ffff
s_add_u32 m0, s50, 0
s_nop 0
buffer_load_dwordx4 v249, s[12:15], s54 offen nt lds
s_waitcnt lgkmcnt(13)
v_mfma_f32_32x32x16_bf16 v[16:31], v[68:71], v[224:227], v[16:31]
ds_read_b128 v[68:71], v237 offset:16384
s_or_b32 s54, s54, 0x100000
s_add_u32 m0, s50, 40960
s_nop 0
buffer_load_dwordx4 v249, s[12:15], s54 offen nt lds
s_waitcnt lgkmcnt(12)
v_mfma_f32_32x32x16_bf16 v[32:47], v[72:75], v[224:227], v[32:47]
ds_read_b128 v[72:75], v238 offset:16384
s_add_u32 s54, s5, 114688
s_and_b32 s54, s54, 0x1ffff
s_add_u32 m0, s50, 114688
s_nop 0
buffer_load_dwordx4 v250, s[16:19], s54 offen nt lds
s_waitcnt lgkmcnt(11)
v_mfma_f32_32x32x16_bf16 v[48:63], v[76:79], v[224:227], v[48:63]
ds_read_b128 v[76:79], v239 offset:16384
v_exp_f32 v232, v96
v_exp_f32 v233, v97
s_or_b32 s54, s54, 0x100000
s_add_u32 m0, s50, 155648
s_nop 0
buffer_load_dwordx4 v250, s[16:19], s54 offen nt lds
s_waitcnt lgkmcnt(10)
v_mfma_f32_32x32x16_bf16 v[0:15], v[80:83], v[228:231], v[0:15]
ds_read_b128 v[80:83], v240 offset:16384
v_exp_f32 v234, v98
v_exp_f32 v235, v99
v_add_f32 v251, v232, v233
v_cvt_pk_bf16_f32 v224, v232, v233
s_waitcnt lgkmcnt(9)
v_mfma_f32_32x32x16_bf16 v[16:31], v[84:87], v[228:231], v[16:31]
ds_read_b128 v[84:87], v241 offset:16384
v_exp_f32 v232, v100
v_exp_f32 v233, v101
v_add_f32 v251, v251, v234
v_cvt_pk_bf16_f32 v225, v234, v235
v_add_f32 v251, v251, v235
s_waitcnt lgkmcnt(8)
v_mfma_f32_32x32x16_bf16 v[32:47], v[88:91], v[228:231], v[32:47]
ds_read_b128 v[88:91], v242 offset:16384
v_exp_f32 v234, v102
v_exp_f32 v235, v103
v_add_f32 v251, v251, v232
v_cvt_pk_bf16_f32 v226, v232, v233
v_add_f32 v251, v251, v233
s_waitcnt lgkmcnt(7)
v_mfma_f32_32x32x16_bf16 v[48:63], v[92:95], v[228:231], v[48:63]
ds_read_b128 v[92:95], v243 offset:16384
s_waitcnt vmcnt(10)
s_barrier
s_waitcnt lgkmcnt(7)
v_mfma_f32_32x32x16_bf16 v[160:175], v[64:67], v[128:131], v[112:127]
ds_read_b64_tr_b16 v[64:65], v244 offset:8192
ds_read_b64_tr_b16 v[66:67], v244 offset:10240
v_exp_f32 v232, v104
v_exp_f32 v233, v105
v_add_f32 v251, v251, v234
v_cvt_pk_bf16_f32 v227, v234, v235
v_add_f32 v251, v251, v235
s_waitcnt lgkmcnt(8)
v_mfma_f32_32x32x16_bf16 v[160:175], v[68:71], v[132:135], v[160:175]
ds_read_b64_tr_b16 v[68:69], v245 offset:8192
ds_read_b64_tr_b16 v[70:71], v245 offset:10240
s_waitcnt lgkmcnt(9)
v_mfma_f32_32x32x16_bf16 v[160:175], v[72:75], v[136:139], v[160:175]
ds_read_b64_tr_b16 v[72:73], v246 offset:8192
ds_read_b64_tr_b16 v[74:75], v246 offset:10240
v_exp_f32 v234, v106
v_exp_f32 v235, v107
v_add_f32 v251, v251, v232
v_cvt_pk_bf16_f32 v228, v232, v233
v_add_f32 v251, v251, v233
s_waitcnt lgkmcnt(10)
v_mfma_f32_32x32x16_bf16 v[160:175], v[76:79], v[140:143], v[160:175]
ds_read_b64_tr_b16 v[76:77], v247 offset:8192
ds_read_b64_tr_b16 v[78:79], v247 offset:10240
s_waitcnt lgkmcnt(11)
v_mfma_f32_32x32x16_bf16 v[160:175], v[80:83], v[144:147], v[160:175]
ds_read_b64_tr_b16 v[80:81], v244 offset:12288
ds_read_b64_tr_b16 v[82:83], v244 offset:14336
v_exp_f32 v232, v108
v_exp_f32 v233, v109
v_add_f32 v251, v251, v234
v_cvt_pk_bf16_f32 v229, v234, v235
v_add_f32 v251, v251, v235
s_waitcnt lgkmcnt(12)
v_mfma_f32_32x32x16_bf16 v[160:175], v[84:87], v[148:151], v[160:175]
ds_read_b64_tr_b16 v[84:85], v245 offset:12288
ds_read_b64_tr_b16 v[86:87], v245 offset:14336
v_exp_f32 v234, v110
v_exp_f32 v235, v111
v_add_f32 v251, v251, v232
v_cvt_pk_bf16_f32 v230, v232, v233
v_add_f32 v251, v251, v233
s_waitcnt lgkmcnt(13)
v_mfma_f32_32x32x16_bf16 v[160:175], v[88:91], v[152:155], v[160:175]
ds_read_b64_tr_b16 v[88:89], v246 offset:12288
ds_read_b64_tr_b16 v[90:91], v246 offset:14336
v_add_f32 v251, v251, v234
v_cvt_pk_bf16_f32 v231, v234, v235
v_add_f32 v251, v251, v235
s_waitcnt lgkmcnt(14)
v_mfma_f32_32x32x16_bf16 v[160:175], v[92:95], v[156:159], v[160:175]
ds_read_b64_tr_b16 v[92:93], v247 offset:12288
ds_read_b64_tr_b16 v[94:95], v247 offset:14336
v_cmp_lt_f32 vcc, s48, v251
s_mov_b32 s49, 11
s_cbranch_vccnz FIX_1
SM_11:
v_add_f32 v248, v248, v251
s_waitcnt lgkmcnt(14)
v_mfma_f32_32x32x16_bf16 v[0:15], v[64:67], v[224:227], v[0:15]
ds_read_b128 v[64:67], v236 offset:24576
s_add_u32 s54, s5, 122880
s_and_b32 s54, s54, 0x1ffff
s_add_u32 m0, s50, 81920
s_nop 0
buffer_load_dwordx4 v250, s[16:19], s54 offen nt lds
s_waitcnt lgkmcnt(13)
v_mfma_f32_32x32x16_bf16 v[16:31], v[68:71], v[224:227], v[16:31]
ds_read_b128 v[68:71], v237 offset:24576
s_or_b32 s54, s54, 0x100000
s_add_u32 m0, s50, 122880
s_nop 0
buffer_load_dwordx4 v250, s[16:19], s54 offen nt lds
s_waitcnt lgkmcnt(12)
v_mfma_f32_32x32x16_bf16 v[32:47], v[72:75], v[224:227], v[32:47]
ds_read_b128 v[72:75], v238 offset:24576
s_waitcnt lgkmcnt(11)
v_mfma_f32_32x32x16_bf16 v[48:63], v[76:79], v[224:227], v[48:63]
ds_read_b128 v[76:79], v239 offset:24576
v_exp_f32 v232, v160
v_exp_f32 v233, v161
s_waitcnt lgkmcnt(10)
v_mfma_f32_32x32x16_bf16 v[0:15], v[80:83], v[228:231], v[0:15]
ds_read_b128 v[80:83], v240 offset:24576
v_exp_f32 v234, v162
v_exp_f32 v235, v163
v_add_f32 v251, v232, v233
v_cvt_pk_bf16_f32 v224, v232, v233
s_waitcnt lgkmcnt(9)
v_mfma_f32_32x32x16_bf16 v[16:31], v[84:87], v[228:231], v[16:31]
ds_read_b128 v[84:87], v241 offset:24576
v_exp_f32 v232, v164
v_exp_f32 v233, v165
v_add_f32 v251, v251, v234
v_cvt_pk_bf16_f32 v225, v234, v235
v_add_f32 v251, v251, v235
s_waitcnt lgkmcnt(8)
v_mfma_f32_32x32x16_bf16 v[32:47], v[88:91], v[228:231], v[32:47]
ds_read_b128 v[88:91], v242 offset:24576
v_exp_f32 v234, v166
v_exp_f32 v235, v167
v_add_f32 v251, v251, v232
v_cvt_pk_bf16_f32 v226, v232, v233
v_add_f32 v251, v251, v233
s_waitcnt lgkmcnt(7)
v_mfma_f32_32x32x16_bf16 v[48:63], v[92:95], v[228:231], v[48:63]
ds_read_b128 v[92:95], v243 offset:24576
s_waitcnt vmcnt(8)
s_barrier
s_waitcnt lgkmcnt(7)
v_mfma_f32_32x32x16_bf16 v[96:111], v[64:67], v[128:131], v[112:127]
ds_read_b64_tr_b16 v[64:65], v244 offset:16384
ds_read_b64_tr_b16 v[66:67], v244 offset:18432
v_exp_f32 v232, v168
v_exp_f32 v233, v169
v_add_f32 v251, v251, v234
v_cvt_pk_bf16_f32 v227, v234, v235
v_add_f32 v251, v251, v235
s_waitcnt lgkmcnt(8)
v_mfma_f32_32x32x16_bf16 v[96:111], v[68:71], v[132:135], v[96:111]
ds_read_b64_tr_b16 v[68:69], v245 offset:16384
ds_read_b64_tr_b16 v[70:71], v245 offset:18432
s_waitcnt lgkmcnt(9)
v_mfma_f32_32x32x16_bf16 v[96:111], v[72:75], v[136:139], v[96:111]
ds_read_b64_tr_b16 v[72:73], v246 offset:16384
ds_read_b64_tr_b16 v[74:75], v246 offset:18432
v_exp_f32 v234, v170
v_exp_f32 v235, v171
v_add_f32 v251, v251, v232
v_cvt_pk_bf16_f32 v228, v232, v233
v_add_f32 v251, v251, v233
s_waitcnt lgkmcnt(10)
v_mfma_f32_32x32x16_bf16 v[96:111], v[76:79], v[140:143], v[96:111]
ds_read_b64_tr_b16 v[76:77], v247 offset:16384
ds_read_b64_tr_b16 v[78:79], v247 offset:18432
s_waitcnt lgkmcnt(11)
v_mfma_f32_32x32x16_bf16 v[96:111], v[80:83], v[144:147], v[96:111]
ds_read_b64_tr_b16 v[80:81], v244 offset:20480
ds_read_b64_tr_b16 v[82:83], v244 offset:22528
v_exp_f32 v232, v172
v_exp_f32 v233, v173
v_add_f32 v251, v251, v234
v_cvt_pk_bf16_f32 v229, v234, v235
v_add_f32 v251, v251, v235
s_waitcnt lgkmcnt(12)
v_mfma_f32_32x32x16_bf16 v[96:111], v[84:87], v[148:151], v[96:111]
ds_read_b64_tr_b16 v[84:85], v245 offset:20480
ds_read_b64_tr_b16 v[86:87], v245 offset:22528
v_exp_f32 v234, v174
v_exp_f32 v235, v175
v_add_f32 v251, v251, v232
v_cvt_pk_bf16_f32 v230, v232, v233
v_add_f32 v251, v251, v233
s_waitcnt lgkmcnt(13)
v_mfma_f32_32x32x16_bf16 v[96:111], v[88:91], v[152:155], v[96:111]
ds_read_b64_tr_b16 v[88:89], v246 offset:20480
ds_read_b64_tr_b16 v[90:91], v246 offset:22528
v_add_f32 v251, v251, v234
v_cvt_pk_bf16_f32 v231, v234, v235
v_add_f32 v251, v251, v235
s_waitcnt lgkmcnt(14)
v_mfma_f32_32x32x16_bf16 v[96:111], v[92:95], v[156:159], v[96:111]
ds_read_b64_tr_b16 v[92:93], v247 offset:20480
ds_read_b64_tr_b16 v[94:95], v247 offset:22528
v_cmp_lt_f32 vcc, s48, v251
s_mov_b32 s49, 12
s_cbranch_vccnz FIX_0
SM_12:
v_add_f32 v248, v248, v251
s_waitcnt lgkmcnt(14)
v_mfma_f32_32x32x16_bf16 v[0:15], v[64:67], v[224:227], v[0:15]
ds_read_b128 v[64:67], v236 offset:32768
s_add_u32 s56, s3, 0
s_and_b32 s56, s56, 15
s_lshl_b32 s56, s56, 15
s_add_u32 s57, s56, 8192
buffer_load_dwordx4 v[176:179], v252, s[24:27], s56 offen offset:0
s_waitcnt lgkmcnt(13)
v_mfma_f32_32x32x16_bf16 v[16:31], v[68:71], v[224:227], v[16:31]
ds_read_b128 v[68:71], v237 offset:32768
buffer_load_dwordx4 v[180:183], v252, s[24:27], s56 offen offset:2048
s_waitcnt lgkmcnt(12)
v_mfma_f32_32x32x16_bf16 v[32:47], v[72:75], v[224:227], v[32:47]
ds_read_b128 v[72:75], v238 offset:32768
buffer_load_dwordx4 v[184:187], v252, s[24:27], s57 offen offset:0
s_waitcnt lgkmcnt(11)
v_mfma_f32_32x32x16_bf16 v[48:63], v[76:79], v[224:227], v[48:63]
ds_read_b128 v[76:79], v239 offset:32768
v_exp_f32 v232, v96
v_exp_f32 v233, v97
buffer_load_dwordx4 v[188:191], v252, s[24:27], s57 offen offset:2048
s_waitcnt lgkmcnt(10)
v_mfma_f32_32x32x16_bf16 v[0:15], v[80:83], v[228:231], v[0:15]
ds_read_b128 v[80:83], v240 offset:32768
v_exp_f32 v234, v98
v_exp_f32 v235, v99
v_add_f32 v251, v232, v233
v_cvt_pk_bf16_f32 v224, v232, v233
s_lshl_b32 s52, s51, 2
s_add_u32 s52, s52, s50
v_mov_b32 v254, s52
buffer_load_dword v253, v254, s[36:39], 0 offen sc1
s_waitcnt lgkmcnt(9)
v_mfma_f32_32x32x16_bf16 v[16:31], v[84:87], v[228:231], v[16:31]
ds_read_b128 v[84:87], v241 offset:32768
v_exp_f32 v232, v100
v_exp_f32 v233, v101
v_add_f32 v251, v251, v234
v_cvt_pk_bf16_f32 v225, v234, v235
v_add_f32 v251, v251, v235
s_waitcnt lgkmcnt(8)
v_mfma_f32_32x32x16_bf16 v[32:47], v[88:91], v[228:231], v[32:47]
ds_read_b128 v[88:91], v242 offset:32768
v_exp_f32 v234, v102
v_exp_f32 v235, v103
v_add_f32 v251, v251, v232
v_cvt_pk_bf16_f32 v226, v232, v233
v_add_f32 v251, v251, v233
s_waitcnt lgkmcnt(7)
v_mfma_f32_32x32x16_bf16 v[48:63], v[92:95], v[228:231], v[48:63]
ds_read_b128 v[92:95], v243 offset:32768
s_waitcnt vmcnt(9)
s_barrier
s_waitcnt lgkmcnt(7)
v_mfma_f32_32x32x16_bf16 v[160:175], v[64:67], v[128:131], v[112:127]
ds_read_b64_tr_b16 v[64:65], v244 offset:24576
ds_read_b64_tr_b16 v[66:67], v244 offset:26624
v_exp_f32 v232, v104
v_exp_f32 v233, v105
v_add_f32 v251, v251, v234
v_cvt_pk_bf16_f32 v227, v234, v235
v_add_f32 v251, v251, v235
s_waitcnt lgkmcnt(8)
v_mfma_f32_32x32x16_bf16 v[160:175], v[68:71], v[132:135], v[160:175]
ds_read_b64_tr_b16 v[68:69], v245 offset:24576
ds_read_b64_tr_b16 v[70:71], v245 offset:26624
s_waitcnt lgkmcnt(9)
v_mfma_f32_32x32x16_bf16 v[160:175], v[72:75], v[136:139], v[160:175]
ds_read_b64_tr_b16 v[72:73], v246 offset:24576
ds_read_b64_tr_b16 v[74:75], v246 offset:26624
v_exp_f32 v234, v106
v_exp_f32 v235, v107
v_add_f32 v251, v251, v232
v_cvt_pk_bf16_f32 v228, v232, v233
v_add_f32 v251, v251, v233
s_waitcnt lgkmcnt(10)
v_mfma_f32_32x32x16_bf16 v[160:175], v[76:79], v[140:143], v[160:175]
ds_read_b64_tr_b16 v[76:77], v247 offset:24576
ds_read_b64_tr_b16 v[78:79], v247 offset:26624
s_waitcnt lgkmcnt(11)
v_mfma_f32_32x32x16_bf16 v[160:175], v[80:83], v[144:147], v[160:175]
ds_read_b64_tr_b16 v[80:81], v244 offset:28672
ds_read_b64_tr_b16 v[82:83], v244 offset:30720
v_exp_f32 v232, v108
v_exp_f32 v233, v109
v_add_f32 v251, v251, v234
v_cvt_pk_bf16_f32 v229, v234, v235
v_add_f32 v251, v251, v235
s_waitcnt lgkmcnt(12)
v_mfma_f32_32x32x16_bf16 v[160:175], v[84:87], v[148:151], v[160:175]
ds_read_b64_tr_b16 v[84:85], v245 offset:28672
ds_read_b64_tr_b16 v[86:87], v245 offset:30720
v_exp_f32 v234, v110
v_exp_f32 v235, v111
v_add_f32 v251, v251, v232
v_cvt_pk_bf16_f32 v230, v232, v233
v_add_f32 v251, v251, v233
s_waitcnt lgkmcnt(13)
v_mfma_f32_32x32x16_bf16 v[160:175], v[88:91], v[152:155], v[160:175]
ds_read_b64_tr_b16 v[88:89], v246 offset:28672
ds_read_b64_tr_b16 v[90:91], v246 offset:30720
v_add_f32 v251, v251, v234
v_cvt_pk_bf16_f32 v231, v234, v235
v_add_f32 v251, v251, v235
s_waitcnt lgkmcnt(14)
v_mfma_f32_32x32x16_bf16 v[160:175], v[92:95], v[156:159], v[160:175]
ds_read_b64_tr_b16 v[92:93], v247 offset:28672
ds_read_b64_tr_b16 v[94:95], v247 offset:30720
v_cmp_lt_f32 vcc, s48, v251
s_mov_b32 s49, 13
s_cbranch_vccnz FIX_1
SM_13:
v_add_f32 v248, v248, v251
s_waitcnt lgkmcnt(14)
v_mfma_f32_32x32x16_bf16 v[0:15], v[64:67], v[224:227], v[0:15]
ds_read_b128 v[64:67], v236 offset:0
s_add_u32 s56, s3, 1
s_and_b32 s56, s56, 15
s_lshl_b32 s56, s56, 15
s_add_u32 s57, s56, 8192
buffer_load_dwordx4 v[192:195], v252, s[24:27], s56 offen offset:0
s_waitcnt lgkmcnt(13)
v_mfma_f32_32x32x16_bf16 v[16:31], v[68:71], v[224:227], v[16:31]
ds_read_b128 v[68:71], v237 offset:0
buffer_load_dwordx4 v[196:199], v252, s[24:27], s56 offen offset:2048
s_waitcnt lgkmcnt(12)
v_mfma_f32_32x32x16_bf16 v[32:47], v[72:75], v[224:227], v[32:47]
ds_read_b128 v[72:75], v238 offset:0
buffer_load_dwordx4 v[200:203], v252, s[24:27], s57 offen offset:0
s_waitcnt lgkmcnt(11)
v_mfma_f32_32x32x16_bf16 v[48:63], v[76:79], v[224:227], v[48:63]
ds_read_b128 v[76:79], v239 offset:0
v_exp_f32 v232, v160
v_exp_f32 v233, v161
buffer_load_dwordx4 v[204:207], v252, s[24:27], s57 offen offset:2048
s_waitcnt lgkmcnt(10)
v_mfma_f32_32x32x16_bf16 v[0:15], v[80:83], v[228:231], v[0:15]
ds_read_b128 v[80:83], v240 offset:0
v_exp_f32 v234, v162
v_exp_f32 v235, v163
v_add_f32 v251, v232, v233
v_cvt_pk_bf16_f32 v224, v232, v233
s_waitcnt lgkmcnt(9)
v_mfma_f32_32x32x16_bf16 v[16:31], v[84:87], v[228:231], v[16:31]
ds_read_b128 v[84:87], v241 offset:0
v_exp_f32 v232, v164
v_exp_f32 v233, v165
v_add_f32 v251, v251, v234
v_cvt_pk_bf16_f32 v225, v234, v235
v_add_f32 v251, v251, v235
s_waitcnt lgkmcnt(8)
v_mfma_f32_32x32x16_bf16 v[32:47], v[88:91], v[228:231], v[32:47]
ds_read_b128 v[88:91], v242 offset:0
v_exp_f32 v234, v166
v_exp_f32 v235, v167
v_add_f32 v251, v251, v232
v_cvt_pk_bf16_f32 v226, v232, v233
v_add_f32 v251, v251, v233
s_waitcnt lgkmcnt(7)
v_mfma_f32_32x32x16_bf16 v[48:63], v[92:95], v[228:231], v[48:63]
ds_read_b128 v[92:95], v243 offset:0
s_waitcnt vmcnt(11)
s_barrier
s_waitcnt lgkmcnt(7)
v_mfma_f32_32x32x16_bf16 v[96:111], v[64:67], v[128:131], v[112:127]
ds_read_b64_tr_b16 v[64:65], v244 offset:32768
ds_read_b64_tr_b16 v[66:67], v244 offset:34816
v_exp_f32 v232, v168
v_exp_f32 v233, v169
v_add_f32 v251, v251, v234
v_cvt_pk_bf16_f32 v227, v234, v235
v_add_f32 v251, v251, v235
s_waitcnt lgkmcnt(8)
v_mfma_f32_32x32x16_bf16 v[96:111], v[68:71], v[132:135], v[96:111]
ds_read_b64_tr_b16 v[68:69], v245 offset:32768
ds_read_b64_tr_b16 v[70:71], v245 offset:34816
s_waitcnt lgkmcnt(9)
v_mfma_f32_32x32x16_bf16 v[96:111], v[72:75], v[136:139], v[96:111]
ds_read_b64_tr_b16 v[72:73], v246 offset:32768
ds_read_b64_tr_b16 v[74:75], v246 offset:34816
v_exp_f32 v234, v170
v_exp_f32 v235, v171
v_add_f32 v251, v251, v232
v_cvt_pk_bf16_f32 v228, v232, v233
v_add_f32 v251, v251, v233
s_waitcnt lgkmcnt(10)
v_mfma_f32_32x32x16_bf16 v[96:111], v[76:79], v[140:143], v[96:111]
ds_read_b64_tr_b16 v[76:77], v247 offset:32768
ds_read_b64_tr_b16 v[78:79], v247 offset:34816
s_waitcnt lgkmcnt(11)
v_mfma_f32_32x32x16_bf16 v[96:111], v[80:83], v[144:147], v[96:111]
ds_read_b64_tr_b16 v[80:81], v244 offset:36864
ds_read_b64_tr_b16 v[82:83], v244 offset:38912
v_exp_f32 v232, v172
v_exp_f32 v233, v173
v_add_f32 v251, v251, v234
v_cvt_pk_bf16_f32 v229, v234, v235
v_add_f32 v251, v251, v235
s_waitcnt lgkmcnt(12)
v_mfma_f32_32x32x16_bf16 v[96:111], v[84:87], v[148:151], v[96:111]
ds_read_b64_tr_b16 v[84:85], v245 offset:36864
ds_read_b64_tr_b16 v[86:87], v245 offset:38912
v_exp_f32 v234, v174
v_exp_f32 v235, v175
v_add_f32 v251, v251, v232
v_cvt_pk_bf16_f32 v230, v232, v233
v_add_f32 v251, v251, v233
s_waitcnt lgkmcnt(13)
v_mfma_f32_32x32x16_bf16 v[96:111], v[88:91], v[152:155], v[96:111]
ds_read_b64_tr_b16 v[88:89], v246 offset:36864
ds_read_b64_tr_b16 v[90:91], v246 offset:38912
v_add_f32 v251, v251, v234
v_cvt_pk_bf16_f32 v231, v234, v235
v_add_f32 v251, v251, v235
s_waitcnt lgkmcnt(14)
v_mfma_f32_32x32x16_bf16 v[96:111], v[92:95], v[156:159], v[96:111]
ds_read_b64_tr_b16 v[92:93], v247 offset:36864
ds_read_b64_tr_b16 v[94:95], v247 offset:38912
v_cmp_lt_f32 vcc, s48, v251
s_mov_b32 s49, 14
s_cbranch_vccnz FIX_0
SM_14:
v_add_f32 v248, v248, v251
s_waitcnt lgkmcnt(14)
v_mfma_f32_32x32x16_bf16 v[0:15], v[64:67], v[224:227], v[0:15]
s_add_u32 s56, s3, 2
s_and_b32 s56, s56, 15
s_lshl_b32 s56, s56, 15
s_add_u32 s57, s56, 8192
buffer_load_dwordx4 v[208:211], v252, s[24:27], s56 offen offset:0
s_waitcnt lgkmcnt(12)
v_mfma_f32_32x32x16_bf16 v[16:31], v[68:71], v[224:227], v[16:31]
buffer_load_dwordx4 v[212:215], v252, s[24:27], s56 offen offset:2048
s_waitcnt lgkmcnt(10)
v_mfma_f32_32x32x16_bf16 v[32:47], v[72:75], v[224:227], v[32:47]
buffer_load_dwordx4 v[216:219], v252, s[24:27], s57 offen offset:0
s_waitcnt lgkmcnt(8)
v_mfma_f32_32x32x16_bf16 v[48:63], v[76:79], v[224:227], v[48:63]
v_exp_f32 v232, v96
v_exp_f32 v233, v97
buffer_load_dwordx4 v[220:223], v252, s[24:27], s57 offen offset:2048
s_waitcnt lgkmcnt(6)
v_mfma_f32_32x32x16_bf16 v[0:15], v[80:83], v[228:231], v[0:15]
v_exp_f32 v234, v98
v_exp_f32 v235, v99
v_add_f32 v251, v232, v233
v_cvt_pk_bf16_f32 v224, v232, v233
s_waitcnt lgkmcnt(4)
v_mfma_f32_32x32x16_bf16 v[16:31], v[84:87], v[228:231], v[16:31]
v_exp_f32 v232, v100
v_exp_f32 v233, v101
v_add_f32 v251, v251, v234
v_cvt_pk_bf16_f32 v225, v234, v235
v_add_f32 v251, v251, v235
s_waitcnt lgkmcnt(2)
v_mfma_f32_32x32x16_bf16 v[32:47], v[88:91], v[228:231], v[32:47]
v_exp_f32 v234, v102
v_exp_f32 v235, v103
v_add_f32 v251, v251, v232
v_cvt_pk_bf16_f32 v226, v232, v233
v_add_f32 v251, v251, v233
s_waitcnt lgkmcnt(0)
v_mfma_f32_32x32x16_bf16 v[48:63], v[92:95], v[228:231], v[48:63]
s_waitcnt vmcnt(13)
s_barrier
ds_read_b64_tr_b16 v[64:65], v244 offset:0
ds_read_b64_tr_b16 v[66:67], v244 offset:2048
v_exp_f32 v232, v104
v_exp_f32 v233, v105
v_add_f32 v251, v251, v234
v_cvt_pk_bf16_f32 v227, v234, v235
v_add_f32 v251, v251, v235
ds_read_b64_tr_b16 v[68:69], v245 offset:0
ds_read_b64_tr_b16 v[70:71], v245 offset:2048
ds_read_b64_tr_b16 v[72:73], v246 offset:0
ds_read_b64_tr_b16 v[74:75], v246 offset:2048
v_exp_f32 v234, v106
v_exp_f32 v235, v107
v_add_f32 v251, v251, v232
v_cvt_pk_bf16_f32 v228, v232, v233
v_add_f32 v251, v251, v233
ds_read_b64_tr_b16 v[76:77], v247 offset:0
ds_read_b64_tr_b16 v[78:79], v247 offset:2048
ds_read_b64_tr_b16 v[80:81], v244 offset:4096
ds_read_b64_tr_b16 v[82:83], v244 offset:6144
v_exp_f32 v232, v108
v_exp_f32 v233, v109
v_add_f32 v251, v251, v234
v_cvt_pk_bf16_f32 v229, v234, v235
v_add_f32 v251, v251, v235
ds_read_b64_tr_b16 v[84:85], v245 offset:4096
ds_read_b64_tr_b16 v[86:87], v245 offset:6144
v_exp_f32 v234, v110
v_exp_f32 v235, v111
v_add_f32 v251, v251, v232
v_cvt_pk_bf16_f32 v230, v232, v233
v_add_f32 v251, v251, v233
ds_read_b64_tr_b16 v[88:89], v246 offset:4096
ds_read_b64_tr_b16 v[90:91], v246 offset:6144
v_add_f32 v251, v251, v234
v_cvt_pk_bf16_f32 v231, v234, v235
v_add_f32 v251, v251, v235
ds_read_b64_tr_b16 v[92:93], v247 offset:4096
ds_read_b64_tr_b16 v[94:95], v247 offset:6144
v_cmp_lt_f32 vcc, s48, v251
s_mov_b32 s49, 15
s_cbranch_vccnz FIX_1
SM_15:
v_add_f32 v248, v248, v251
s_waitcnt lgkmcnt(14)
v_mfma_f32_32x32x16_bf16 v[0:15], v[64:67], v[224:227], v[0:15]
s_add_u32 s56, s3, 3
s_and_b32 s56, s56, 15
s_lshl_b32 s56, s56, 15
s_add_u32 s57, s56, 8192
buffer_load_dwordx4 v[128:131], v252, s[24:27], s56 offen offset:0
s_waitcnt lgkmcnt(12)
v_mfma_f32_32x32x16_bf16 v[16:31], v[68:71], v[224:227], v[16:31]
buffer_load_dwordx4 v[132:135], v252, s[24:27], s56 offen offset:2048
s_waitcnt lgkmcnt(10)
v_mfma_f32_32x32x16_bf16 v[32:47], v[72:75], v[224:227], v[32:47]
buffer_load_dwordx4 v[136:139], v252, s[24:27], s57 offen offset:0
s_waitcnt lgkmcnt(8)
v_mfma_f32_32x32x16_bf16 v[48:63], v[76:79], v[224:227], v[48:63]
buffer_load_dwordx4 v[140:143], v252, s[24:27], s57 offen offset:2048
s_waitcnt lgkmcnt(6)
v_mfma_f32_32x32x16_bf16 v[0:15], v[80:83], v[228:231], v[0:15]
s_waitcnt lgkmcnt(4)
v_mfma_f32_32x32x16_bf16 v[16:31], v[84:87], v[228:231], v[16:31]
s_waitcnt lgkmcnt(2)
v_mfma_f32_32x32x16_bf16 v[32:47], v[88:91], v[228:231], v[32:47]
s_waitcnt lgkmcnt(0)
v_mfma_f32_32x32x16_bf16 v[48:63], v[92:95], v[228:231], v[48:63]
s_add_u32 s56, s3, 4
s_and_b32 s56, s56, 15
s_lshl_b32 s56, s56, 15
s_add_u32 s57, s56, 8192
buffer_load_dwordx4 v[144:147], v252, s[24:27], s56 offen offset:0
buffer_load_dwordx4 v[148:151], v252, s[24:27], s56 offen offset:2048
buffer_load_dwordx4 v[152:155], v252, s[24:27], s57 offen offset:0
buffer_load_dwordx4 v[156:159], v252, s[24:27], s57 offen offset:2048
s_add_u32 s56, s3, 5
s_and_b32 s56, s56, 15
s_lshl_b32 s56, s56, 15
s_add_u32 s57, s56, 8192
buffer_load_dwordx4 v[112:115], v252, s[24:27], s56 offen offset:0
buffer_load_dwordx4 v[116:119], v252, s[24:27], s56 offen offset:2048
buffer_load_dwordx4 v[120:123], v252, s[24:27], s57 offen offset:0
buffer_load_dwordx4 v[124:127], v252, s[24:27], s57 offen offset:2048
s_waitcnt vmcnt(20)
v_readfirstlane_b32 s52, v253
s_mov_b32 s55, 1048576
s_cmp_lg_u32 s40, 0
s_cbranch_scc1 L_cnt_ok
L_cnt:
s_cmp_ge_u32 s52, 8
s_cbranch_scc1 L_cnt_ok
s_sub_u32 s55, s55, 1
s_cbranch_scc1 L_cnt_ok
buffer_load_dword v253, v254, s[36:39], 0 offen sc1
s_waitcnt vmcnt(0)
v_readfirstlane_b32 s52, v253
s_nop 1
s_branch L_cnt
L_cnt_ok:
v_mov_b32 v232, v248
s_nop 1
v_permlane32_swap_b32 v248, v232
v_add_f32 v248, v248, v232
v_rcp_f32 v248, v248
v_and_b32 v232, 15, v255
v_lshlrev_b32 v232, 4, v232
v_bfe_u32 v233, v255, 4, 1
v_lshl_add_u32 v232, v233, 10, v232
v_lshrrev_b32 v233, 5, v255
v_lshl_add_u32 v232, v233, 8, v232
s_and_b32 s52, s40, 3
s_lshl_b32 s52, s52, 14
s_lshl_b32 s53, s47, 11
s_add_u32 s52, s52, s53
v_add_u32 v254, s52, v232
v_mov_b32 v249, v248
v_pk_mul_f32 v[0:1], v[0:1], v[248:249]
v_pk_mul_f32 v[2:3], v[2:3], v[248:249]
v_pk_mul_f32 v[4:5], v[4:5], v[248:249]
v_pk_mul_f32 v[6:7], v[6:7], v[248:249]
v_pk_mul_f32 v[8:9], v[8:9], v[248:249]
v_pk_mul_f32 v[10:11], v[10:11], v[248:249]
v_pk_mul_f32 v[12:13], v[12:13], v[248:249]
v_pk_mul_f32 v[14:15], v[14:15], v[248:249]
v_cvt_pk_bf16_f32 v0, v0, v1
v_cvt_pk_bf16_f32 v1, v2, v3
v_cvt_pk_bf16_f32 v2, v4, v5
v_cvt_pk_bf16_f32 v3, v6, v7
v_cvt_pk_bf16_f32 v4, v8, v9
v_cvt_pk_bf16_f32 v5, v10, v11
v_cvt_pk_bf16_f32 v6, v12, v13
v_cvt_pk_bf16_f32 v7, v14, v15
ds_write_b128 v254, v[0:3] offset:0
ds_write_b128 v254, v[4:7] offset:512
v_pk_mul_f32 v[16:17], v[16:17], v[248:249]
v_pk_mul_f32 v[18:19], v[18:19], v[248:249]
v_pk_mul_f32 v[20:21], v[20:21], v[248:249]
v_pk_mul_f32 v[22:23], v[22:23], v[248:249]
v_pk_mul_f32 v[24:25], v[24:25], v[248:249]
v_pk_mul_f32 v[26:27], v[26:27], v[248:249]
v_pk_mul_f32 v[28:29], v[28:29], v[248:249]
v_pk_mul_f32 v[30:31], v[30:31], v[248:249]
v_cvt_pk_bf16_f32 v16, v16, v17
v_cvt_pk_bf16_f32 v17, v18, v19
v_cvt_pk_bf16_f32 v18, v20, v21
v_cvt_pk_bf16_f32 v19, v22, v23
v_cvt_pk_bf16_f32 v20, v24, v25
v_cvt_pk_bf16_f32 v21, v26, v27
v_cvt_pk_bf16_f32 v22, v28, v29
v_cvt_pk_bf16_f32 v23, v30, v31
ds_write_b128 v254, v[16:19] offset:4096
ds_write_b128 v254, v[20:23] offset:4608
v_pk_mul_f32 v[32:33], v[32:33], v[248:249]
v_pk_mul_f32 v[34:35], v[34:35], v[248:249]
v_pk_mul_f32 v[36:37], v[36:37], v[248:249]
v_pk_mul_f32 v[38:39], v[38:39], v[248:249]
v_pk_mul_f32 v[40:41], v[40:41], v[248:249]
v_pk_mul_f32 v[42:43], v[42:43], v[248:249]
v_pk_mul_f32 v[44:45], v[44:45], v[248:249]
v_pk_mul_f32 v[46:47], v[46:47], v[248:249]
v_cvt_pk_bf16_f32 v32, v32, v33
v_cvt_pk_bf16_f32 v33, v34, v35
v_cvt_pk_bf16_f32 v34, v36, v37
v_cvt_pk_bf16_f32 v35, v38, v39
v_cvt_pk_bf16_f32 v36, v40, v41
v_cvt_pk_bf16_f32 v37, v42, v43
v_cvt_pk_bf16_f32 v38, v44, v45
v_cvt_pk_bf16_f32 v39, v46, v47
ds_write_b128 v254, v[32:35] offset:8192
ds_write_b128 v254, v[36:39] offset:8704
v_pk_mul_f32 v[48:49], v[48:49], v[248:249]
v_pk_mul_f32 v[50:51], v[50:51], v[248:249]
v_pk_mul_f32 v[52:53], v[52:53], v[248:249]
v_pk_mul_f32 v[54:55], v[54:55], v[248:249]
v_pk_mul_f32 v[56:57], v[56:57], v[248:249]
v_pk_mul_f32 v[58:59], v[58:59], v[248:249]
v_pk_mul_f32 v[60:61], v[60:61], v[248:249]
v_pk_mul_f32 v[62:63], v[62:63], v[248:249]
v_cvt_pk_bf16_f32 v48, v48, v49
v_cvt_pk_bf16_f32 v49, v50, v51
v_cvt_pk_bf16_f32 v50, v52, v53
v_cvt_pk_bf16_f32 v51, v54, v55
v_cvt_pk_bf16_f32 v52, v56, v57
v_cvt_pk_bf16_f32 v53, v58, v59
v_cvt_pk_bf16_f32 v54, v60, v61
v_cvt_pk_bf16_f32 v55, v62, v63
ds_write_b128 v254, v[48:51] offset:12288
ds_write_b128 v254, v[52:55] offset:12800
s_add_u32 s56, s3, 6
s_and_b32 s56, s56, 15
s_lshl_b32 s56, s56, 15
s_add_u32 s57, s56, 8192
buffer_load_dwordx4 v[64:67], v252, s[24:27], s56 offen offset:0
buffer_load_dwordx4 v[68:71], v252, s[24:27], s56 offen offset:2048
buffer_load_dwordx4 v[72:75], v252, s[24:27], s57 offen offset:0
buffer_load_dwordx4 v[76:79], v252, s[24:27], s57 offen offset:2048
s_add_u32 s56, s3, 7
s_and_b32 s56, s56, 15
s_lshl_b32 s56, s56, 15
s_add_u32 s57, s56, 8192
buffer_load_dwordx4 v[80:83], v252, s[24:27], s56 offen offset:0
buffer_load_dwordx4 v[84:87], v252, s[24:27], s56 offen offset:2048
buffer_load_dwordx4 v[88:91], v252, s[24:27], s57 offen offset:0
buffer_load_dwordx4 v[92:95], v252, s[24:27], s57 offen offset:2048
s_waitcnt lgkmcnt(0)
s_barrier
s_mov_b32 vcc_lo, 0x00ff00ff
s_mov_b32 vcc_hi, 0x00ff00ff
v_lshlrev_b32 v253, 4, v255
s_add_u32 s54, s3, 0
s_and_b32 s54, s54, 15
s_lshl_b32 s54, s54, 12
v_add_u32 v254, s54, v253
ds_read_b128 v[160:163], v254 offset:0
ds_read_b128 v[164:167], v254 offset:1024
ds_read_b128 v[168:171], v254 offset:2048
ds_read_b128 v[172:175], v254 offset:3072
v_bfe_u32 v237, v255, 3, 1
v_lshlrev_b32 v236, 10, v237
v_and_b32 v237, 7, v255
v_lshl_add_u32 v236, v237, 4, v236
v_bfe_u32 v237, v255, 4, 1
v_lshl_add_u32 v236, v237, 7, v236
v_lshrrev_b32 v237, 5, v255
v_lshl_add_u32 v236, v237, 9, v236
v_cndmask_b32_dpp v100, v178, v176, vcc row_ror:8 row_mask:0xf bank_mask:0xf
v_cndmask_b32_dpp v101, v182, v180, vcc row_ror:8 row_mask:0xf bank_mask:0xf
v_mov_b32_dpp v178, v176 row_ror:8 row_mask:0xf bank_mask:0x3
v_mov_b32_dpp v182, v180 row_ror:8 row_mask:0xf bank_mask:0x3
v_perm_b32 v96, v178, v100, s45
v_perm_b32 v97, v182, v101, s45
v_perm_b32 v100, v178, v100, s46
v_perm_b32 v101, v182, v101, s46
v_cndmask_b32_dpp v102, v186, v184, vcc row_ror:8 row_mask:0xf bank_mask:0xf
v_cndmask_b32_dpp v103, v190, v188, vcc row_ror:8 row_mask:0xf bank_mask:0xf
v_mov_b32_dpp v186, v184 row_ror:8 row_mask:0xf bank_mask:0x3
v_mov_b32_dpp v190, v188 row_ror:8 row_mask:0xf bank_mask:0x3
v_perm_b32 v98, v186, v102, s45
v_perm_b32 v99, v190, v103, s45
v_perm_b32 v102, v186, v102, s46
v_perm_b32 v103, v190, v103, s46
s_waitcnt lgkmcnt(3)
v_mfma_f32_16x16x32_bf16 v[0:3], v[96:99], v[160:163], 0
v_cndmask_b32_dpp v108, v179, v177, vcc row_ror:8 row_mask:0xf bank_mask:0xf
v_cndmask_b32_dpp v109, v183, v181, vcc row_ror:8 row_mask:0xf bank_mask:0xf
s_waitcnt lgkmcnt(2)
v_mfma_f32_16x16x32_bf16 v[4:7], v[96:99], v[164:167], 0
v_mov_b32_dpp v179, v177 row_ror:8 row_mask:0xf bank_mask:0x3
v_mov_b32_dpp v183, v181 row_ror:8 row_mask:0xf bank_mask:0x3
s_waitcnt lgkmcnt(1)
v_mfma_f32_16x16x32_bf16 v[8:11], v[96:99], v[168:171], 0
v_perm_b32 v104, v179, v108, s45
v_perm_b32 v105, v183, v109, s45
s_waitcnt lgkmcnt(0)
v_mfma_f32_16x16x32_bf16 v[12:15], v[96:99], v[172:175], 0
v_perm_b32 v108, v179, v108, s46
v_perm_b32 v109, v183, v109, s46
v_mfma_f32_16x16x32_bf16 v[16:19], v[100:103], v[160:163], 0
v_cndmask_b32_dpp v110, v187, v185, vcc row_ror:8 row_mask:0xf bank_mask:0xf
v_cndmask_b32_dpp v111, v191, v189, vcc row_ror:8 row_mask:0xf bank_mask:0xf
v_mfma_f32_16x16x32_bf16 v[20:23], v[100:103], v[164:167], 0
v_mov_b32_dpp v187, v185 row_ror:8 row_mask:0xf bank_mask:0x3
v_mov_b32_dpp v191, v189 row_ror:8 row_mask:0xf bank_mask:0x3
v_mfma_f32_16x16x32_bf16 v[24:27], v[100:103], v[168:171], 0
v_perm_b32 v106, v187, v110, s45
v_perm_b32 v107, v191, v111, s45
v_mfma_f32_16x16x32_bf16 v[28:31], v[100:103], v[172:175], 0
v_perm_b32 v110, v187, v110, s46
v_perm_b32 v111, v191, v111, s46
v_mfma_f32_16x16x32_bf16 v[32:35], v[104:107], v[160:163], 0
s_add_u32 s56, s3, 8
s_and_b32 s56, s56, 15
s_lshl_b32 s56, s56, 15
s_add_u32 s57, s56, 8192
buffer_load_dwordx4 v[176:179], v252, s[24:27], s56 offen offset:0
buffer_load_dwordx4 v[180:183], v252, s[24:27], s56 offen offset:2048
buffer_load_dwordx4 v[184:187], v252, s[24:27], s57 offen offset:0
buffer_load_dwordx4 v[188:191], v252, s[24:27], s57 offen offset:2048
s_waitcnt vmcnt(31)
v_cndmask_b32_dpp v100, v194, v192, vcc row_ror:8 row_mask:0xf bank_mask:0xf
s_waitcnt vmcnt(30)
v_cndmask_b32_dpp v101, v198, v196, vcc row_ror:8 row_mask:0xf bank_mask:0xf
v_mfma_f32_16x16x32_bf16 v[48:51], v[108:111], v[160:163], 0
s_add_u32 s54, s3, 1
s_and_b32 s54, s54, 15
s_lshl_b32 s54, s54, 12
v_add_u32 v254, s54, v253
ds_read_b128 v[160:163], v254 offset:0
v_mov_b32_dpp v194, v192 row_ror:8 row_mask:0xf bank_mask:0x3
v_mov_b32_dpp v198, v196 row_ror:8 row_mask:0xf bank_mask:0x3
v_mfma_f32_16x16x32_bf16 v[36:39], v[104:107], v[164:167], 0
v_perm_b32 v96, v194, v100, s45
v_perm_b32 v97, v198, v101, s45
v_mfma_f32_16x16x32_bf16 v[52:55], v[108:111], v[164:167], 0
ds_read_b128 v[164:167], v254 offset:1024
v_perm_b32 v100, v194, v100, s46
v_perm_b32 v101, v198, v101, s46
v_mfma_f32_16x16x32_bf16 v[40:43], v[104:107], v[168:171], 0
s_waitcnt vmcnt(29)
v_cndmask_b32_dpp v102, v202, v200, vcc row_ror:8 row_mask:0xf bank_mask:0xf
s_waitcnt vmcnt(28)
v_cndmask_b32_dpp v103, v206, v204, vcc row_ror:8 row_mask:0xf bank_mask:0xf
v_mfma_f32_16x16x32_bf16 v[56:59], v[108:111], v[168:171], 0
ds_read_b128 v[168:171], v254 offset:2048
v_mov_b32_dpp v202, v200 row_ror:8 row_mask:0xf bank_mask:0x3
v_mov_b32_dpp v206, v204 row_ror:8 row_mask:0xf bank_mask:0x3
v_mfma_f32_16x16x32_bf16 v[44:47], v[104:107], v[172:175], 0
v_perm_b32 v98, v202, v102, s45
v_perm_b32 v99, v206, v103, s45
v_mfma_f32_16x16x32_bf16 v[60:63], v[108:111], v[172:175], 0
ds_read_b128 v[172:175], v254 offset:3072
v_perm_b32 v102, v202, v102, s46
v_perm_b32 v103, v206, v103, s46
s_waitcnt lgkmcnt(3)
v_mfma_f32_16x16x32_bf16 v[0:3], v[96:99], v[160:163], v[0:3]
v_cndmask_b32_dpp v108, v195, v193, vcc row_ror:8 row_mask:0xf bank_mask:0xf
v_cndmask_b32_dpp v109, v199, v197, vcc row_ror:8 row_mask:0xf bank_mask:0xf
s_waitcnt lgkmcnt(2)
v_mfma_f32_16x16x32_bf16 v[4:7], v[96:99], v[164:167], v[4:7]
v_mov_b32_dpp v195, v193 row_ror:8 row_mask:0xf bank_mask:0x3
v_mov_b32_dpp v199, v197 row_ror:8 row_mask:0xf bank_mask:0x3
s_waitcnt lgkmcnt(1)
v_mfma_f32_16x16x32_bf16 v[8:11], v[96:99], v[168:171], v[8:11]
v_perm_b32 v104, v195, v108, s45
v_perm_b32 v105, v199, v109, s45
s_waitcnt lgkmcnt(0)
v_mfma_f32_16x16x32_bf16 v[12:15], v[96:99], v[172:175], v[12:15]
v_perm_b32 v108, v195, v108, s46
v_perm_b32 v109, v199, v109, s46
v_mfma_f32_16x16x32_bf16 v[16:19], v[100:103], v[160:163], v[16:19]
v_cndmask_b32_dpp v110, v203, v201, vcc row_ror:8 row_mask:0xf bank_mask:0xf
v_cndmask_b32_dpp v111, v207, v205, vcc row_ror:8 row_mask:0xf bank_mask:0xf
v_mfma_f32_16x16x32_bf16 v[20:23], v[100:103], v[164:167], v[20:23]
v_mov_b32_dpp v203, v201 row_ror:8 row_mask:0xf bank_mask:0x3
v_mov_b32_dpp v207, v205 row_ror:8 row_mask:0xf bank_mask:0x3
v_mfma_f32_16x16x32_bf16 v[24:27], v[100:103], v[168:171], v[24:27]
v_perm_b32 v106, v203, v110, s45
v_perm_b32 v107, v207, v111, s45
v_mfma_f32_16x16x32_bf16 v[28:31], v[100:103], v[172:175], v[28:31]
v_perm_b32 v110, v203, v110, s46
v_perm_b32 v111, v207, v111, s46
v_mfma_f32_16x16x32_bf16 v[32:35], v[104:107], v[160:163], v[32:35]
s_add_u32 s56, s3, 9
s_and_b32 s56, s56, 15
s_lshl_b32 s56, s56, 15
s_add_u32 s57, s56, 8192
buffer_load_dwordx4 v[192:195], v252, s[24:27], s56 offen offset:0
buffer_load_dwordx4 v[196:199], v252, s[24:27], s56 offen offset:2048
buffer_load_dwordx4 v[200:203], v252, s[24:27], s57 offen offset:0
buffer_load_dwordx4 v[204:207], v252, s[24:27], s57 offen offset:2048
s_waitcnt vmcnt(31)
v_cndmask_b32_dpp v100, v210, v208, vcc row_ror:8 row_mask:0xf bank_mask:0xf
s_waitcnt vmcnt(30)
v_cndmask_b32_dpp v101, v214, v212, vcc row_ror:8 row_mask:0xf bank_mask:0xf
v_mfma_f32_16x16x32_bf16 v[48:51], v[108:111], v[160:163], v[48:51]
s_add_u32 s54, s3, 2
s_and_b32 s54, s54, 15
s_lshl_b32 s54, s54, 12
v_add_u32 v254, s54, v253
ds_read_b128 v[160:163], v254 offset:0
v_mov_b32_dpp v210, v208 row_ror:8 row_mask:0xf bank_mask:0x3
v_mov_b32_dpp v214, v212 row_ror:8 row_mask:0xf bank_mask:0x3
v_mfma_f32_16x16x32_bf16 v[36:39], v[104:107], v[164:167], v[36:39]
v_perm_b32 v96, v210, v100, s45
v_perm_b32 v97, v214, v101, s45
v_mfma_f32_16x16x32_bf16 v[52:55], v[108:111], v[164:167], v[52:55]
ds_read_b128 v[164:167], v254 offset:1024
v_perm_b32 v100, v210, v100, s46
v_perm_b32 v101, v214, v101, s46
v_mfma_f32_16x16x32_bf16 v[40:43], v[104:107], v[168:171], v[40:43]
s_waitcnt vmcnt(29)
v_cndmask_b32_dpp v102, v218, v216, vcc row_ror:8 row_mask:0xf bank_mask:0xf
s_waitcnt vmcnt(28)
v_cndmask_b32_dpp v103, v222, v220, vcc row_ror:8 row_mask:0xf bank_mask:0xf
v_mfma_f32_16x16x32_bf16 v[56:59], v[108:111], v[168:171], v[56:59]
ds_read_b128 v[168:171], v254 offset:2048
v_mov_b32_dpp v218, v216 row_ror:8 row_mask:0xf bank_mask:0x3
v_mov_b32_dpp v222, v220 row_ror:8 row_mask:0xf bank_mask:0x3
v_mfma_f32_16x16x32_bf16 v[44:47], v[104:107], v[172:175], v[44:47]
v_perm_b32 v98, v218, v102, s45
v_perm_b32 v99, v222, v103, s45
v_mfma_f32_16x16x32_bf16 v[60:63], v[108:111], v[172:175], v[60:63]
ds_read_b128 v[172:175], v254 offset:3072
v_perm_b32 v102, v218, v102, s46
v_perm_b32 v103, v222, v103, s46
s_waitcnt lgkmcnt(3)
v_mfma_f32_16x16x32_bf16 v[0:3], v[96:99], v[160:163], v[0:3]
v_cndmask_b32_dpp v108, v211, v209, vcc row_ror:8 row_mask:0xf bank_mask:0xf
v_cndmask_b32_dpp v109, v215, v213, vcc row_ror:8 row_mask:0xf bank_mask:0xf
s_waitcnt lgkmcnt(2)
v_mfma_f32_16x16x32_bf16 v[4:7], v[96:99], v[164:167], v[4:7]
v_mov_b32_dpp v211, v209 row_ror:8 row_mask:0xf bank_mask:0x3
v_mov_b32_dpp v215, v213 row_ror:8 row_mask:0xf bank_mask:0x3
s_waitcnt lgkmcnt(1)
v_mfma_f32_16x16x32_bf16 v[8:11], v[96:99], v[168:171], v[8:11]
v_perm_b32 v104, v211, v108, s45
v_perm_b32 v105, v215, v109, s45
s_waitcnt lgkmcnt(0)
v_mfma_f32_16x16x32_bf16 v[12:15], v[96:99], v[172:175], v[12:15]
v_perm_b32 v108, v211, v108, s46
v_perm_b32 v109, v215, v109, s46
v_mfma_f32_16x16x32_bf16 v[16:19], v[100:103], v[160:163], v[16:19]
v_cndmask_b32_dpp v110, v219, v217, vcc row_ror:8 row_mask:0xf bank_mask:0xf
v_cndmask_b32_dpp v111, v223, v221, vcc row_ror:8 row_mask:0xf bank_mask:0xf
v_mfma_f32_16x16x32_bf16 v[20:23], v[100:103], v[164:167], v[20:23]
v_mov_b32_dpp v219, v217 row_ror:8 row_mask:0xf bank_mask:0x3
v_mov_b32_dpp v223, v221 row_ror:8 row_mask:0xf bank_mask:0x3
v_mfma_f32_16x16x32_bf16 v[24:27], v[100:103], v[168:171], v[24:27]
v_perm_b32 v106, v219, v110, s45
v_perm_b32 v107, v223, v111, s45
v_mfma_f32_16x16x32_bf16 v[28:31], v[100:103], v[172:175], v[28:31]
v_perm_b32 v110, v219, v110, s46
v_perm_b32 v111, v223, v111, s46
v_mfma_f32_16x16x32_bf16 v[32:35], v[104:107], v[160:163], v[32:35]
s_add_u32 s56, s3, 10
s_and_b32 s56, s56, 15
s_lshl_b32 s56, s56, 15
s_add_u32 s57, s56, 8192
buffer_load_dwordx4 v[208:211], v252, s[24:27], s56 offen offset:0
buffer_load_dwordx4 v[212:215], v252, s[24:27], s56 offen offset:2048
buffer_load_dwordx4 v[216:219], v252, s[24:27], s57 offen offset:0
buffer_load_dwordx4 v[220:223], v252, s[24:27], s57 offen offset:2048
s_waitcnt vmcnt(31)
v_cndmask_b32_dpp v100, v130, v128, vcc row_ror:8 row_mask:0xf bank_mask:0xf
s_waitcnt vmcnt(30)
v_cndmask_b32_dpp v101, v134, v132, vcc row_ror:8 row_mask:0xf bank_mask:0xf
v_mfma_f32_16x16x32_bf16 v[48:51], v[108:111], v[160:163], v[48:51]
s_add_u32 s54, s3, 3
s_and_b32 s54, s54, 15
s_lshl_b32 s54, s54, 12
v_add_u32 v254, s54, v253
ds_read_b128 v[160:163], v254 offset:0
v_mov_b32_dpp v130, v128 row_ror:8 row_mask:0xf bank_mask:0x3
v_mov_b32_dpp v134, v132 row_ror:8 row_mask:0xf bank_mask:0x3
v_mfma_f32_16x16x32_bf16 v[36:39], v[104:107], v[164:167], v[36:39]
v_perm_b32 v96, v130, v100, s45
v_perm_b32 v97, v134, v101, s45
v_mfma_f32_16x16x32_bf16 v[52:55], v[108:111], v[164:167], v[52:55]
ds_read_b128 v[164:167], v254 offset:1024
v_perm_b32 v100, v130, v100, s46
v_perm_b32 v101, v134, v101, s46
v_mfma_f32_16x16x32_bf16 v[40:43], v[104:107], v[168:171], v[40:43]
s_waitcnt vmcnt(29)
v_cndmask_b32_dpp v102, v138, v136, vcc row_ror:8 row_mask:0xf bank_mask:0xf
s_waitcnt vmcnt(28)
v_cndmask_b32_dpp v103, v142, v140, vcc row_ror:8 row_mask:0xf bank_mask:0xf
v_mfma_f32_16x16x32_bf16 v[56:59], v[108:111], v[168:171], v[56:59]
ds_read_b128 v[168:171], v254 offset:2048
v_mov_b32_dpp v138, v136 row_ror:8 row_mask:0xf bank_mask:0x3
v_mov_b32_dpp v142, v140 row_ror:8 row_mask:0xf bank_mask:0x3
v_mfma_f32_16x16x32_bf16 v[44:47], v[104:107], v[172:175], v[44:47]
v_perm_b32 v98, v138, v102, s45
v_perm_b32 v99, v142, v103, s45
v_mfma_f32_16x16x32_bf16 v[60:63], v[108:111], v[172:175], v[60:63]
ds_read_b128 v[172:175], v254 offset:3072
v_perm_b32 v102, v138, v102, s46
v_perm_b32 v103, v142, v103, s46
s_waitcnt lgkmcnt(3)
v_mfma_f32_16x16x32_bf16 v[0:3], v[96:99], v[160:163], v[0:3]
v_cndmask_b32_dpp v108, v131, v129, vcc row_ror:8 row_mask:0xf bank_mask:0xf
v_cndmask_b32_dpp v109, v135, v133, vcc row_ror:8 row_mask:0xf bank_mask:0xf
s_waitcnt lgkmcnt(2)
v_mfma_f32_16x16x32_bf16 v[4:7], v[96:99], v[164:167], v[4:7]
v_mov_b32_dpp v131, v129 row_ror:8 row_mask:0xf bank_mask:0x3
v_mov_b32_dpp v135, v133 row_ror:8 row_mask:0xf bank_mask:0x3
s_waitcnt lgkmcnt(1)
v_mfma_f32_16x16x32_bf16 v[8:11], v[96:99], v[168:171], v[8:11]
v_perm_b32 v104, v131, v108, s45
v_perm_b32 v105, v135, v109, s45
s_waitcnt lgkmcnt(0)
v_mfma_f32_16x16x32_bf16 v[12:15], v[96:99], v[172:175], v[12:15]
v_perm_b32 v108, v131, v108, s46
v_perm_b32 v109, v135, v109, s46
v_mfma_f32_16x16x32_bf16 v[16:19], v[100:103], v[160:163], v[16:19]
v_cndmask_b32_dpp v110, v139, v137, vcc row_ror:8 row_mask:0xf bank_mask:0xf
v_cndmask_b32_dpp v111, v143, v141, vcc row_ror:8 row_mask:0xf bank_mask:0xf
v_mfma_f32_16x16x32_bf16 v[20:23], v[100:103], v[164:167], v[20:23]
v_mov_b32_dpp v139, v137 row_ror:8 row_mask:0xf bank_mask:0x3
v_mov_b32_dpp v143, v141 row_ror:8 row_mask:0xf bank_mask:0x3
v_mfma_f32_16x16x32_bf16 v[24:27], v[100:103], v[168:171], v[24:27]
v_perm_b32 v106, v139, v110, s45
v_perm_b32 v107, v143, v111, s45
v_mfma_f32_16x16x32_bf16 v[28:31], v[100:103], v[172:175], v[28:31]
v_perm_b32 v110, v139, v110, s46
v_perm_b32 v111, v143, v111, s46
v_mfma_f32_16x16x32_bf16 v[32:35], v[104:107], v[160:163], v[32:35]
s_add_u32 s56, s3, 11
s_and_b32 s56, s56, 15
s_lshl_b32 s56, s56, 15
s_add_u32 s57, s56, 8192
buffer_load_dwordx4 v[128:131], v252, s[24:27], s56 offen offset:0
buffer_load_dwordx4 v[132:135], v252, s[24:27], s56 offen offset:2048
buffer_load_dwordx4 v[136:139], v252, s[24:27], s57 offen offset:0
buffer_load_dwordx4 v[140:143], v252, s[24:27], s57 offen offset:2048
s_waitcnt vmcnt(31)
v_cndmask_b32_dpp v100, v146, v144, vcc row_ror:8 row_mask:0xf bank_mask:0xf
s_waitcnt vmcnt(30)
v_cndmask_b32_dpp v101, v150, v148, vcc row_ror:8 row_mask:0xf bank_mask:0xf
v_mfma_f32_16x16x32_bf16 v[48:51], v[108:111], v[160:163], v[48:51]
s_add_u32 s54, s3, 4
s_and_b32 s54, s54, 15
s_lshl_b32 s54, s54, 12
v_add_u32 v254, s54, v253
ds_read_b128 v[160:163], v254 offset:0
v_mov_b32_dpp v146, v144 row_ror:8 row_mask:0xf bank_mask:0x3
v_mov_b32_dpp v150, v148 row_ror:8 row_mask:0xf bank_mask:0x3
v_mfma_f32_16x16x32_bf16 v[36:39], v[104:107], v[164:167], v[36:39]
v_perm_b32 v96, v146, v100, s45
v_perm_b32 v97, v150, v101, s45
v_mfma_f32_16x16x32_bf16 v[52:55], v[108:111], v[164:167], v[52:55]
ds_read_b128 v[164:167], v254 offset:1024
v_perm_b32 v100, v146, v100, s46
v_perm_b32 v101, v150, v101, s46
v_mfma_f32_16x16x32_bf16 v[40:43], v[104:107], v[168:171], v[40:43]
s_waitcnt vmcnt(29)
v_cndmask_b32_dpp v102, v154, v152, vcc row_ror:8 row_mask:0xf bank_mask:0xf
s_waitcnt vmcnt(28)
v_cndmask_b32_dpp v103, v158, v156, vcc row_ror:8 row_mask:0xf bank_mask:0xf
v_mfma_f32_16x16x32_bf16 v[56:59], v[108:111], v[168:171], v[56:59]
ds_read_b128 v[168:171], v254 offset:2048
v_mov_b32_dpp v154, v152 row_ror:8 row_mask:0xf bank_mask:0x3
v_mov_b32_dpp v158, v156 row_ror:8 row_mask:0xf bank_mask:0x3
v_mfma_f32_16x16x32_bf16 v[44:47], v[104:107], v[172:175], v[44:47]
v_perm_b32 v98, v154, v102, s45
v_perm_b32 v99, v158, v103, s45
v_mfma_f32_16x16x32_bf16 v[60:63], v[108:111], v[172:175], v[60:63]
ds_read_b128 v[172:175], v254 offset:3072
v_perm_b32 v102, v154, v102, s46
v_perm_b32 v103, v158, v103, s46
s_waitcnt lgkmcnt(3)
v_mfma_f32_16x16x32_bf16 v[0:3], v[96:99], v[160:163], v[0:3]
v_cndmask_b32_dpp v108, v147, v145, vcc row_ror:8 row_mask:0xf bank_mask:0xf
v_cndmask_b32_dpp v109, v151, v149, vcc row_ror:8 row_mask:0xf bank_mask:0xf
s_waitcnt lgkmcnt(2)
v_mfma_f32_16x16x32_bf16 v[4:7], v[96:99], v[164:167], v[4:7]
v_mov_b32_dpp v147, v145 row_ror:8 row_mask:0xf bank_mask:0x3
v_mov_b32_dpp v151, v149 row_ror:8 row_mask:0xf bank_mask:0x3
s_waitcnt lgkmcnt(1)
v_mfma_f32_16x16x32_bf16 v[8:11], v[96:99], v[168:171], v[8:11]
v_perm_b32 v104, v147, v108, s45
v_perm_b32 v105, v151, v109, s45
s_waitcnt lgkmcnt(0)
v_mfma_f32_16x16x32_bf16 v[12:15], v[96:99], v[172:175], v[12:15]
v_perm_b32 v108, v147, v108, s46
v_perm_b32 v109, v151, v109, s46
v_mfma_f32_16x16x32_bf16 v[16:19], v[100:103], v[160:163], v[16:19]
v_cndmask_b32_dpp v110, v155, v153, vcc row_ror:8 row_mask:0xf bank_mask:0xf
v_cndmask_b32_dpp v111, v159, v157, vcc row_ror:8 row_mask:0xf bank_mask:0xf
v_mfma_f32_16x16x32_bf16 v[20:23], v[100:103], v[164:167], v[20:23]
v_mov_b32_dpp v155, v153 row_ror:8 row_mask:0xf bank_mask:0x3
v_mov_b32_dpp v159, v157 row_ror:8 row_mask:0xf bank_mask:0x3
v_mfma_f32_16x16x32_bf16 v[24:27], v[100:103], v[168:171], v[24:27]
v_perm_b32 v106, v155, v110, s45
v_perm_b32 v107, v159, v111, s45
v_mfma_f32_16x16x32_bf16 v[28:31], v[100:103], v[172:175], v[28:31]
v_perm_b32 v110, v155, v110, s46
v_perm_b32 v111, v159, v111, s46
v_mfma_f32_16x16x32_bf16 v[32:35], v[104:107], v[160:163], v[32:35]
s_add_u32 s56, s3, 12
s_and_b32 s56, s56, 15
s_lshl_b32 s56, s56, 15
s_add_u32 s57, s56, 8192
buffer_load_dwordx4 v[144:147], v252, s[24:27], s56 offen offset:0
buffer_load_dwordx4 v[148:151], v252, s[24:27], s56 offen offset:2048
buffer_load_dwordx4 v[152:155], v252, s[24:27], s57 offen offset:0
buffer_load_dwordx4 v[156:159], v252, s[24:27], s57 offen offset:2048
s_waitcnt vmcnt(31)
v_cndmask_b32_dpp v100, v114, v112, vcc row_ror:8 row_mask:0xf bank_mask:0xf
s_waitcnt vmcnt(30)
v_cndmask_b32_dpp v101, v118, v116, vcc row_ror:8 row_mask:0xf bank_mask:0xf
v_mfma_f32_16x16x32_bf16 v[48:51], v[108:111], v[160:163], v[48:51]
s_add_u32 s54, s3, 5
s_and_b32 s54, s54, 15
s_lshl_b32 s54, s54, 12
v_add_u32 v254, s54, v253
ds_read_b128 v[160:163], v254 offset:0
v_mov_b32_dpp v114, v112 row_ror:8 row_mask:0xf bank_mask:0x3
v_mov_b32_dpp v118, v116 row_ror:8 row_mask:0xf bank_mask:0x3
v_mfma_f32_16x16x32_bf16 v[36:39], v[104:107], v[164:167], v[36:39]
v_perm_b32 v96, v114, v100, s45
v_perm_b32 v97, v118, v101, s45
v_mfma_f32_16x16x32_bf16 v[52:55], v[108:111], v[164:167], v[52:55]
ds_read_b128 v[164:167], v254 offset:1024
v_perm_b32 v100, v114, v100, s46
v_perm_b32 v101, v118, v101, s46
v_mfma_f32_16x16x32_bf16 v[40:43], v[104:107], v[168:171], v[40:43]
s_waitcnt vmcnt(29)
v_cndmask_b32_dpp v102, v122, v120, vcc row_ror:8 row_mask:0xf bank_mask:0xf
s_waitcnt vmcnt(28)
v_cndmask_b32_dpp v103, v126, v124, vcc row_ror:8 row_mask:0xf bank_mask:0xf
v_mfma_f32_16x16x32_bf16 v[56:59], v[108:111], v[168:171], v[56:59]
ds_read_b128 v[168:171], v254 offset:2048
v_mov_b32_dpp v122, v120 row_ror:8 row_mask:0xf bank_mask:0x3
v_mov_b32_dpp v126, v124 row_ror:8 row_mask:0xf bank_mask:0x3
v_mfma_f32_16x16x32_bf16 v[44:47], v[104:107], v[172:175], v[44:47]
v_perm_b32 v98, v122, v102, s45
v_perm_b32 v99, v126, v103, s45
v_mfma_f32_16x16x32_bf16 v[60:63], v[108:111], v[172:175], v[60:63]
ds_read_b128 v[172:175], v254 offset:3072
v_perm_b32 v102, v122, v102, s46
v_perm_b32 v103, v126, v103, s46
s_waitcnt lgkmcnt(3)
v_mfma_f32_16x16x32_bf16 v[0:3], v[96:99], v[160:163], v[0:3]
v_cndmask_b32_dpp v108, v115, v113, vcc row_ror:8 row_mask:0xf bank_mask:0xf
v_cndmask_b32_dpp v109, v119, v117, vcc row_ror:8 row_mask:0xf bank_mask:0xf
s_waitcnt lgkmcnt(2)
v_mfma_f32_16x16x32_bf16 v[4:7], v[96:99], v[164:167], v[4:7]
v_mov_b32_dpp v115, v113 row_ror:8 row_mask:0xf bank_mask:0x3
v_mov_b32_dpp v119, v117 row_ror:8 row_mask:0xf bank_mask:0x3
s_waitcnt lgkmcnt(1)
v_mfma_f32_16x16x32_bf16 v[8:11], v[96:99], v[168:171], v[8:11]
v_perm_b32 v104, v115, v108, s45
v_perm_b32 v105, v119, v109, s45
s_waitcnt lgkmcnt(0)
v_mfma_f32_16x16x32_bf16 v[12:15], v[96:99], v[172:175], v[12:15]
v_perm_b32 v108, v115, v108, s46
v_perm_b32 v109, v119, v109, s46
v_mfma_f32_16x16x32_bf16 v[16:19], v[100:103], v[160:163], v[16:19]
v_cndmask_b32_dpp v110, v123, v121, vcc row_ror:8 row_mask:0xf bank_mask:0xf
v_cndmask_b32_dpp v111, v127, v125, vcc row_ror:8 row_mask:0xf bank_mask:0xf
v_mfma_f32_16x16x32_bf16 v[20:23], v[100:103], v[164:167], v[20:23]
v_mov_b32_dpp v123, v121 row_ror:8 row_mask:0xf bank_mask:0x3
v_mov_b32_dpp v127, v125 row_ror:8 row_mask:0xf bank_mask:0x3
v_mfma_f32_16x16x32_bf16 v[24:27], v[100:103], v[168:171], v[24:27]
v_perm_b32 v106, v123, v110, s45
v_perm_b32 v107, v127, v111, s45
v_mfma_f32_16x16x32_bf16 v[28:31], v[100:103], v[172:175], v[28:31]
v_perm_b32 v110, v123, v110, s46
v_perm_b32 v111, v127, v111, s46
v_mfma_f32_16x16x32_bf16 v[32:35], v[104:107], v[160:163], v[32:35]
s_add_u32 s56, s3, 13
s_and_b32 s56, s56, 15
s_lshl_b32 s56, s56, 15
s_add_u32 s57, s56, 8192
buffer_load_dwordx4 v[112:115], v252, s[24:27], s56 offen offset:0
buffer_load_dwordx4 v[116:119], v252, s[24:27], s56 offen offset:2048
buffer_load_dwordx4 v[120:123], v252, s[24:27], s57 offen offset:0
buffer_load_dwordx4 v[124:127], v252, s[24:27], s57 offen offset:2048
s_waitcnt vmcnt(31)
v_cndmask_b32_dpp v100, v66, v64, vcc row_ror:8 row_mask:0xf bank_mask:0xf
s_waitcnt vmcnt(30)
v_cndmask_b32_dpp v101, v70, v68, vcc row_ror:8 row_mask:0xf bank_mask:0xf
v_mfma_f32_16x16x32_bf16 v[48:51], v[108:111], v[160:163], v[48:51]
s_add_u32 s54, s3, 6
s_and_b32 s54, s54, 15
s_lshl_b32 s54, s54, 12
v_add_u32 v254, s54, v253
ds_read_b128 v[160:163], v254 offset:0
v_mov_b32_dpp v66, v64 row_ror:8 row_mask:0xf bank_mask:0x3
v_mov_b32_dpp v70, v68 row_ror:8 row_mask:0xf bank_mask:0x3
v_mfma_f32_16x16x32_bf16 v[36:39], v[104:107], v[164:167], v[36:39]
v_perm_b32 v96, v66, v100, s45
v_perm_b32 v97, v70, v101, s45
v_mfma_f32_16x16x32_bf16 v[52:55], v[108:111], v[164:167], v[52:55]
ds_read_b128 v[164:167], v254 offset:1024
v_perm_b32 v100, v66, v100, s46
v_perm_b32 v101, v70, v101, s46
v_mfma_f32_16x16x32_bf16 v[40:43], v[104:107], v[168:171], v[40:43]
s_waitcnt vmcnt(29)
v_cndmask_b32_dpp v102, v74, v72, vcc row_ror:8 row_mask:0xf bank_mask:0xf
s_waitcnt vmcnt(28)
v_cndmask_b32_dpp v103, v78, v76, vcc row_ror:8 row_mask:0xf bank_mask:0xf
v_mfma_f32_16x16x32_bf16 v[56:59], v[108:111], v[168:171], v[56:59]
ds_read_b128 v[168:171], v254 offset:2048
v_mov_b32_dpp v74, v72 row_ror:8 row_mask:0xf bank_mask:0x3
v_mov_b32_dpp v78, v76 row_ror:8 row_mask:0xf bank_mask:0x3
v_mfma_f32_16x16x32_bf16 v[44:47], v[104:107], v[172:175], v[44:47]
v_perm_b32 v98, v74, v102, s45
v_perm_b32 v99, v78, v103, s45
v_mfma_f32_16x16x32_bf16 v[60:63], v[108:111], v[172:175], v[60:63]
ds_read_b128 v[172:175], v254 offset:3072
v_perm_b32 v102, v74, v102, s46
v_perm_b32 v103, v78, v103, s46
s_waitcnt lgkmcnt(3)
v_mfma_f32_16x16x32_bf16 v[0:3], v[96:99], v[160:163], v[0:3]
v_cndmask_b32_dpp v108, v67, v65, vcc row_ror:8 row_mask:0xf bank_mask:0xf
v_cndmask_b32_dpp v109, v71, v69, vcc row_ror:8 row_mask:0xf bank_mask:0xf
s_waitcnt lgkmcnt(2)
v_mfma_f32_16x16x32_bf16 v[4:7], v[96:99], v[164:167], v[4:7]
v_mov_b32_dpp v67, v65 row_ror:8 row_mask:0xf bank_mask:0x3
v_mov_b32_dpp v71, v69 row_ror:8 row_mask:0xf bank_mask:0x3
s_waitcnt lgkmcnt(1)
v_mfma_f32_16x16x32_bf16 v[8:11], v[96:99], v[168:171], v[8:11]
v_perm_b32 v104, v67, v108, s45
v_perm_b32 v105, v71, v109, s45
s_waitcnt lgkmcnt(0)
v_mfma_f32_16x16x32_bf16 v[12:15], v[96:99], v[172:175], v[12:15]
v_perm_b32 v108, v67, v108, s46
v_perm_b32 v109, v71, v109, s46
v_mfma_f32_16x16x32_bf16 v[16:19], v[100:103], v[160:163], v[16:19]
v_cndmask_b32_dpp v110, v75, v73, vcc row_ror:8 row_mask:0xf bank_mask:0xf
v_cndmask_b32_dpp v111, v79, v77, vcc row_ror:8 row_mask:0xf bank_mask:0xf
v_mfma_f32_16x16x32_bf16 v[20:23], v[100:103], v[164:167], v[20:23]
v_mov_b32_dpp v75, v73 row_ror:8 row_mask:0xf bank_mask:0x3
v_mov_b32_dpp v79, v77 row_ror:8 row_mask:0xf bank_mask:0x3
v_mfma_f32_16x16x32_bf16 v[24:27], v[100:103], v[168:171], v[24:27]
v_perm_b32 v106, v75, v110, s45
v_perm_b32 v107, v79, v111, s45
v_mfma_f32_16x16x32_bf16 v[28:31], v[100:103], v[172:175], v[28:31]
v_perm_b32 v110, v75, v110, s46
v_perm_b32 v111, v79, v111, s46
v_mfma_f32_16x16x32_bf16 v[32:35], v[104:107], v[160:163], v[32:35]
s_add_u32 s56, s3, 14
s_and_b32 s56, s56, 15
s_lshl_b32 s56, s56, 15
s_add_u32 s57, s56, 8192
buffer_load_dwordx4 v[64:67], v252, s[24:27], s56 offen offset:0
buffer_load_dwordx4 v[68:71], v252, s[24:27], s56 offen offset:2048
buffer_load_dwordx4 v[72:75], v252, s[24:27], s57 offen offset:0
buffer_load_dwordx4 v[76:79], v252, s[24:27], s57 offen offset:2048
s_waitcnt vmcnt(31)
v_cndmask_b32_dpp v100, v82, v80, vcc row_ror:8 row_mask:0xf bank_mask:0xf
s_waitcnt vmcnt(30)
v_cndmask_b32_dpp v101, v86, v84, vcc row_ror:8 row_mask:0xf bank_mask:0xf
v_mfma_f32_16x16x32_bf16 v[48:51], v[108:111], v[160:163], v[48:51]
s_add_u32 s54, s3, 7
s_and_b32 s54, s54, 15
s_lshl_b32 s54, s54, 12
v_add_u32 v254, s54, v253
ds_read_b128 v[160:163], v254 offset:0
v_mov_b32_dpp v82, v80 row_ror:8 row_mask:0xf bank_mask:0x3
v_mov_b32_dpp v86, v84 row_ror:8 row_mask:0xf bank_mask:0x3
v_mfma_f32_16x16x32_bf16 v[36:39], v[104:107], v[164:167], v[36:39]
v_perm_b32 v96, v82, v100, s45
v_perm_b32 v97, v86, v101, s45
v_mfma_f32_16x16x32_bf16 v[52:55], v[108:111], v[164:167], v[52:55]
ds_read_b128 v[164:167], v254 offset:1024
v_perm_b32 v100, v82, v100, s46
v_perm_b32 v101, v86, v101, s46
v_mfma_f32_16x16x32_bf16 v[40:43], v[104:107], v[168:171], v[40:43]
s_waitcnt vmcnt(29)
v_cndmask_b32_dpp v102, v90, v88, vcc row_ror:8 row_mask:0xf bank_mask:0xf
s_waitcnt vmcnt(28)
v_cndmask_b32_dpp v103, v94, v92, vcc row_ror:8 row_mask:0xf bank_mask:0xf
v_mfma_f32_16x16x32_bf16 v[56:59], v[108:111], v[168:171], v[56:59]
ds_read_b128 v[168:171], v254 offset:2048
v_mov_b32_dpp v90, v88 row_ror:8 row_mask:0xf bank_mask:0x3
v_mov_b32_dpp v94, v92 row_ror:8 row_mask:0xf bank_mask:0x3
v_mfma_f32_16x16x32_bf16 v[44:47], v[104:107], v[172:175], v[44:47]
v_perm_b32 v98, v90, v102, s45
v_perm_b32 v99, v94, v103, s45
v_mfma_f32_16x16x32_bf16 v[60:63], v[108:111], v[172:175], v[60:63]
ds_read_b128 v[172:175], v254 offset:3072
v_perm_b32 v102, v90, v102, s46
v_perm_b32 v103, v94, v103, s46
s_waitcnt lgkmcnt(3)
v_mfma_f32_16x16x32_bf16 v[0:3], v[96:99], v[160:163], v[0:3]
v_cndmask_b32_dpp v108, v83, v81, vcc row_ror:8 row_mask:0xf bank_mask:0xf
v_cndmask_b32_dpp v109, v87, v85, vcc row_ror:8 row_mask:0xf bank_mask:0xf
s_waitcnt lgkmcnt(2)
v_mfma_f32_16x16x32_bf16 v[4:7], v[96:99], v[164:167], v[4:7]
v_mov_b32_dpp v83, v81 row_ror:8 row_mask:0xf bank_mask:0x3
v_mov_b32_dpp v87, v85 row_ror:8 row_mask:0xf bank_mask:0x3
s_waitcnt lgkmcnt(1)
v_mfma_f32_16x16x32_bf16 v[8:11], v[96:99], v[168:171], v[8:11]
v_perm_b32 v104, v83, v108, s45
v_perm_b32 v105, v87, v109, s45
s_waitcnt lgkmcnt(0)
v_mfma_f32_16x16x32_bf16 v[12:15], v[96:99], v[172:175], v[12:15]
v_perm_b32 v108, v83, v108, s46
v_perm_b32 v109, v87, v109, s46
v_mfma_f32_16x16x32_bf16 v[16:19], v[100:103], v[160:163], v[16:19]
v_cndmask_b32_dpp v110, v91, v89, vcc row_ror:8 row_mask:0xf bank_mask:0xf
v_cndmask_b32_dpp v111, v95, v93, vcc row_ror:8 row_mask:0xf bank_mask:0xf
v_mfma_f32_16x16x32_bf16 v[20:23], v[100:103], v[164:167], v[20:23]
v_mov_b32_dpp v91, v89 row_ror:8 row_mask:0xf bank_mask:0x3
v_mov_b32_dpp v95, v93 row_ror:8 row_mask:0xf bank_mask:0x3
v_mfma_f32_16x16x32_bf16 v[24:27], v[100:103], v[168:171], v[24:27]
v_perm_b32 v106, v91, v110, s45
v_perm_b32 v107, v95, v111, s45
v_mfma_f32_16x16x32_bf16 v[28:31], v[100:103], v[172:175], v[28:31]
v_perm_b32 v110, v91, v110, s46
v_perm_b32 v111, v95, v111, s46
v_mfma_f32_16x16x32_bf16 v[32:35], v[104:107], v[160:163], v[32:35]
s_add_u32 s56, s3, 15
s_and_b32 s56, s56, 15
s_lshl_b32 s56, s56, 15
s_add_u32 s57, s56, 8192
buffer_load_dwordx4 v[80:83], v252, s[24:27], s56 offen offset:0
buffer_load_dwordx4 v[84:87], v252, s[24:27], s56 offen offset:2048
buffer_load_dwordx4 v[88:91], v252, s[24:27], s57 offen offset:0
buffer_load_dwordx4 v[92:95], v252, s[24:27], s57 offen offset:2048
s_waitcnt vmcnt(31)
v_cndmask_b32_dpp v100, v178, v176, vcc row_ror:8 row_mask:0xf bank_mask:0xf
s_waitcnt vmcnt(30)
v_cndmask_b32_dpp v101, v182, v180, vcc row_ror:8 row_mask:0xf bank_mask:0xf
v_mfma_f32_16x16x32_bf16 v[48:51], v[108:111], v[160:163], v[48:51]
s_add_u32 s54, s3, 8
s_and_b32 s54, s54, 15
s_lshl_b32 s54, s54, 12
v_add_u32 v254, s54, v253
ds_read_b128 v[160:163], v254 offset:0
v_mov_b32_dpp v178, v176 row_ror:8 row_mask:0xf bank_mask:0x3
v_mov_b32_dpp v182, v180 row_ror:8 row_mask:0xf bank_mask:0x3
v_mfma_f32_16x16x32_bf16 v[36:39], v[104:107], v[164:167], v[36:39]
v_perm_b32 v96, v178, v100, s45
v_perm_b32 v97, v182, v101, s45
v_mfma_f32_16x16x32_bf16 v[52:55], v[108:111], v[164:167], v[52:55]
ds_read_b128 v[164:167], v254 offset:1024
v_perm_b32 v100, v178, v100, s46
v_perm_b32 v101, v182, v101, s46
v_mfma_f32_16x16x32_bf16 v[40:43], v[104:107], v[168:171], v[40:43]
s_waitcnt vmcnt(29)
v_cndmask_b32_dpp v102, v186, v184, vcc row_ror:8 row_mask:0xf bank_mask:0xf
s_waitcnt vmcnt(28)
v_cndmask_b32_dpp v103, v190, v188, vcc row_ror:8 row_mask:0xf bank_mask:0xf
v_mfma_f32_16x16x32_bf16 v[56:59], v[108:111], v[168:171], v[56:59]
ds_read_b128 v[168:171], v254 offset:2048
v_mov_b32_dpp v186, v184 row_ror:8 row_mask:0xf bank_mask:0x3
v_mov_b32_dpp v190, v188 row_ror:8 row_mask:0xf bank_mask:0x3
v_mfma_f32_16x16x32_bf16 v[44:47], v[104:107], v[172:175], v[44:47]
v_perm_b32 v98, v186, v102, s45
v_perm_b32 v99, v190, v103, s45
v_mfma_f32_16x16x32_bf16 v[60:63], v[108:111], v[172:175], v[60:63]
ds_read_b128 v[172:175], v254 offset:3072
v_perm_b32 v102, v186, v102, s46
v_perm_b32 v103, v190, v103, s46
s_waitcnt lgkmcnt(3)
v_mfma_f32_16x16x32_bf16 v[0:3], v[96:99], v[160:163], v[0:3]
v_cndmask_b32_dpp v108, v179, v177, vcc row_ror:8 row_mask:0xf bank_mask:0xf
v_cndmask_b32_dpp v109, v183, v181, vcc row_ror:8 row_mask:0xf bank_mask:0xf
s_waitcnt lgkmcnt(2)
v_mfma_f32_16x16x32_bf16 v[4:7], v[96:99], v[164:167], v[4:7]
v_mov_b32_dpp v179, v177 row_ror:8 row_mask:0xf bank_mask:0x3
v_mov_b32_dpp v183, v181 row_ror:8 row_mask:0xf bank_mask:0x3
s_waitcnt lgkmcnt(1)
v_mfma_f32_16x16x32_bf16 v[8:11], v[96:99], v[168:171], v[8:11]
v_perm_b32 v104, v179, v108, s45
v_perm_b32 v105, v183, v109, s45
s_waitcnt lgkmcnt(0)
v_mfma_f32_16x16x32_bf16 v[12:15], v[96:99], v[172:175], v[12:15]
v_perm_b32 v108, v179, v108, s46
v_perm_b32 v109, v183, v109, s46
v_mfma_f32_16x16x32_bf16 v[16:19], v[100:103], v[160:163], v[16:19]
v_cndmask_b32_dpp v110, v187, v185, vcc row_ror:8 row_mask:0xf bank_mask:0xf
v_cndmask_b32_dpp v111, v191, v189, vcc row_ror:8 row_mask:0xf bank_mask:0xf
v_mfma_f32_16x16x32_bf16 v[20:23], v[100:103], v[164:167], v[20:23]
v_mov_b32_dpp v187, v185 row_ror:8 row_mask:0xf bank_mask:0x3
v_mov_b32_dpp v191, v189 row_ror:8 row_mask:0xf bank_mask:0x3
v_mfma_f32_16x16x32_bf16 v[24:27], v[100:103], v[168:171], v[24:27]
v_perm_b32 v106, v187, v110, s45
v_perm_b32 v107, v191, v111, s45
v_mfma_f32_16x16x32_bf16 v[28:31], v[100:103], v[172:175], v[28:31]
v_perm_b32 v110, v187, v110, s46
v_perm_b32 v111, v191, v111, s46
v_mfma_f32_16x16x32_bf16 v[32:35], v[104:107], v[160:163], v[32:35]
s_waitcnt vmcnt(27)
v_cndmask_b32_dpp v100, v194, v192, vcc row_ror:8 row_mask:0xf bank_mask:0xf
s_waitcnt vmcnt(26)
v_cndmask_b32_dpp v101, v198, v196, vcc row_ror:8 row_mask:0xf bank_mask:0xf
v_mfma_f32_16x16x32_bf16 v[48:51], v[108:111], v[160:163], v[48:51]
s_add_u32 s54, s3, 9
s_and_b32 s54, s54, 15
s_lshl_b32 s54, s54, 12
v_add_u32 v254, s54, v253
ds_read_b128 v[160:163], v254 offset:0
v_mov_b32_dpp v194, v192 row_ror:8 row_mask:0xf bank_mask:0x3
v_mov_b32_dpp v198, v196 row_ror:8 row_mask:0xf bank_mask:0x3
v_mfma_f32_16x16x32_bf16 v[36:39], v[104:107], v[164:167], v[36:39]
v_perm_b32 v96, v194, v100, s45
v_perm_b32 v97, v198, v101, s45
v_mfma_f32_16x16x32_bf16 v[52:55], v[108:111], v[164:167], v[52:55]
ds_read_b128 v[164:167], v254 offset:1024
v_perm_b32 v100, v194, v100, s46
v_perm_b32 v101, v198, v101, s46
v_mfma_f32_16x16x32_bf16 v[40:43], v[104:107], v[168:171], v[40:43]
s_waitcnt vmcnt(25)
v_cndmask_b32_dpp v102, v202, v200, vcc row_ror:8 row_mask:0xf bank_mask:0xf
s_waitcnt vmcnt(24)
v_cndmask_b32_dpp v103, v206, v204, vcc row_ror:8 row_mask:0xf bank_mask:0xf
v_mfma_f32_16x16x32_bf16 v[56:59], v[108:111], v[168:171], v[56:59]
ds_read_b128 v[168:171], v254 offset:2048
v_mov_b32_dpp v202, v200 row_ror:8 row_mask:0xf bank_mask:0x3
v_mov_b32_dpp v206, v204 row_ror:8 row_mask:0xf bank_mask:0x3
v_mfma_f32_16x16x32_bf16 v[44:47], v[104:107], v[172:175], v[44:47]
v_perm_b32 v98, v202, v102, s45
v_perm_b32 v99, v206, v103, s45
v_mfma_f32_16x16x32_bf16 v[60:63], v[108:111], v[172:175], v[60:63]
ds_read_b128 v[172:175], v254 offset:3072
v_perm_b32 v102, v202, v102, s46
v_perm_b32 v103, v206, v103, s46
s_waitcnt lgkmcnt(3)
v_mfma_f32_16x16x32_bf16 v[0:3], v[96:99], v[160:163], v[0:3]
v_cndmask_b32_dpp v108, v195, v193, vcc row_ror:8 row_mask:0xf bank_mask:0xf
v_cndmask_b32_dpp v109, v199, v197, vcc row_ror:8 row_mask:0xf bank_mask:0xf
s_waitcnt lgkmcnt(2)
v_mfma_f32_16x16x32_bf16 v[4:7], v[96:99], v[164:167], v[4:7]
v_mov_b32_dpp v195, v193 row_ror:8 row_mask:0xf bank_mask:0x3
v_mov_b32_dpp v199, v197 row_ror:8 row_mask:0xf bank_mask:0x3
s_waitcnt lgkmcnt(1)
v_mfma_f32_16x16x32_bf16 v[8:11], v[96:99], v[168:171], v[8:11]
v_perm_b32 v104, v195, v108, s45
v_perm_b32 v105, v199, v109, s45
s_waitcnt lgkmcnt(0)
v_mfma_f32_16x16x32_bf16 v[12:15], v[96:99], v[172:175], v[12:15]
v_perm_b32 v108, v195, v108, s46
v_perm_b32 v109, v199, v109, s46
v_mfma_f32_16x16x32_bf16 v[16:19], v[100:103], v[160:163], v[16:19]
v_cndmask_b32_dpp v110, v203, v201, vcc row_ror:8 row_mask:0xf bank_mask:0xf
v_cndmask_b32_dpp v111, v207, v205, vcc row_ror:8 row_mask:0xf bank_mask:0xf
v_mfma_f32_16x16x32_bf16 v[20:23], v[100:103], v[164:167], v[20:23]
v_mov_b32_dpp v203, v201 row_ror:8 row_mask:0xf bank_mask:0x3
v_mov_b32_dpp v207, v205 row_ror:8 row_mask:0xf bank_mask:0x3
v_mfma_f32_16x16x32_bf16 v[24:27], v[100:103], v[168:171], v[24:27]
v_perm_b32 v106, v203, v110, s45
v_perm_b32 v107, v207, v111, s45
v_mfma_f32_16x16x32_bf16 v[28:31], v[100:103], v[172:175], v[28:31]
v_perm_b32 v110, v203, v110, s46
v_perm_b32 v111, v207, v111, s46
v_mfma_f32_16x16x32_bf16 v[32:35], v[104:107], v[160:163], v[32:35]
s_waitcnt vmcnt(23)
v_cndmask_b32_dpp v100, v210, v208, vcc row_ror:8 row_mask:0xf bank_mask:0xf
s_waitcnt vmcnt(22)
v_cndmask_b32_dpp v101, v214, v212, vcc row_ror:8 row_mask:0xf bank_mask:0xf
v_mfma_f32_16x16x32_bf16 v[48:51], v[108:111], v[160:163], v[48:51]
s_add_u32 s54, s3, 10
s_and_b32 s54, s54, 15
s_lshl_b32 s54, s54, 12
v_add_u32 v254, s54, v253
ds_read_b128 v[160:163], v254 offset:0
v_mov_b32_dpp v210, v208 row_ror:8 row_mask:0xf bank_mask:0x3
v_mov_b32_dpp v214, v212 row_ror:8 row_mask:0xf bank_mask:0x3
v_mfma_f32_16x16x32_bf16 v[36:39], v[104:107], v[164:167], v[36:39]
v_perm_b32 v96, v210, v100, s45
v_perm_b32 v97, v214, v101, s45
v_mfma_f32_16x16x32_bf16 v[52:55], v[108:111], v[164:167], v[52:55]
ds_read_b128 v[164:167], v254 offset:1024
v_perm_b32 v100, v210, v100, s46
v_perm_b32 v101, v214, v101, s46
v_mfma_f32_16x16x32_bf16 v[40:43], v[104:107], v[168:171], v[40:43]
s_waitcnt vmcnt(21)
v_cndmask_b32_dpp v102, v218, v216, vcc row_ror:8 row_mask:0xf bank_mask:0xf
s_waitcnt vmcnt(20)
v_cndmask_b32_dpp v103, v222, v220, vcc row_ror:8 row_mask:0xf bank_mask:0xf
v_mfma_f32_16x16x32_bf16 v[56:59], v[108:111], v[168:171], v[56:59]
ds_read_b128 v[168:171], v254 offset:2048
v_mov_b32_dpp v218, v216 row_ror:8 row_mask:0xf bank_mask:0x3
v_mov_b32_dpp v222, v220 row_ror:8 row_mask:0xf bank_mask:0x3
v_mfma_f32_16x16x32_bf16 v[44:47], v[104:107], v[172:175], v[44:47]
v_perm_b32 v98, v218, v102, s45
v_perm_b32 v99, v222, v103, s45
v_mfma_f32_16x16x32_bf16 v[60:63], v[108:111], v[172:175], v[60:63]
ds_read_b128 v[172:175], v254 offset:3072
v_perm_b32 v102, v218, v102, s46
v_perm_b32 v103, v222, v103, s46
s_waitcnt lgkmcnt(3)
v_mfma_f32_16x16x32_bf16 v[0:3], v[96:99], v[160:163], v[0:3]
v_cndmask_b32_dpp v108, v211, v209, vcc row_ror:8 row_mask:0xf bank_mask:0xf
v_cndmask_b32_dpp v109, v215, v213, vcc row_ror:8 row_mask:0xf bank_mask:0xf
s_waitcnt lgkmcnt(2)
v_mfma_f32_16x16x32_bf16 v[4:7], v[96:99], v[164:167], v[4:7]
v_mov_b32_dpp v211, v209 row_ror:8 row_mask:0xf bank_mask:0x3
v_mov_b32_dpp v215, v213 row_ror:8 row_mask:0xf bank_mask:0x3
s_waitcnt lgkmcnt(1)
v_mfma_f32_16x16x32_bf16 v[8:11], v[96:99], v[168:171], v[8:11]
v_perm_b32 v104, v211, v108, s45
v_perm_b32 v105, v215, v109, s45
s_waitcnt lgkmcnt(0)
v_mfma_f32_16x16x32_bf16 v[12:15], v[96:99], v[172:175], v[12:15]
v_perm_b32 v108, v211, v108, s46
v_perm_b32 v109, v215, v109, s46
v_mfma_f32_16x16x32_bf16 v[16:19], v[100:103], v[160:163], v[16:19]
v_cndmask_b32_dpp v110, v219, v217, vcc row_ror:8 row_mask:0xf bank_mask:0xf
v_cndmask_b32_dpp v111, v223, v221, vcc row_ror:8 row_mask:0xf bank_mask:0xf
v_mfma_f32_16x16x32_bf16 v[20:23], v[100:103], v[164:167], v[20:23]
v_mov_b32_dpp v219, v217 row_ror:8 row_mask:0xf bank_mask:0x3
v_mov_b32_dpp v223, v221 row_ror:8 row_mask:0xf bank_mask:0x3
v_mfma_f32_16x16x32_bf16 v[24:27], v[100:103], v[168:171], v[24:27]
v_perm_b32 v106, v219, v110, s45
v_perm_b32 v107, v223, v111, s45
v_mfma_f32_16x16x32_bf16 v[28:31], v[100:103], v[172:175], v[28:31]
v_perm_b32 v110, v219, v110, s46
v_perm_b32 v111, v223, v111, s46
v_mfma_f32_16x16x32_bf16 v[32:35], v[104:107], v[160:163], v[32:35]
s_waitcnt vmcnt(19)
v_cndmask_b32_dpp v100, v130, v128, vcc row_ror:8 row_mask:0xf bank_mask:0xf
s_waitcnt vmcnt(18)
v_cndmask_b32_dpp v101, v134, v132, vcc row_ror:8 row_mask:0xf bank_mask:0xf
v_mfma_f32_16x16x32_bf16 v[48:51], v[108:111], v[160:163], v[48:51]
s_add_u32 s54, s3, 11
s_and_b32 s54, s54, 15
s_lshl_b32 s54, s54, 12
v_add_u32 v254, s54, v253
ds_read_b128 v[160:163], v254 offset:0
v_mov_b32_dpp v130, v128 row_ror:8 row_mask:0xf bank_mask:0x3
v_mov_b32_dpp v134, v132 row_ror:8 row_mask:0xf bank_mask:0x3
v_mfma_f32_16x16x32_bf16 v[36:39], v[104:107], v[164:167], v[36:39]
v_perm_b32 v96, v130, v100, s45
v_perm_b32 v97, v134, v101, s45
v_mfma_f32_16x16x32_bf16 v[52:55], v[108:111], v[164:167], v[52:55]
ds_read_b128 v[164:167], v254 offset:1024
v_perm_b32 v100, v130, v100, s46
v_perm_b32 v101, v134, v101, s46
v_mfma_f32_16x16x32_bf16 v[40:43], v[104:107], v[168:171], v[40:43]
s_waitcnt vmcnt(17)
v_cndmask_b32_dpp v102, v138, v136, vcc row_ror:8 row_mask:0xf bank_mask:0xf
s_waitcnt vmcnt(16)
v_cndmask_b32_dpp v103, v142, v140, vcc row_ror:8 row_mask:0xf bank_mask:0xf
v_mfma_f32_16x16x32_bf16 v[56:59], v[108:111], v[168:171], v[56:59]
ds_read_b128 v[168:171], v254 offset:2048
v_mov_b32_dpp v138, v136 row_ror:8 row_mask:0xf bank_mask:0x3
v_mov_b32_dpp v142, v140 row_ror:8 row_mask:0xf bank_mask:0x3
v_mfma_f32_16x16x32_bf16 v[44:47], v[104:107], v[172:175], v[44:47]
v_perm_b32 v98, v138, v102, s45
v_perm_b32 v99, v142, v103, s45
v_mfma_f32_16x16x32_bf16 v[60:63], v[108:111], v[172:175], v[60:63]
ds_read_b128 v[172:175], v254 offset:3072
v_perm_b32 v102, v138, v102, s46
v_perm_b32 v103, v142, v103, s46
s_waitcnt lgkmcnt(3)
v_mfma_f32_16x16x32_bf16 v[0:3], v[96:99], v[160:163], v[0:3]
v_cndmask_b32_dpp v108, v131, v129, vcc row_ror:8 row_mask:0xf bank_mask:0xf
v_cndmask_b32_dpp v109, v135, v133, vcc row_ror:8 row_mask:0xf bank_mask:0xf
s_waitcnt lgkmcnt(2)
v_mfma_f32_16x16x32_bf16 v[4:7], v[96:99], v[164:167], v[4:7]
v_mov_b32_dpp v131, v129 row_ror:8 row_mask:0xf bank_mask:0x3
v_mov_b32_dpp v135, v133 row_ror:8 row_mask:0xf bank_mask:0x3
s_waitcnt lgkmcnt(1)
v_mfma_f32_16x16x32_bf16 v[8:11], v[96:99], v[168:171], v[8:11]
v_perm_b32 v104, v131, v108, s45
v_perm_b32 v105, v135, v109, s45
s_waitcnt lgkmcnt(0)
v_mfma_f32_16x16x32_bf16 v[12:15], v[96:99], v[172:175], v[12:15]
v_perm_b32 v108, v131, v108, s46
v_perm_b32 v109, v135, v109, s46
v_mfma_f32_16x16x32_bf16 v[16:19], v[100:103], v[160:163], v[16:19]
v_cndmask_b32_dpp v110, v139, v137, vcc row_ror:8 row_mask:0xf bank_mask:0xf
v_cndmask_b32_dpp v111, v143, v141, vcc row_ror:8 row_mask:0xf bank_mask:0xf
v_mfma_f32_16x16x32_bf16 v[20:23], v[100:103], v[164:167], v[20:23]
v_mov_b32_dpp v139, v137 row_ror:8 row_mask:0xf bank_mask:0x3
v_mov_b32_dpp v143, v141 row_ror:8 row_mask:0xf bank_mask:0x3
v_mfma_f32_16x16x32_bf16 v[24:27], v[100:103], v[168:171], v[24:27]
v_perm_b32 v106, v139, v110, s45
v_perm_b32 v107, v143, v111, s45
v_mfma_f32_16x16x32_bf16 v[28:31], v[100:103], v[172:175], v[28:31]
v_perm_b32 v110, v139, v110, s46
v_perm_b32 v111, v143, v111, s46
v_mfma_f32_16x16x32_bf16 v[32:35], v[104:107], v[160:163], v[32:35]
s_waitcnt vmcnt(15)
v_cndmask_b32_dpp v100, v146, v144, vcc row_ror:8 row_mask:0xf bank_mask:0xf
s_waitcnt vmcnt(14)
v_cndmask_b32_dpp v101, v150, v148, vcc row_ror:8 row_mask:0xf bank_mask:0xf
v_mfma_f32_16x16x32_bf16 v[48:51], v[108:111], v[160:163], v[48:51]
s_add_u32 s54, s3, 12
s_and_b32 s54, s54, 15
s_lshl_b32 s54, s54, 12
v_add_u32 v254, s54, v253
ds_read_b128 v[160:163], v254 offset:0
v_mov_b32_dpp v146, v144 row_ror:8 row_mask:0xf bank_mask:0x3
v_mov_b32_dpp v150, v148 row_ror:8 row_mask:0xf bank_mask:0x3
v_mfma_f32_16x16x32_bf16 v[36:39], v[104:107], v[164:167], v[36:39]
v_perm_b32 v96, v146, v100, s45
v_perm_b32 v97, v150, v101, s45
v_mfma_f32_16x16x32_bf16 v[52:55], v[108:111], v[164:167], v[52:55]
ds_read_b128 v[164:167], v254 offset:1024
v_perm_b32 v100, v146, v100, s46
v_perm_b32 v101, v150, v101, s46
v_mfma_f32_16x16x32_bf16 v[40:43], v[104:107], v[168:171], v[40:43]
s_waitcnt vmcnt(13)
v_cndmask_b32_dpp v102, v154, v152, vcc row_ror:8 row_mask:0xf bank_mask:0xf
s_waitcnt vmcnt(12)
v_cndmask_b32_dpp v103, v158, v156, vcc row_ror:8 row_mask:0xf bank_mask:0xf
v_mfma_f32_16x16x32_bf16 v[56:59], v[108:111], v[168:171], v[56:59]
ds_read_b128 v[168:171], v254 offset:2048
v_mov_b32_dpp v154, v152 row_ror:8 row_mask:0xf bank_mask:0x3
v_mov_b32_dpp v158, v156 row_ror:8 row_mask:0xf bank_mask:0x3
v_mfma_f32_16x16x32_bf16 v[44:47], v[104:107], v[172:175], v[44:47]
v_perm_b32 v98, v154, v102, s45
v_perm_b32 v99, v158, v103, s45
v_mfma_f32_16x16x32_bf16 v[60:63], v[108:111], v[172:175], v[60:63]
ds_read_b128 v[172:175], v254 offset:3072
v_perm_b32 v102, v154, v102, s46
v_perm_b32 v103, v158, v103, s46
s_waitcnt lgkmcnt(3)
v_mfma_f32_16x16x32_bf16 v[0:3], v[96:99], v[160:163], v[0:3]
v_cndmask_b32_dpp v108, v147, v145, vcc row_ror:8 row_mask:0xf bank_mask:0xf
v_cndmask_b32_dpp v109, v151, v149, vcc row_ror:8 row_mask:0xf bank_mask:0xf
s_waitcnt lgkmcnt(2)
v_mfma_f32_16x16x32_bf16 v[4:7], v[96:99], v[164:167], v[4:7]
v_mov_b32_dpp v147, v145 row_ror:8 row_mask:0xf bank_mask:0x3
v_mov_b32_dpp v151, v149 row_ror:8 row_mask:0xf bank_mask:0x3
s_waitcnt lgkmcnt(1)
v_mfma_f32_16x16x32_bf16 v[8:11], v[96:99], v[168:171], v[8:11]
v_perm_b32 v104, v147, v108, s45
v_perm_b32 v105, v151, v109, s45
s_waitcnt lgkmcnt(0)
v_mfma_f32_16x16x32_bf16 v[12:15], v[96:99], v[172:175], v[12:15]
v_perm_b32 v108, v147, v108, s46
v_perm_b32 v109, v151, v109, s46
v_mfma_f32_16x16x32_bf16 v[16:19], v[100:103], v[160:163], v[16:19]
v_cndmask_b32_dpp v110, v155, v153, vcc row_ror:8 row_mask:0xf bank_mask:0xf
v_cndmask_b32_dpp v111, v159, v157, vcc row_ror:8 row_mask:0xf bank_mask:0xf
v_mfma_f32_16x16x32_bf16 v[20:23], v[100:103], v[164:167], v[20:23]
v_mov_b32_dpp v155, v153 row_ror:8 row_mask:0xf bank_mask:0x3
v_mov_b32_dpp v159, v157 row_ror:8 row_mask:0xf bank_mask:0x3
v_mfma_f32_16x16x32_bf16 v[24:27], v[100:103], v[168:171], v[24:27]
v_perm_b32 v106, v155, v110, s45
v_perm_b32 v107, v159, v111, s45
v_mfma_f32_16x16x32_bf16 v[28:31], v[100:103], v[172:175], v[28:31]
v_perm_b32 v110, v155, v110, s46
v_perm_b32 v111, v159, v111, s46
v_mfma_f32_16x16x32_bf16 v[32:35], v[104:107], v[160:163], v[32:35]
s_waitcnt vmcnt(11)
v_cndmask_b32_dpp v100, v114, v112, vcc row_ror:8 row_mask:0xf bank_mask:0xf
s_waitcnt vmcnt(10)
v_cndmask_b32_dpp v101, v118, v116, vcc row_ror:8 row_mask:0xf bank_mask:0xf
v_mfma_f32_16x16x32_bf16 v[48:51], v[108:111], v[160:163], v[48:51]
s_add_u32 s54, s3, 13
s_and_b32 s54, s54, 15
s_lshl_b32 s54, s54, 12
v_add_u32 v254, s54, v253
ds_read_b128 v[160:163], v254 offset:0
v_mov_b32_dpp v114, v112 row_ror:8 row_mask:0xf bank_mask:0x3
v_mov_b32_dpp v118, v116 row_ror:8 row_mask:0xf bank_mask:0x3
v_mfma_f32_16x16x32_bf16 v[36:39], v[104:107], v[164:167], v[36:39]
v_perm_b32 v96, v114, v100, s45
v_perm_b32 v97, v118, v101, s45
v_mfma_f32_16x16x32_bf16 v[52:55], v[108:111], v[164:167], v[52:55]
ds_read_b128 v[164:167], v254 offset:1024
v_perm_b32 v100, v114, v100, s46
v_perm_b32 v101, v118, v101, s46
v_mfma_f32_16x16x32_bf16 v[40:43], v[104:107], v[168:171], v[40:43]
s_waitcnt vmcnt(9)
v_cndmask_b32_dpp v102, v122, v120, vcc row_ror:8 row_mask:0xf bank_mask:0xf
s_waitcnt vmcnt(8)
v_cndmask_b32_dpp v103, v126, v124, vcc row_ror:8 row_mask:0xf bank_mask:0xf
v_mfma_f32_16x16x32_bf16 v[56:59], v[108:111], v[168:171], v[56:59]
ds_read_b128 v[168:171], v254 offset:2048
v_mov_b32_dpp v122, v120 row_ror:8 row_mask:0xf bank_mask:0x3
v_mov_b32_dpp v126, v124 row_ror:8 row_mask:0xf bank_mask:0x3
v_mfma_f32_16x16x32_bf16 v[44:47], v[104:107], v[172:175], v[44:47]
v_perm_b32 v98, v122, v102, s45
v_perm_b32 v99, v126, v103, s45
v_mfma_f32_16x16x32_bf16 v[60:63], v[108:111], v[172:175], v[60:63]
ds_read_b128 v[172:175], v254 offset:3072
v_perm_b32 v102, v122, v102, s46
v_perm_b32 v103, v126, v103, s46
s_waitcnt lgkmcnt(3)
v_mfma_f32_16x16x32_bf16 v[0:3], v[96:99], v[160:163], v[0:3]
v_cndmask_b32_dpp v108, v115, v113, vcc row_ror:8 row_mask:0xf bank_mask:0xf
v_cndmask_b32_dpp v109, v119, v117, vcc row_ror:8 row_mask:0xf bank_mask:0xf
s_waitcnt lgkmcnt(2)
v_mfma_f32_16x16x32_bf16 v[4:7], v[96:99], v[164:167], v[4:7]
v_mov_b32_dpp v115, v113 row_ror:8 row_mask:0xf bank_mask:0x3
v_mov_b32_dpp v119, v117 row_ror:8 row_mask:0xf bank_mask:0x3
s_waitcnt lgkmcnt(1)
v_mfma_f32_16x16x32_bf16 v[8:11], v[96:99], v[168:171], v[8:11]
v_perm_b32 v104, v115, v108, s45
v_perm_b32 v105, v119, v109, s45
s_waitcnt lgkmcnt(0)
v_mfma_f32_16x16x32_bf16 v[12:15], v[96:99], v[172:175], v[12:15]
v_perm_b32 v108, v115, v108, s46
v_perm_b32 v109, v119, v109, s46
v_mfma_f32_16x16x32_bf16 v[16:19], v[100:103], v[160:163], v[16:19]
v_cndmask_b32_dpp v110, v123, v121, vcc row_ror:8 row_mask:0xf bank_mask:0xf
v_cndmask_b32_dpp v111, v127, v125, vcc row_ror:8 row_mask:0xf bank_mask:0xf
v_mfma_f32_16x16x32_bf16 v[20:23], v[100:103], v[164:167], v[20:23]
v_mov_b32_dpp v123, v121 row_ror:8 row_mask:0xf bank_mask:0x3
v_mov_b32_dpp v127, v125 row_ror:8 row_mask:0xf bank_mask:0x3
v_mfma_f32_16x16x32_bf16 v[24:27], v[100:103], v[168:171], v[24:27]
v_perm_b32 v106, v123, v110, s45
v_perm_b32 v107, v127, v111, s45
v_mfma_f32_16x16x32_bf16 v[28:31], v[100:103], v[172:175], v[28:31]
v_perm_b32 v110, v123, v110, s46
v_perm_b32 v111, v127, v111, s46
v_mfma_f32_16x16x32_bf16 v[32:35], v[104:107], v[160:163], v[32:35]
s_waitcnt vmcnt(7)
v_cndmask_b32_dpp v100, v66, v64, vcc row_ror:8 row_mask:0xf bank_mask:0xf
s_waitcnt vmcnt(6)
v_cndmask_b32_dpp v101, v70, v68, vcc row_ror:8 row_mask:0xf bank_mask:0xf
v_mfma_f32_16x16x32_bf16 v[48:51], v[108:111], v[160:163], v[48:51]
s_add_u32 s54, s3, 14
s_and_b32 s54, s54, 15
s_lshl_b32 s54, s54, 12
v_add_u32 v254, s54, v253
ds_read_b128 v[160:163], v254 offset:0
v_mov_b32_dpp v66, v64 row_ror:8 row_mask:0xf bank_mask:0x3
v_mov_b32_dpp v70, v68 row_ror:8 row_mask:0xf bank_mask:0x3
v_mfma_f32_16x16x32_bf16 v[36:39], v[104:107], v[164:167], v[36:39]
v_perm_b32 v96, v66, v100, s45
v_perm_b32 v97, v70, v101, s45
v_mfma_f32_16x16x32_bf16 v[52:55], v[108:111], v[164:167], v[52:55]
ds_read_b128 v[164:167], v254 offset:1024
v_perm_b32 v100, v66, v100, s46
v_perm_b32 v101, v70, v101, s46
v_mfma_f32_16x16x32_bf16 v[40:43], v[104:107], v[168:171], v[40:43]
s_waitcnt vmcnt(5)
v_cndmask_b32_dpp v102, v74, v72, vcc row_ror:8 row_mask:0xf bank_mask:0xf
s_waitcnt vmcnt(4)
v_cndmask_b32_dpp v103, v78, v76, vcc row_ror:8 row_mask:0xf bank_mask:0xf
v_mfma_f32_16x16x32_bf16 v[56:59], v[108:111], v[168:171], v[56:59]
ds_read_b128 v[168:171], v254 offset:2048
v_mov_b32_dpp v74, v72 row_ror:8 row_mask:0xf bank_mask:0x3
v_mov_b32_dpp v78, v76 row_ror:8 row_mask:0xf bank_mask:0x3
v_mfma_f32_16x16x32_bf16 v[44:47], v[104:107], v[172:175], v[44:47]
v_perm_b32 v98, v74, v102, s45
v_perm_b32 v99, v78, v103, s45
v_mfma_f32_16x16x32_bf16 v[60:63], v[108:111], v[172:175], v[60:63]
ds_read_b128 v[172:175], v254 offset:3072
v_perm_b32 v102, v74, v102, s46
v_perm_b32 v103, v78, v103, s46
s_waitcnt lgkmcnt(3)
v_mfma_f32_16x16x32_bf16 v[0:3], v[96:99], v[160:163], v[0:3]
v_cndmask_b32_dpp v108, v67, v65, vcc row_ror:8 row_mask:0xf bank_mask:0xf
v_cndmask_b32_dpp v109, v71, v69, vcc row_ror:8 row_mask:0xf bank_mask:0xf
s_waitcnt lgkmcnt(2)
v_mfma_f32_16x16x32_bf16 v[4:7], v[96:99], v[164:167], v[4:7]
v_mov_b32_dpp v67, v65 row_ror:8 row_mask:0xf bank_mask:0x3
v_mov_b32_dpp v71, v69 row_ror:8 row_mask:0xf bank_mask:0x3
s_waitcnt lgkmcnt(1)
v_mfma_f32_16x16x32_bf16 v[8:11], v[96:99], v[168:171], v[8:11]
v_perm_b32 v104, v67, v108, s45
v_perm_b32 v105, v71, v109, s45
s_waitcnt lgkmcnt(0)
v_mfma_f32_16x16x32_bf16 v[12:15], v[96:99], v[172:175], v[12:15]
v_perm_b32 v108, v67, v108, s46
v_perm_b32 v109, v71, v109, s46
v_mfma_f32_16x16x32_bf16 v[16:19], v[100:103], v[160:163], v[16:19]
v_cndmask_b32_dpp v110, v75, v73, vcc row_ror:8 row_mask:0xf bank_mask:0xf
v_cndmask_b32_dpp v111, v79, v77, vcc row_ror:8 row_mask:0xf bank_mask:0xf
v_mfma_f32_16x16x32_bf16 v[20:23], v[100:103], v[164:167], v[20:23]
v_mov_b32_dpp v75, v73 row_ror:8 row_mask:0xf bank_mask:0x3
v_mov_b32_dpp v79, v77 row_ror:8 row_mask:0xf bank_mask:0x3
v_mfma_f32_16x16x32_bf16 v[24:27], v[100:103], v[168:171], v[24:27]
v_perm_b32 v106, v75, v110, s45
v_perm_b32 v107, v79, v111, s45
v_mfma_f32_16x16x32_bf16 v[28:31], v[100:103], v[172:175], v[28:31]
v_perm_b32 v110, v75, v110, s46
v_perm_b32 v111, v79, v111, s46
v_mfma_f32_16x16x32_bf16 v[32:35], v[104:107], v[160:163], v[32:35]
s_waitcnt vmcnt(3)
v_cndmask_b32_dpp v100, v82, v80, vcc row_ror:8 row_mask:0xf bank_mask:0xf
s_waitcnt vmcnt(2)
v_cndmask_b32_dpp v101, v86, v84, vcc row_ror:8 row_mask:0xf bank_mask:0xf
v_mfma_f32_16x16x32_bf16 v[48:51], v[108:111], v[160:163], v[48:51]
s_add_u32 s54, s3, 15
s_and_b32 s54, s54, 15
s_lshl_b32 s54, s54, 12
v_add_u32 v254, s54, v253
ds_read_b128 v[160:163], v254 offset:0
v_mov_b32_dpp v82, v80 row_ror:8 row_mask:0xf bank_mask:0x3
v_mov_b32_dpp v86, v84 row_ror:8 row_mask:0xf bank_mask:0x3
v_mfma_f32_16x16x32_bf16 v[36:39], v[104:107], v[164:167], v[36:39]
v_perm_b32 v96, v82, v100, s45
v_perm_b32 v97, v86, v101, s45
v_mfma_f32_16x16x32_bf16 v[52:55], v[108:111], v[164:167], v[52:55]
ds_read_b128 v[164:167], v254 offset:1024
v_perm_b32 v100, v82, v100, s46
v_perm_b32 v101, v86, v101, s46
v_mfma_f32_16x16x32_bf16 v[40:43], v[104:107], v[168:171], v[40:43]
s_waitcnt vmcnt(1)
v_cndmask_b32_dpp v102, v90, v88, vcc row_ror:8 row_mask:0xf bank_mask:0xf
s_waitcnt vmcnt(0)
v_cndmask_b32_dpp v103, v94, v92, vcc row_ror:8 row_mask:0xf bank_mask:0xf
v_mfma_f32_16x16x32_bf16 v[56:59], v[108:111], v[168:171], v[56:59]
ds_read_b128 v[168:171], v254 offset:2048
v_mov_b32_dpp v90, v88 row_ror:8 row_mask:0xf bank_mask:0x3
v_mov_b32_dpp v94, v92 row_ror:8 row_mask:0xf bank_mask:0x3
v_mfma_f32_16x16x32_bf16 v[44:47], v[104:107], v[172:175], v[44:47]
v_perm_b32 v98, v90, v102, s45
v_perm_b32 v99, v94, v103, s45
v_mfma_f32_16x16x32_bf16 v[60:63], v[108:111], v[172:175], v[60:63]
ds_read_b128 v[172:175], v254 offset:3072
v_perm_b32 v102, v90, v102, s46
v_perm_b32 v103, v94, v103, s46
s_waitcnt lgkmcnt(3)
v_mfma_f32_16x16x32_bf16 v[0:3], v[96:99], v[160:163], v[0:3]
v_cndmask_b32_dpp v108, v83, v81, vcc row_ror:8 row_mask:0xf bank_mask:0xf
v_cndmask_b32_dpp v109, v87, v85, vcc row_ror:8 row_mask:0xf bank_mask:0xf
s_waitcnt lgkmcnt(2)
v_mfma_f32_16x16x32_bf16 v[4:7], v[96:99], v[164:167], v[4:7]
v_mov_b32_dpp v83, v81 row_ror:8 row_mask:0xf bank_mask:0x3
v_mov_b32_dpp v87, v85 row_ror:8 row_mask:0xf bank_mask:0x3
s_waitcnt lgkmcnt(1)
v_mfma_f32_16x16x32_bf16 v[8:11], v[96:99], v[168:171], v[8:11]
v_perm_b32 v104, v83, v108, s45
v_perm_b32 v105, v87, v109, s45
s_waitcnt lgkmcnt(0)
v_mfma_f32_16x16x32_bf16 v[12:15], v[96:99], v[172:175], v[12:15]
v_perm_b32 v108, v83, v108, s46
v_perm_b32 v109, v87, v109, s46
v_mfma_f32_16x16x32_bf16 v[16:19], v[100:103], v[160:163], v[16:19]
v_cndmask_b32_dpp v110, v91, v89, vcc row_ror:8 row_mask:0xf bank_mask:0xf
v_cndmask_b32_dpp v111, v95, v93, vcc row_ror:8 row_mask:0xf bank_mask:0xf
v_mfma_f32_16x16x32_bf16 v[20:23], v[100:103], v[164:167], v[20:23]
v_mov_b32_dpp v91, v89 row_ror:8 row_mask:0xf bank_mask:0x3
v_mov_b32_dpp v95, v93 row_ror:8 row_mask:0xf bank_mask:0x3
v_mfma_f32_16x16x32_bf16 v[24:27], v[100:103], v[168:171], v[24:27]
v_perm_b32 v106, v91, v110, s45
v_perm_b32 v107, v95, v111, s45
v_mfma_f32_16x16x32_bf16 v[28:31], v[100:103], v[172:175], v[28:31]
v_perm_b32 v110, v91, v110, s46
v_perm_b32 v111, v95, v111, s46
v_mfma_f32_16x16x32_bf16 v[32:35], v[104:107], v[160:163], v[32:35]
s_nop 0
v_mfma_f32_16x16x32_bf16 v[48:51], v[108:111], v[160:163], v[48:51]
v_mfma_f32_16x16x32_bf16 v[36:39], v[104:107], v[164:167], v[36:39]
v_mfma_f32_16x16x32_bf16 v[52:55], v[108:111], v[164:167], v[52:55]
v_mfma_f32_16x16x32_bf16 v[40:43], v[104:107], v[168:171], v[40:43]
v_mfma_f32_16x16x32_bf16 v[56:59], v[108:111], v[168:171], v[56:59]
v_mfma_f32_16x16x32_bf16 v[44:47], v[104:107], v[172:175], v[44:47]
v_mfma_f32_16x16x32_bf16 v[60:63], v[108:111], v[172:175], v[60:63]
v_cvt_pk_bf16_f32 v64, v0, v16
s_nop 0
v_cvt_pk_bf16_f32 v65, v32, v48
v_cvt_pk_bf16_f32 v66, v1, v17
v_cvt_pk_bf16_f32 v67, v33, v49
s_add_u32 s52, s62, 0
buffer_store_dwordx4 v[64:67], v236, s[28:31], s52 offen offset:0 sc1
v_cvt_pk_bf16_f32 v68, v2, v18
v_cvt_pk_bf16_f32 v69, v34, v50
v_cvt_pk_bf16_f32 v70, v3, v19
v_cvt_pk_bf16_f32 v71, v35, v51
buffer_store_dwordx4 v[68:71], v236, s[28:31], s52 offen offset:256 sc1
v_cvt_pk_bf16_f32 v72, v4, v20
v_cvt_pk_bf16_f32 v73, v36, v52
v_cvt_pk_bf16_f32 v74, v5, v21
v_cvt_pk_bf16_f32 v75, v37, v53
s_add_u32 s52, s62, 2048
buffer_store_dwordx4 v[72:75], v236, s[28:31], s52 offen offset:0 sc1
v_cvt_pk_bf16_f32 v76, v6, v22
v_cvt_pk_bf16_f32 v77, v38, v54
v_cvt_pk_bf16_f32 v78, v7, v23
v_cvt_pk_bf16_f32 v79, v39, v55
buffer_store_dwordx4 v[76:79], v236, s[28:31], s52 offen offset:256 sc1
v_cvt_pk_bf16_f32 v80, v8, v24
v_cvt_pk_bf16_f32 v81, v40, v56
v_cvt_pk_bf16_f32 v82, v9, v25
v_cvt_pk_bf16_f32 v83, v41, v57
s_add_u32 s52, s62, 4096
buffer_store_dwordx4 v[80:83], v236, s[28:31], s52 offen offset:0 sc1
v_cvt_pk_bf16_f32 v84, v10, v26
v_cvt_pk_bf16_f32 v85, v42, v58
v_cvt_pk_bf16_f32 v86, v11, v27
v_cvt_pk_bf16_f32 v87, v43, v59
buffer_store_dwordx4 v[84:87], v236, s[28:31], s52 offen offset:256 sc1
v_cvt_pk_bf16_f32 v88, v12, v28
v_cvt_pk_bf16_f32 v89, v44, v60
v_cvt_pk_bf16_f32 v90, v13, v29
v_cvt_pk_bf16_f32 v91, v45, v61
s_add_u32 s52, s62, 6144
buffer_store_dwordx4 v[88:91], v236, s[28:31], s52 offen offset:0 sc1
v_cvt_pk_bf16_f32 v92, v14, v30
v_cvt_pk_bf16_f32 v93, v46, v62
v_cvt_pk_bf16_f32 v94, v15, v31
v_cvt_pk_bf16_f32 v95, v47, v63
buffer_store_dwordx4 v[92:95], v236, s[28:31], s52 offen offset:256 sc1
s_lshl_b32 s52, s51, 11
s_lshr_b32 s53, s50, 2
s_add_u32 s52, s52, s53
s_add_u32 s52, s52, 16777216
s_lshl_b32 s53, s41, 2
s_add_u32 s52, s52, s53
v_min_u32 v51, 1, v255
v_lshlrev_b32 v51, 30, v51
v_mov_b32 v50, 1
s_waitcnt vmcnt(0)
buffer_store_dword v50, v51, s[28:31], s52 offen sc1
s_lshl_b32 s57, s51, 11
s_lshr_b32 s53, s50, 2
s_add_u32 s57, s57, s53
s_add_u32 s57, s57, 16777216
s_lshl_b32 s52, s51, 19
s_lshl_b32 s53, s41, 10
s_add_u32 s52, s52, s53
s_lshl_b32 s53, s40, 13
s_add_u32 s52, s52, s53
s_add_u32 s53, s52, 4096
v_and_b32 v48, 7, v255
v_lshlrev_b32 v48, 11, v48
v_bfe_u32 v49, v255, 3, 1
v_lshl_add_u32 v48, v49, 6, v48
v_bfe_u32 v49, v255, 4, 1
v_lshl_add_u32 v48, v49, 5, v48
v_lshrrev_b32 v49, 5, v255
v_lshl_add_u32 v48, v49, 4, v48
s_lshl_b32 s54, s43, 17
s_lshl_b32 s55, s41, 14
s_add_u32 s54, s54, s55
s_lshl_b32 s55, s42, 10
s_add_u32 s54, s54, s55
s_lshr_b32 s55, s50, 3
s_add_u32 s54, s54, s55
s_mov_b32 s56, 1048576
v_and_b32 v51, 7, v255
v_lshlrev_b32 v51, 2, v51
L_poll:
buffer_load_dword v50, v51, s[28:31], s57 offen sc1
s_sub_u32 s56, s56, 1
s_cbranch_scc1 L_pollx
s_waitcnt vmcnt(0)
v_cmp_ne_u32 vcc, 1, v50
s_nop 0
s_cbranch_vccz L_pollx
s_sleep 2
s_branch L_poll
L_pollx:
buffer_load_dwordx4 v[0:3], v253, s[28:31], s52 offen sc1
s_add_u32 s52, s52, 65536
buffer_load_dwordx4 v[4:7], v253, s[28:31], s52 offen sc1
s_add_u32 s52, s52, 65536
buffer_load_dwordx4 v[8:11], v253, s[28:31], s52 offen sc1
s_add_u32 s52, s52, 65536
buffer_load_dwordx4 v[12:15], v253, s[28:31], s52 offen sc1
s_add_u32 s52, s52, 65536
buffer_load_dwordx4 v[16:19], v253, s[28:31], s52 offen sc1
s_add_u32 s52, s52, 65536
buffer_load_dwordx4 v[20:23], v253, s[28:31], s52 offen sc1
s_add_u32 s52, s52, 65536
buffer_load_dwordx4 v[24:27], v253, s[28:31], s52 offen sc1
s_add_u32 s52, s52, 65536
buffer_load_dwordx4 v[28:31], v253, s[28:31], s52 offen sc1
s_waitcnt vmcnt(7)
v_lshlrev_b32 v32, 16, v0
v_and_b32 v33, 0xffff0000, v0
v_lshlrev_b32 v34, 16, v1
v_and_b32 v35, 0xffff0000, v1
v_lshlrev_b32 v36, 16, v2
v_and_b32 v37, 0xffff0000, v2
v_lshlrev_b32 v38, 16, v3
v_and_b32 v39, 0xffff0000, v3
s_waitcnt vmcnt(6)
v_dot2c_f32_bf16 v32, s58, v4
v_dot2c_f32_bf16 v33, s59, v4
v_dot2c_f32_bf16 v34, s58, v5
v_dot2c_f32_bf16 v35, s59, v5
v_dot2c_f32_bf16 v36, s58, v6
v_dot2c_f32_bf16 v37, s59, v6
v_dot2c_f32_bf16 v38, s58, v7
v_dot2c_f32_bf16 v39, s59, v7
s_waitcnt vmcnt(5)
v_dot2c_f32_bf16 v32, s58, v8
v_dot2c_f32_bf16 v33, s59, v8
v_dot2c_f32_bf16 v34, s58, v9
v_dot2c_f32_bf16 v35, s59, v9
v_dot2c_f32_bf16 v36, s58, v10
v_dot2c_f32_bf16 v37, s59, v10
v_dot2c_f32_bf16 v38, s58, v11
v_dot2c_f32_bf16 v39, s59, v11
s_waitcnt vmcnt(4)
v_dot2c_f32_bf16 v32, s58, v12
v_dot2c_f32_bf16 v33, s59, v12
v_dot2c_f32_bf16 v34, s58, v13
v_dot2c_f32_bf16 v35, s59, v13
v_dot2c_f32_bf16 v36, s58, v14
v_dot2c_f32_bf16 v37, s59, v14
v_dot2c_f32_bf16 v38, s58, v15
v_dot2c_f32_bf16 v39, s59, v15
s_waitcnt vmcnt(3)
v_dot2c_f32_bf16 v32, s58, v16
v_dot2c_f32_bf16 v33, s59, v16
v_dot2c_f32_bf16 v34, s58, v17
v_dot2c_f32_bf16 v35, s59, v17
v_dot2c_f32_bf16 v36, s58, v18
v_dot2c_f32_bf16 v37, s59, v18
v_dot2c_f32_bf16 v38, s58, v19
v_dot2c_f32_bf16 v39, s59, v19
s_waitcnt vmcnt(2)
v_dot2c_f32_bf16 v32, s58, v20
v_dot2c_f32_bf16 v33, s59, v20
v_dot2c_f32_bf16 v34, s58, v21
v_dot2c_f32_bf16 v35, s59, v21
v_dot2c_f32_bf16 v36, s58, v22
v_dot2c_f32_bf16 v37, s59, v22
v_dot2c_f32_bf16 v38, s58, v23
v_dot2c_f32_bf16 v39, s59, v23
s_waitcnt vmcnt(1)
v_dot2c_f32_bf16 v32, s58, v24
v_dot2c_f32_bf16 v33, s59, v24
v_dot2c_f32_bf16 v34, s58, v25
v_dot2c_f32_bf16 v35, s59, v25
v_dot2c_f32_bf16 v36, s58, v26
v_dot2c_f32_bf16 v37, s59, v26
v_dot2c_f32_bf16 v38, s58, v27
v_dot2c_f32_bf16 v39, s59, v27
s_waitcnt vmcnt(0)
v_dot2c_f32_bf16 v32, s58, v28
v_dot2c_f32_bf16 v33, s59, v28
v_dot2c_f32_bf16 v34, s58, v29
v_dot2c_f32_bf16 v35, s59, v29
v_dot2c_f32_bf16 v36, s58, v30
v_dot2c_f32_bf16 v37, s59, v30
v_dot2c_f32_bf16 v38, s58, v31
v_dot2c_f32_bf16 v39, s59, v31
v_cvt_pk_bf16_f32 v40, v32, v33
v_cvt_pk_bf16_f32 v41, v34, v35
v_cvt_pk_bf16_f32 v42, v36, v37
v_cvt_pk_bf16_f32 v43, v38, v39
s_nop 0
v_permlane32_swap_b32 v40, v42
v_permlane32_swap_b32 v41, v43
buffer_store_dwordx4 v[40:43], v48, s[32:35], s54 offen sc0 sc1
s_endpgm
FIX_0:
s_nop 15
v_max3_f32 v232, v160, v161, v162
v_max3_f32 v232, v232, v163, v164
v_max3_f32 v232, v232, v165, v166
v_max3_f32 v232, v232, v167, v168
v_max3_f32 v232, v232, v169, v170
v_max3_f32 v232, v232, v171, v172
v_max3_f32 v232, v232, v173, v174
v_max_f32 v232, v232, v175
v_mov_b32 v233, v232
s_nop 1
v_permlane32_swap_b32 v232, v233
v_max_f32 v232, v232, v233
v_max_f32 v232, 0, v232
v_exp_f32 v233, -v232
v_sub_f32 v160, v160, v232
v_sub_f32 v161, v161, v232
v_sub_f32 v162, v162, v232
v_sub_f32 v163, v163, v232
v_sub_f32 v164, v164, v232
v_sub_f32 v165, v165, v232
v_sub_f32 v166, v166, v232
v_sub_f32 v167, v167, v232
v_sub_f32 v168, v168, v232
v_sub_f32 v169, v169, v232
v_sub_f32 v170, v170, v232
v_sub_f32 v171, v171, v232
v_sub_f32 v172, v172, v232
v_sub_f32 v173, v173, v232
v_sub_f32 v174, v174, v232
v_sub_f32 v175, v175, v232
v_sub_f32 v96, v96, v232
v_sub_f32 v97, v97, v232
v_sub_f32 v98, v98, v232
v_sub_f32 v99, v99, v232
v_sub_f32 v100, v100, v232
v_sub_f32 v101, v101, v232
v_sub_f32 v102, v102, v232
v_sub_f32 v103, v103, v232
v_sub_f32 v104, v104, v232
v_sub_f32 v105, v105, v232
v_sub_f32 v106, v106, v232
v_sub_f32 v107, v107, v232
v_sub_f32 v108, v108, v232
v_sub_f32 v109, v109, v232
v_sub_f32 v110, v110, v232
v_sub_f32 v111, v111, v232
v_sub_f32 v112, v112, v232
v_sub_f32 v113, v113, v232
v_sub_f32 v114, v114, v232
v_sub_f32 v115, v115, v232
v_sub_f32 v116, v116, v232
v_sub_f32 v117, v117, v232
v_sub_f32 v118, v118, v232
v_sub_f32 v119, v119, v232
v_sub_f32 v120, v120, v232
v_sub_f32 v121, v121, v232
v_sub_f32 v122, v122, v232
v_sub_f32 v123, v123, v232
v_sub_f32 v124, v124, v232
v_sub_f32 v125, v125, v232
v_sub_f32 v126, v126, v232
v_sub_f32 v127, v127, v232
v_mul_f32 v0, v0, v233
v_mul_f32 v1, v1, v233
v_mul_f32 v2, v2, v233
v_mul_f32 v3, v3, v233
v_mul_f32 v4, v4, v233
v_mul_f32 v5, v5, v233
v_mul_f32 v6, v6, v233
v_mul_f32 v7, v7, v233
v_mul_f32 v8, v8, v233
v_mul_f32 v9, v9, v233
v_mul_f32 v10, v10, v233
v_mul_f32 v11, v11, v233
v_mul_f32 v12, v12, v233
v_mul_f32 v13, v13, v233
v_mul_f32 v14, v14, v233
v_mul_f32 v15, v15, v233
v_mul_f32 v16, v16, v233
v_mul_f32 v17, v17, v233
v_mul_f32 v18, v18, v233
v_mul_f32 v19, v19, v233
v_mul_f32 v20, v20, v233
v_mul_f32 v21, v21, v233
v_mul_f32 v22, v22, v233
v_mul_f32 v23, v23, v233
v_mul_f32 v24, v24, v233
v_mul_f32 v25, v25, v233
v_mul_f32 v26, v26, v233
v_mul_f32 v27, v27, v233
v_mul_f32 v28, v28, v233
v_mul_f32 v29, v29, v233
v_mul_f32 v30, v30, v233
v_mul_f32 v31, v31, v233
v_mul_f32 v32, v32, v233
v_mul_f32 v33, v33, v233
v_mul_f32 v34, v34, v233
v_mul_f32 v35, v35, v233
v_mul_f32 v36, v36, v233
v_mul_f32 v37, v37, v233
v_mul_f32 v38, v38, v233
v_mul_f32 v39, v39, v233
v_mul_f32 v40, v40, v233
v_mul_f32 v41, v41, v233
v_mul_f32 v42, v42, v233
v_mul_f32 v43, v43, v233
v_mul_f32 v44, v44, v233
v_mul_f32 v45, v45, v233
v_mul_f32 v46, v46, v233
v_mul_f32 v47, v47, v233
v_mul_f32 v48, v48, v233
v_mul_f32 v49, v49, v233
v_mul_f32 v50, v50, v233
v_mul_f32 v51, v51, v233
v_mul_f32 v52, v52, v233
v_mul_f32 v53, v53, v233
v_mul_f32 v54, v54, v233
v_mul_f32 v55, v55, v233
v_mul_f32 v56, v56, v233
v_mul_f32 v57, v57, v233
v_mul_f32 v58, v58, v233
v_mul_f32 v59, v59, v233
v_mul_f32 v60, v60, v233
v_mul_f32 v61, v61, v233
v_mul_f32 v62, v62, v233
v_mul_f32 v63, v63, v233
v_mul_f32 v248, v248, v233
v_exp_f32 v232, v160
v_exp_f32 v233, v161
s_nop 0
v_add_f32 v251, v232, v233
v_cvt_pk_bf16_f32 v224, v232, v233
v_exp_f32 v234, v162
v_exp_f32 v235, v163
v_add_f32 v251, v251, v234
v_cvt_pk_bf16_f32 v225, v234, v235
v_add_f32 v251, v251, v235
v_exp_f32 v232, v164
v_exp_f32 v233, v165
v_add_f32 v251, v251, v232
v_cvt_pk_bf16_f32 v226, v232, v233
v_add_f32 v251, v251, v233
v_exp_f32 v234, v166
v_exp_f32 v235, v167
v_add_f32 v251, v251, v234
v_cvt_pk_bf16_f32 v227, v234, v235
v_add_f32 v251, v251, v235
v_exp_f32 v232, v168
v_exp_f32 v233, v169
v_add_f32 v251, v251, v232
v_cvt_pk_bf16_f32 v228, v232, v233
v_add_f32 v251, v251, v233
v_exp_f32 v234, v170
v_exp_f32 v235, v171
v_add_f32 v251, v251, v234
v_cvt_pk_bf16_f32 v229, v234, v235
v_add_f32 v251, v251, v235
v_exp_f32 v232, v172
v_exp_f32 v233, v173
v_add_f32 v251, v251, v232
v_cvt_pk_bf16_f32 v230, v232, v233
v_add_f32 v251, v251, v233
v_exp_f32 v234, v174
v_exp_f32 v235, v175
v_add_f32 v251, v251, v234
v_cvt_pk_bf16_f32 v231, v234, v235
v_add_f32 v251, v251, v235
s_nop 15
s_cmp_eq_u32 s49, 2
s_cbranch_scc1 SM_2
s_cmp_eq_u32 s49, 4
s_cbranch_scc1 SM_4
s_cmp_eq_u32 s49, 18
s_cbranch_scc1 SM_18
s_cmp_eq_u32 s49, 20
s_cbranch_scc1 SM_20
s_cmp_eq_u32 s49, 6
s_cbranch_scc1 SM_6
s_cmp_eq_u32 s49, 8
s_cbranch_scc1 SM_8
s_cmp_eq_u32 s49, 10
s_cbranch_scc1 SM_10
s_cmp_eq_u32 s49, 12
s_cbranch_scc1 SM_12
s_branch SM_14
FIX_1:
s_nop 15
v_max3_f32 v232, v96, v97, v98
v_max3_f32 v232, v232, v99, v100
v_max3_f32 v232, v232, v101, v102
v_max3_f32 v232, v232, v103, v104
v_max3_f32 v232, v232, v105, v106
v_max3_f32 v232, v232, v107, v108
v_max3_f32 v232, v232, v109, v110
v_max_f32 v232, v232, v111
v_mov_b32 v233, v232
s_nop 1
v_permlane32_swap_b32 v232, v233
v_max_f32 v232, v232, v233
v_max_f32 v232, 0, v232
v_exp_f32 v233, -v232
v_sub_f32 v96, v96, v232
v_sub_f32 v97, v97, v232
v_sub_f32 v98, v98, v232
v_sub_f32 v99, v99, v232
v_sub_f32 v100, v100, v232
v_sub_f32 v101, v101, v232
v_sub_f32 v102, v102, v232
v_sub_f32 v103, v103, v232
v_sub_f32 v104, v104, v232
v_sub_f32 v105, v105, v232
v_sub_f32 v106, v106, v232
v_sub_f32 v107, v107, v232
v_sub_f32 v108, v108, v232
v_sub_f32 v109, v109, v232
v_sub_f32 v110, v110, v232
v_sub_f32 v111, v111, v232
v_sub_f32 v160, v160, v232
v_sub_f32 v161, v161, v232
v_sub_f32 v162, v162, v232
v_sub_f32 v163, v163, v232
v_sub_f32 v164, v164, v232
v_sub_f32 v165, v165, v232
v_sub_f32 v166, v166, v232
v_sub_f32 v167, v167, v232
v_sub_f32 v168, v168, v232
v_sub_f32 v169, v169, v232
v_sub_f32 v170, v170, v232
v_sub_f32 v171, v171, v232
v_sub_f32 v172, v172, v232
v_sub_f32 v173, v173, v232
v_sub_f32 v174, v174, v232
v_sub_f32 v175, v175, v232
v_sub_f32 v112, v112, v232
v_sub_f32 v113, v113, v232
v_sub_f32 v114, v114, v232
v_sub_f32 v115, v115, v232
v_sub_f32 v116, v116, v232
v_sub_f32 v117, v117, v232
v_sub_f32 v118, v118, v232
v_sub_f32 v119, v119, v232
v_sub_f32 v120, v120, v232
v_sub_f32 v121, v121, v232
v_sub_f32 v122, v122, v232
v_sub_f32 v123, v123, v232
v_sub_f32 v124, v124, v232
v_sub_f32 v125, v125, v232
v_sub_f32 v126, v126, v232
v_sub_f32 v127, v127, v232
v_mul_f32 v0, v0, v233
v_mul_f32 v1, v1, v233
v_mul_f32 v2, v2, v233
v_mul_f32 v3, v3, v233
v_mul_f32 v4, v4, v233
v_mul_f32 v5, v5, v233
v_mul_f32 v6, v6, v233
v_mul_f32 v7, v7, v233
v_mul_f32 v8, v8, v233
v_mul_f32 v9, v9, v233
v_mul_f32 v10, v10, v233
v_mul_f32 v11, v11, v233
v_mul_f32 v12, v12, v233
v_mul_f32 v13, v13, v233
v_mul_f32 v14, v14, v233
v_mul_f32 v15, v15, v233
v_mul_f32 v16, v16, v233
v_mul_f32 v17, v17, v233
v_mul_f32 v18, v18, v233
v_mul_f32 v19, v19, v233
v_mul_f32 v20, v20, v233
v_mul_f32 v21, v21, v233
v_mul_f32 v22, v22, v233
v_mul_f32 v23, v23, v233
v_mul_f32 v24, v24, v233
v_mul_f32 v25, v25, v233
v_mul_f32 v26, v26, v233
v_mul_f32 v27, v27, v233
v_mul_f32 v28, v28, v233
v_mul_f32 v29, v29, v233
v_mul_f32 v30, v30, v233
v_mul_f32 v31, v31, v233
v_mul_f32 v32, v32, v233
v_mul_f32 v33, v33, v233
v_mul_f32 v34, v34, v233
v_mul_f32 v35, v35, v233
v_mul_f32 v36, v36, v233
v_mul_f32 v37, v37, v233
v_mul_f32 v38, v38, v233
v_mul_f32 v39, v39, v233
v_mul_f32 v40, v40, v233
v_mul_f32 v41, v41, v233
v_mul_f32 v42, v42, v233
v_mul_f32 v43, v43, v233
v_mul_f32 v44, v44, v233
v_mul_f32 v45, v45, v233
v_mul_f32 v46, v46, v233
v_mul_f32 v47, v47, v233
v_mul_f32 v48, v48, v233
v_mul_f32 v49, v49, v233
v_mul_f32 v50, v50, v233
v_mul_f32 v51, v51, v233
v_mul_f32 v52, v52, v233
v_mul_f32 v53, v53, v233
v_mul_f32 v54, v54, v233
v_mul_f32 v55, v55, v233
v_mul_f32 v56, v56, v233
v_mul_f32 v57, v57, v233
v_mul_f32 v58, v58, v233
v_mul_f32 v59, v59, v233
v_mul_f32 v60, v60, v233
v_mul_f32 v61, v61, v233
v_mul_f32 v62, v62, v233
v_mul_f32 v63, v63, v233
v_mul_f32 v248, v248, v233
v_exp_f32 v232, v96
v_exp_f32 v233, v97
s_nop 0
v_add_f32 v251, v232, v233
v_cvt_pk_bf16_f32 v224, v232, v233
v_exp_f32 v234, v98
v_exp_f32 v235, v99
v_add_f32 v251, v251, v234
v_cvt_pk_bf16_f32 v225, v234, v235
v_add_f32 v251, v251, v235
v_exp_f32 v232, v100
v_exp_f32 v233, v101
v_add_f32 v251, v251, v232
v_cvt_pk_bf16_f32 v226, v232, v233
v_add_f32 v251, v251, v233
v_exp_f32 v234, v102
v_exp_f32 v235, v103
v_add_f32 v251, v251, v234
v_cvt_pk_bf16_f32 v227, v234, v235
v_add_f32 v251, v251, v235
v_exp_f32 v232, v104
v_exp_f32 v233, v105
v_add_f32 v251, v251, v232
v_cvt_pk_bf16_f32 v228, v232, v233
v_add_f32 v251, v251, v233
v_exp_f32 v234, v106
v_exp_f32 v235, v107
v_add_f32 v251, v251, v234
v_cvt_pk_bf16_f32 v229, v234, v235
v_add_f32 v251, v251, v235
v_exp_f32 v232, v108
v_exp_f32 v233, v109
v_add_f32 v251, v251, v232
v_cvt_pk_bf16_f32 v230, v232, v233
v_add_f32 v251, v251, v233
v_exp_f32 v234, v110
v_exp_f32 v235, v111
v_add_f32 v251, v251, v234
v_cvt_pk_bf16_f32 v231, v234, v235
v_add_f32 v251, v251, v235
s_nop 15
s_cmp_eq_u32 s49, 1
s_cbranch_scc1 SM_1
s_cmp_eq_u32 s49, 3
s_cbranch_scc1 SM_3
s_cmp_eq_u32 s49, 5
s_cbranch_scc1 SM_5
s_cmp_eq_u32 s49, 17
s_cbranch_scc1 SM_17
s_cmp_eq_u32 s49, 19
s_cbranch_scc1 SM_19
s_cmp_eq_u32 s49, 21
s_cbranch_scc1 SM_21
s_cmp_eq_u32 s49, 7
s_cbranch_scc1 SM_7
s_cmp_eq_u32 s49, 9
s_cbranch_scc1 SM_9
s_cmp_eq_u32 s49, 11
s_cbranch_scc1 SM_11
s_cmp_eq_u32 s49, 13
s_cbranch_scc1 SM_13
s_branch SM_15
L_end:
s_endpgm
.section .rodata,"a"
.p2align 6
.amdhsa_kernel concat_heads__gqa_block_cached__gqa_block_cached__near_ridge_kernel
  .amdhsa_next_free_vgpr 256
  .amdhsa_next_free_sgpr 102
  .amdhsa_accum_offset 256
  .amdhsa_group_segment_fixed_size 0
  .amdhsa_kernarg_size 104
  .amdhsa_user_sgpr_count 2
  .amdhsa_user_sgpr_kernarg_segment_ptr 1
  .amdhsa_system_sgpr_workgroup_id_x 1
.end_amdhsa_kernel
```
